```python
import torch

def _softmax(x, axis=-1):
    return torch.softmax(x, dim=axis)
def _gelu(x):
    return torch.nn.functional.gelu(x, approximate="tanh")
def _silu(x):
    return torch.nn.functional.silu(x)
def _sigmoid(x):
    return torch.sigmoid(x)
def _layernorm(x, axis=-1, eps=1e-5):
    m = x.mean(dim=axis, keepdim=True)
    v = x.var(dim=axis, keepdim=True, unbiased=False)
    return (x - m) / torch.sqrt(v + eps)
def _scatter_add(tgt, idx, src, axis=0):
    return tgt.clone().index_add_(axis, idx, src)
def _segment_sum(src, seg, n):
    out = torch.zeros((n,) + src.shape[1:], dtype=src.dtype)
    return out.index_add_(0, seg, src)
def _pad(x, pw):
    flat = tuple(v for pair in reversed(pw) for v in pair)
    return torch.nn.functional.pad(x, flat)

kernel_name = 'recurrent_scan__linear_kernel_hedgehog__dense_activation_squared_relu__prompt'

def setup_inputs():

    _w = (lambda a: (lambda t: t.to(torch.bfloat16) if t.is_floating_point() else t)(torch.as_tensor(a)))
    def _A_setup():
        B, S, D, H = 1, 2048, 448, 16
        Dh = D // H
        return {
            "x": _w((lambda *s: torch.randn(*s, dtype=torch.bfloat16) * 0.05)(B, S, D)),
            "wqkv": _w((lambda *s: torch.randn(*s, dtype=torch.bfloat16) * 0.2)(D, 3 * D)),
            "w_phi": _w((lambda *s: torch.randn(*s, dtype=torch.bfloat16) * 0.2)(H, Dh, Dh) * (Dh ** -0.5)),
            "wo": _w((lambda *s: torch.randn(*s, dtype=torch.bfloat16) * 0.05)(D, D)),
        }
    _A_in = _A_setup()

    def _B_setup():
        B, S, D, F = 1, 2048, 448, 1792
        return {
            "x": _w((lambda *s: torch.randn(*s, dtype=torch.bfloat16) * 0.05)(B, S, D)),
            "w1": _w((lambda *s: torch.randn(*s, dtype=torch.bfloat16) * 0.05)(D, F)),
            "b1": _w((lambda *s: torch.randn(*s, dtype=torch.bfloat16) * 0.2)(F)),
            "w2": _w((lambda *s: torch.randn(*s, dtype=torch.bfloat16) * 0.05)(F, D)),
            "b2": _w((lambda *s: torch.randn(*s, dtype=torch.bfloat16) * 0.8)(D)),
        }
    _B_in = _B_setup()

    return {
        "A_x": _A_in["x"],
        "A_wqkv": _A_in["wqkv"],
        "A_w_phi": _A_in["w_phi"],
        "A_wo": _A_in["wo"],
        "B_x": _B_in["x"],
        "B_w1": _B_in["w1"],
        "B_b1": _B_in["b1"],
        "B_w2": _B_in["w2"],
        "B_b2": _B_in["b2"],
    }

def reference(A_x, A_wqkv, A_w_phi, A_wo, B_x, B_w1, B_b1, B_w2, B_b2):
    def _A_ref(x, wqkv, w_phi, wo):
        B, S, D = x.shape
        H = 16; Dh = D // H
        qkv = (lambda x, *d: x.permute(*d))((x @ wqkv).reshape(B, S, 3, H, Dh), 2, 0, 3, 1, 4)
        q, k, v = qkv[0], qkv[1], qkv[2]
        pq = torch.einsum("bhsd,hdf->bhsf", q, w_phi)
        pk = torch.einsum("bhsd,hdf->bhsf", k, w_phi)
        phi_q = torch.concatenate([_softmax(pq, axis=-1), _softmax(-pq, axis=-1)], axis=-1)
        phi_k = torch.concatenate([_softmax(pk, axis=-1), _softmax(-pk, axis=-1)], axis=-1)
        kv = torch.einsum("bhsf,bhsd->bhfd", phi_k, v)
        z  = torch.einsum("bhsf->bhf", phi_k)
        num = torch.einsum("bhqf,bhfd->bhqd", phi_q, kv)
        den = torch.einsum("bhqf,bhf->bhq", phi_q, z)[..., None] + 1e-6
        o = num / den
        return (lambda x, *d: x.permute(*d))(o, 0, 2, 1, 3).reshape(B, S, D) @ wo

    def _B_ref(x, w1, b1, w2, b2):
        h = torch.einsum("bsd,df->bsf", x, w1) + b1
        zero = torch.zeros_like(h)
        r = torch.where(h > zero, h, zero)
        h = r * r
        out = torch.einsum("bsf,fd->bsd", h, w2) + b2
        return out

    x = A_x
    xn = _layernorm(x, axis=-1)
    s = _A_ref(xn, A_wqkv, A_w_phi, A_wo)
    g = _silu(_B_ref(xn, B_w1, B_b1, B_w2, B_b2))
    return x + s * g
```

```asm
; @launch grid=(256,1,1) block=(512,1,1) lds=163840
.amdgcn_target "amdgcn-amd-amdhsa--gfx950"
.text
.globl recurrent_scan__linear_kernel_hedgehog__dense_activation_squared_relu__prompt_kernel
.p2align 8
.type recurrent_scan__linear_kernel_hedgehog__dense_activation_squared_relu__prompt_kernel,@function
recurrent_scan__linear_kernel_hedgehog__dense_activation_squared_relu__prompt_kernel:
    s_cmp_ge_u32 s2, 256
    s_cbranch_scc1 L_end
    s_load_dwordx2 s[24:25], s[0:1], 8
    s_load_dwordx2 s[4:5], s[0:1], 0
    s_load_dwordx2 s[12:13], s[0:1], 40
    s_load_dwordx2 s[8:9], s[0:1], 88
    v_lshrrev_b32 v2, 6, v0
    v_and_b32 v1, 63, v0
    v_readfirstlane_b32 s44, v2
    s_mov_b32 s61, s2
    s_nop 0
    s_cmp_lg_u32 s44, 7
    s_cbranch_scc1 L_nocp
    s_getpc_b64 s[66:67]
L_pc:
    s_sub_u32 s66, s66, L_pc-recurrent_scan__linear_kernel_hedgehog__dense_activation_squared_relu__prompt_kernel
    s_subb_u32 s67, s67, 0
    s_lshr_b32 s52, s2, 3
    s_lshl_b32 s52, s52, 11
    v_lshlrev_b32 v222, 7, v1
    v_add_u32 v222, s52, v222
    v_min_u32 v222, L_code_end-recurrent_scan__linear_kernel_hedgehog__dense_activation_squared_relu__prompt_kernel-4, v222
    s_mov_b64 exec, 0xffff
    global_load_dword v249, v222, s[66:67]
    s_mov_b64 exec, -1
L_nocp:
    s_load_dwordx2 s[32:33], s[0:1], 16
    s_load_dwordx2 s[20:21], s[0:1], 24
    s_load_dwordx2 s[36:37], s[0:1], 48
    s_load_dwordx2 s[16:17], s[0:1], 56
    s_load_dwordx2 s[40:41], s[0:1], 64
    s_load_dwordx2 s[28:29], s[0:1], 72
    s_and_b32 s52, s2, 7
    s_lshr_b32 s53, s2, 3
    s_lshr_b32 s54, s53, 4
    s_lshl_b32 s46, s52, 1
    s_add_u32 s46, s46, s54
    s_and_b32 s47, s53, 15
    s_mov_b32 s75, 0
    v_lshrrev_b32 v3, 4, v1
    s_lshl_b32 s58, s44, 11
    s_lshl_b32 s59, s44, 10
    s_lshl_b32 s52, s44, 6
    v_add_u32 v222, s52, v1
    v_mul_u32_u24 v223, 5958, v222
    v_lshrrev_b32 v223, 16, v223
    v_mul_u32_u24 v224, 11, v223
    v_sub_u32 v224, v222, v224
    s_lshr_b32 s52, s61, 4
    s_lshl_b32 s53, s52, 5
    v_add_u32 v223, s53, v223
    v_mul_u32_u24 v223, 2688, v223
    v_lshl_add_u32 v230, v224, 4, v223
    s_and_b32 s53, s61, 15
    s_mul_i32 s53, s53, 168
    v_add_u32 v230, s53, v230
    v_cmp_gt_u32 vcc, 352, v222
    v_mov_b32 v225, 1073741824
    s_cmp_ge_u32 s52, 14
    s_cselect_b32 s55, 1073741824, 0
    v_cndmask_b32 v230, v225, v230, vcc
    v_lshrrev_b32 v222, 3, v1
    s_lshl_b32 s52, s44, 4
    s_lshl_b32 s53, s46, 7
    s_add_u32 s52, s52, s53
    v_add_u32 v222, s52, v222
    v_mul_u32_u24 v222, 896, v222
    v_and_b32 v223, 7, v1
    v_xor_b32 v224, v223, v3
    v_lshl_add_u32 v4, v224, 4, v222
    v_xor_b32 v224, 4, v224
    v_lshl_add_u32 v5, v224, 4, v222
    v_add_u32 v5, 7168, v5
    s_mov_b32 s26, 1204224
    s_mov_b32 s27, 0x20000
    s_mov_b32 s6, 1835008
    s_mov_b32 s7, 0x20000
    s_waitcnt lgkmcnt(0)
    s_add_u32 m0, s59, 131072
    s_nop 0
    buffer_load_dwordx4 v230, s[24:27], s55 offen lds
    s_mul_i32 s2, s75, 384
    s_add_u32 s2, s2, 0
    s_add_u32 m0, s58, 0
    s_nop 0
    buffer_load_dwordx4 v4, s[4:7], s2 offen lds
    s_add_u32 m0, s58, 1024
    s_nop 0
    buffer_load_dwordx4 v5, s[4:7], s2 offen lds
    s_load_dword s60, s[8:9], 0
    v_and_b32 v2, 15, v1
    v_lshlrev_b32 v7, 4, v1
    s_and_b32 s45, s44, 3
    s_and_b32 s52, s44, 1
    s_lshl_b32 s52, s52, 2
    v_or_b32 v222, s52, v3
    v_lshrrev_b32 v223, 1, v2
    v_xor_b32 v223, v223, v222
    v_and_b32 v224, 1, v1
    v_lshl_add_u32 v223, v223, 1, v224
    s_lshl_b32 s52, s44, 3
    v_add_u32 v222, s52, v3
    v_mul_u32_u24 v222, 3584, v222
    v_lshl_add_u32 v6, v223, 4, v222
    s_lshl_b32 s52, s47, 8
    v_add_u32 v6, s52, v6
    s_mov_b32 s14, 1605632
    s_mov_b32 s15, 0x20000
    s_mov_b32 s10, 23068672
    s_mov_b32 s11, 0x20000
    s_mov_b32 s34, 25088
    s_mov_b32 s35, 0x20000
    s_mov_b32 s22, 401408
    s_mov_b32 s23, 0x20000
    s_mov_b32 s38, 3584
    s_mov_b32 s39, 0x20000
    s_mov_b32 s18, 1605632
    s_mov_b32 s19, 0x20000
    s_mov_b32 s42, 896
    s_mov_b32 s43, 0x20000
    s_mov_b32 s30, 1835008
    s_mov_b32 s31, 0x20000
    s_cmp_ge_u32 s47, 14
    s_cbranch_scc1 L_helper
    s_cmp_ge_u32 s44, 4
    s_cbranch_scc1 L_ffnB
    s_branch L_ffnA
L_ffnA:
    s_mul_i32 s2, s75, 688128
    s_add_u32 s2, s2, 0
    s_add_u32 m0, s58, 49152
    s_nop 0
    buffer_load_dwordx4 v6, s[12:15], s2 offen lds
    s_add_u32 s2, s2, 14336
    s_add_u32 m0, s58, 50176
    s_nop 0
    buffer_load_dwordx4 v6, s[12:15], s2 offen lds
    s_mul_i32 s2, s75, 384
    s_add_u32 s2, s2, 128
    s_add_u32 m0, s58, 16384
    s_nop 0
    buffer_load_dwordx4 v4, s[4:7], s2 offen lds
    s_add_u32 m0, s58, 17408
    s_nop 0
    buffer_load_dwordx4 v5, s[4:7], s2 offen lds
    s_mul_i32 s2, s75, 688128
    s_add_u32 s2, s2, 229376
    s_add_u32 m0, s58, 65536
    s_nop 0
    buffer_load_dwordx4 v6, s[12:15], s2 offen lds
    s_add_u32 s2, s2, 14336
    s_add_u32 m0, s58, 66560
    s_nop 0
    buffer_load_dwordx4 v6, s[12:15], s2 offen lds
    s_cmp_ge_u32 s47, 7
    s_cselect_b32 s50, 1, 0
    s_mul_i32 s52, s50, 7
    s_sub_u32 s51, s47, s52
    s_mul_i32 s3, s50, 802816
    s_mov_b32 s49, 0
    s_getreg_b32 s71, hwreg(HW_REG_XCC_ID)
    s_and_b32 s71, s71, 15
    v_mov_b32 v15, 0
    s_movk_i32 s74, 0xfff
    v_mov_b32 v16, 0x3f803f80
    v_mov_b32 v17, 0x3f803f80
    v_mov_b32 v18, 0x3f803f80
    v_mov_b32 v19, 0x3f803f80
    v_cmp_eq_u32 s[62:63], 3, v3
    v_cmp_le_u32 s[64:65], 12, v2
    s_mul_i32 s52, s47, 1568
    s_lshl_b32 s53, s44, 8
    s_add_u32 s52, s52, s53
    s_add_u32 m0, s53, 155648
    s_mov_b64 exec, 0xffff
    buffer_load_dwordx4 v7, s[32:35], s52 offen lds
    s_mov_b64 exec, -1
    v_lshrrev_b32 v222, 1, v2
    v_xor_b32 v222, v222, v3
    v_lshlrev_b32 v223, 7, v2
    s_lshl_b32 s52, s45, 12
    v_add_u32 v223, s52, v223
    v_lshl_add_u32 v12, v222, 4, v223
    v_xor_b32 v222, 4, v222
    v_lshl_add_u32 v13, v222, 4, v223
    v_add_u32 v220, 0x10000, v12
    v_add_u32 v221, 0x10000, v13
    v_lshrrev_b32 v222, 2, v2
    v_lshl_add_u32 v223, v3, 3, v222
    v_lshlrev_b32 v223, 8, v223
    v_and_b32 v224, 3, v1
    v_lshl_add_u32 v223, v224, 3, v223
    v_and_b32 v224, 1, v3
    v_lshl_or_b32 v222, v224, 2, v222
    s_xor_b32 s52, s45, 0
    s_add_u32 s52, s52, 0
    v_xor_b32 v224, s52, v222
    v_lshl_add_u32 v8, v224, 5, v223
    v_add_u32 v216, 0x10000, v8
    s_xor_b32 s52, s45, 1
    s_add_u32 s52, s52, 0
    v_xor_b32 v224, s52, v222
    v_lshl_add_u32 v9, v224, 5, v223
    v_add_u32 v217, 0x10000, v9
    s_xor_b32 s52, s45, 2
    s_add_u32 s52, s52, 0
    v_xor_b32 v224, s52, v222
    v_lshl_add_u32 v10, v224, 5, v223
    v_add_u32 v218, 0x10000, v10
    s_xor_b32 s52, s45, 3
    s_add_u32 s52, s52, 0
    v_xor_b32 v224, s52, v222
    v_lshl_add_u32 v11, v224, 5, v223
    v_add_u32 v219, 0x10000, v11
    v_and_b32 v222, 7, v1
    v_lshrrev_b32 v222, 1, v222
    v_xor_b32 v222, v222, v3
    v_and_b32 v223, 1, v1
    v_lshl_add_u32 v222, v222, 1, v223
    v_lshlrev_b32 v222, 4, v222
    s_lshl_b32 s52, s51, 7
    v_add_u32 v222, s52, v222
    v_lshrrev_b32 v223, 3, v1
    s_lshl_b32 s52, s44, 3
    v_add_u32 v223, s52, v223
    v_mul_u32_u24 v224, 896, v223
    v_add_u32 v252, v224, v222
    v_lshrrev_b32 v224, 5, v223
    v_lshlrev_b32 v224, 2, v224
    v_sub_u32 v224, v223, v224
    v_mul_u32_u24 v224, 896, v224
    v_add_u32 v253, v224, v222
    v_mov_b32 v132, 0
    v_mov_b32 v133, 0
    v_mov_b32 v134, 0
    v_mov_b32 v135, 0
    v_mov_b32 v136, 0
    v_mov_b32 v137, 0
    v_mov_b32 v138, 0
    v_mov_b32 v139, 0
    v_mov_b32 v140, 0
    v_mov_b32 v141, 0
    v_mov_b32 v142, 0
    v_mov_b32 v143, 0
    v_mov_b32 v144, 0
    v_mov_b32 v145, 0
    v_mov_b32 v146, 0
    v_mov_b32 v147, 0
    v_mov_b32 v148, 0
    v_mov_b32 v149, 0
    v_mov_b32 v150, 0
    v_mov_b32 v151, 0
    v_mov_b32 v152, 0
    v_mov_b32 v153, 0
    v_mov_b32 v154, 0
    v_mov_b32 v155, 0
    v_mov_b32 v156, 0
    v_mov_b32 v157, 0
    v_mov_b32 v158, 0
    v_mov_b32 v159, 0
    v_mov_b32 v160, 0
    v_mov_b32 v161, 0
    v_mov_b32 v162, 0
    v_mov_b32 v163, 0
    v_mov_b32 v196, 0
    v_mov_b32 v197, 0
    v_mov_b32 v198, 0
    v_mov_b32 v199, 0
    v_mov_b32 v200, 0
    v_mov_b32 v201, 0
    v_mov_b32 v202, 0
    v_mov_b32 v203, 0
    v_mov_b32 v204, 0
    v_mov_b32 v205, 0
    v_mov_b32 v206, 0
    v_mov_b32 v207, 0
    s_cmp_ge_u32 s44, 6
    s_cselect_b32 s52, 2, 0
    s_sub_u32 s52, s44, s52
    s_lshr_b32 s53, s52, 1
    s_and_b32 s54, s52, 1
    v_lshrrev_b32 v222, 2, v2
    v_lshl_add_u32 v222, v3, 3, v222
    v_mul_u32_u24 v222, 176, v222
    v_and_b32 v223, 3, v1
    v_lshl_add_u32 v222, v223, 3, v222
    s_mul_i32 s55, s53, 56
    s_lshl_b32 s56, s54, 5
    s_add_u32 s55, s55, s56
    s_add_u32 s55, s55, 131072
    v_add_u32 v222, s55, v222
    s_and_b32 s55, s61, 15
    s_mul_i32 s55, s55, 3
    s_add_u32 s55, s55, s53
    s_and_b32 s56, s55, 15
    s_lshr_b32 s55, s55, 4
    s_add_u32 s55, s55, 2
    s_cmp_ge_u32 s55, 3
    s_cselect_b32 s57, 3, 0
    s_sub_u32 s55, s55, s57
    s_mul_i32 s56, s56, 3
    s_add_u32 s56, s56, s55
    s_lshl_b32 s56, s56, 1
    s_add_u32 s56, s56, s54
    s_mul_i32 s56, s56, 14336
    s_lshr_b32 s55, s61, 4
    s_lshl_b32 s57, s55, 10
    s_add_u32 s56, s56, s57
    s_add_u32 s56, s56, 262144
    s_cmp_ge_u32 s55, 14
    s_cselect_b32 s57, 1073741824, 0
    s_add_u32 s56, s56, s57
    s_waitcnt vmcnt(9)
    s_waitcnt lgkmcnt(0)
    s_add_u32 s48, s60, 0x9e3779b9
    v_mov_b32 v14, s48
    s_barrier
    ds_read_b64_tr_b16 v[226:227], v222
    ds_read_b64_tr_b16 v[228:229], v222 offset:704
    s_waitcnt lgkmcnt(0)
    buffer_store_dwordx4 v[226:229], v7, s[8:11], s56 offen sc1
    s_cmp_lg_u32 s45, 0
    s_cbranch_scc1 L_nw_1
    s_and_b32 s52, s61, 7
    s_lshl_b32 s52, s52, 7
    s_lshr_b32 s53, s61, 3
    s_lshl_b32 s53, s53, 2
    s_add_u32 s52, s52, s53
    s_add_u32 s52, s52, 4096
    s_add_u32 s53, s48, s71
    v_mov_b32 v230, s53
    s_mov_b64 exec, 1
    buffer_store_dword v230, v15, s[8:11], s52 offen sc1
    s_mov_b64 exec, -1
L_nw_1:
    s_mul_i32 s2, s75, 688128
    s_add_u32 s2, s2, 458752
    s_add_u32 m0, s58, 81920
    s_nop 0
    buffer_load_dwordx4 v6, s[12:15], s2 offen lds
    s_add_u32 s2, s2, 14336
    s_add_u32 m0, s58, 82944
    s_nop 0
    buffer_load_dwordx4 v6, s[12:15], s2 offen lds
    s_mul_i32 s2, s75, 384
    s_add_u32 s2, s2, 256
    s_add_u32 m0, s58, 32768
    s_nop 0
    buffer_load_dwordx4 v4, s[4:7], s2 offen lds
    s_add_u32 m0, s58, 33792
    s_nop 0
    buffer_load_dwordx4 v5, s[4:7], s2 offen lds
    s_waitcnt vmcnt(10)
    s_barrier
    ds_read_b128 v[20:23], v12 offset:0
    ds_read_b64_tr_b16 v[164:165], v8 offset:49152
    ds_read_b64_tr_b16 v[166:167], v8 offset:50176
    ds_read_b128 v[24:27], v12 offset:2048
    ds_read_b64_tr_b16 v[168:169], v9 offset:49152
    ds_read_b64_tr_b16 v[170:171], v9 offset:50176
    ds_read_b64_tr_b16 v[172:173], v10 offset:49152
    ds_read_b64_tr_b16 v[174:175], v10 offset:50176
    ds_read_b64_tr_b16 v[176:177], v11 offset:49152
    ds_read_b64_tr_b16 v[178:179], v11 offset:50176
    s_waitcnt lgkmcnt(7)
    v_mfma_f32_16x16x32_bf16 v[132:135], v[164:167], v[20:23], v[132:135]
    ds_read_b128 v[28:31], v13 offset:0
    s_waitcnt lgkmcnt(7)
    v_mfma_f32_16x16x32_bf16 v[136:139], v[164:167], v[24:27], v[136:139]
    ds_read_b64_tr_b16 v[180:181], v8 offset:57344
    s_waitcnt lgkmcnt(6)
    v_mfma_f32_16x16x32_bf16 v[140:143], v[168:171], v[20:23], v[140:143]
    ds_read_b64_tr_b16 v[182:183], v8 offset:58368
    v_mfma_f32_16x16x32_bf16 v[144:147], v[168:171], v[24:27], v[144:147]
    ds_read_b128 v[32:35], v13 offset:2048
    s_mul_i32 s2, s75, 688128
    s_add_u32 s2, s2, 688128
    s_add_u32 m0, s58, 98304
    s_nop 0
    buffer_load_dwordx4 v6, s[12:15], s2 offen lds
    s_waitcnt lgkmcnt(6)
    v_mfma_f32_16x16x32_bf16 v[148:151], v[172:175], v[20:23], v[148:151]
    ds_read_b64_tr_b16 v[184:185], v9 offset:57344
    v_mfma_f32_16x16x32_bf16 v[152:155], v[172:175], v[24:27], v[152:155]
    ds_read_b64_tr_b16 v[186:187], v9 offset:58368
    s_waitcnt lgkmcnt(6)
    v_mfma_f32_16x16x32_bf16 v[156:159], v[176:179], v[20:23], v[156:159]
    ds_read_b64_tr_b16 v[188:189], v10 offset:57344
    v_mfma_f32_16x16x32_bf16 v[160:163], v[176:179], v[24:27], v[160:163]
    ds_read_b64_tr_b16 v[190:191], v10 offset:58368
    s_add_u32 s2, s2, 14336
    s_add_u32 m0, s58, 99328
    s_nop 0
    buffer_load_dwordx4 v6, s[12:15], s2 offen lds
    v_mfma_f32_16x16x32_bf16 v[196:199], v[164:167], v[16:19], v[196:199]
    ds_read_b64_tr_b16 v[192:193], v11 offset:57344
    v_mfma_f32_16x16x32_bf16 v[200:203], v[16:19], v[20:23], v[200:203]
    ds_read_b64_tr_b16 v[194:195], v11 offset:58368
    v_mfma_f32_16x16x32_bf16 v[204:207], v[20:23], v[20:23], v[204:207]
    s_waitcnt vmcnt(8)
    s_barrier
    s_waitcnt lgkmcnt(7)
    v_mfma_f32_16x16x32_bf16 v[132:135], v[180:183], v[28:31], v[132:135]
    ds_read_b128 v[36:39], v12 offset:16384
    s_waitcnt lgkmcnt(7)
    v_mfma_f32_16x16x32_bf16 v[136:139], v[180:183], v[32:35], v[136:139]
    ds_read_b64_tr_b16 v[164:165], v216 offset:0
    s_waitcnt lgkmcnt(6)
    v_mfma_f32_16x16x32_bf16 v[140:143], v[184:187], v[28:31], v[140:143]
    ds_read_b64_tr_b16 v[166:167], v216 offset:1024
    v_mfma_f32_16x16x32_bf16 v[144:147], v[184:187], v[32:35], v[144:147]
    ds_read_b128 v[40:43], v12 offset:18432
    s_mul_i32 s2, s75, 4294049792
    s_add_u32 s2, s2, 917504
    s_add_u32 m0, s58, 114688
    s_nop 0
    buffer_load_dwordx4 v6, s[12:15], s2 offen lds
    s_waitcnt lgkmcnt(6)
    v_mfma_f32_16x16x32_bf16 v[148:151], v[188:191], v[28:31], v[148:151]
    ds_read_b64_tr_b16 v[168:169], v217 offset:0
    v_mfma_f32_16x16x32_bf16 v[152:155], v[188:191], v[32:35], v[152:155]
    ds_read_b64_tr_b16 v[170:171], v217 offset:1024
    s_waitcnt lgkmcnt(6)
    v_mfma_f32_16x16x32_bf16 v[156:159], v[192:195], v[28:31], v[156:159]
    ds_read_b64_tr_b16 v[172:173], v218 offset:0
    v_mfma_f32_16x16x32_bf16 v[160:163], v[192:195], v[32:35], v[160:163]
    ds_read_b64_tr_b16 v[174:175], v218 offset:1024
    s_add_u32 s2, s2, 14336
    s_add_u32 m0, s58, 115712
    s_nop 0
    buffer_load_dwordx4 v6, s[12:15], s2 offen lds
    v_mfma_f32_16x16x32_bf16 v[196:199], v[180:183], v[16:19], v[196:199]
    ds_read_b64_tr_b16 v[176:177], v219 offset:0
    v_mfma_f32_16x16x32_bf16 v[200:203], v[16:19], v[28:31], v[200:203]
    ds_read_b64_tr_b16 v[178:179], v219 offset:1024
    v_mfma_f32_16x16x32_bf16 v[204:207], v[28:31], v[28:31], v[204:207]
    s_waitcnt lgkmcnt(7)
    v_mfma_f32_16x16x32_bf16 v[132:135], v[164:167], v[36:39], v[132:135]
    ds_read_b128 v[44:47], v13 offset:16384
    s_waitcnt lgkmcnt(7)
    v_mfma_f32_16x16x32_bf16 v[136:139], v[164:167], v[40:43], v[136:139]
    ds_read_b64_tr_b16 v[180:181], v216 offset:8192
    s_waitcnt lgkmcnt(6)
    v_mfma_f32_16x16x32_bf16 v[140:143], v[168:171], v[36:39], v[140:143]
    ds_read_b64_tr_b16 v[182:183], v216 offset:9216
    v_mfma_f32_16x16x32_bf16 v[144:147], v[168:171], v[40:43], v[144:147]
    ds_read_b128 v[48:51], v13 offset:18432
    s_mul_i32 s2, s75, 384
    s_add_u32 s2, s2, 384
    s_add_u32 m0, s58, 0
    s_nop 0
    buffer_load_dwordx4 v4, s[4:7], s2 offen lds
    s_waitcnt lgkmcnt(6)
    v_mfma_f32_16x16x32_bf16 v[148:151], v[172:175], v[36:39], v[148:151]
    ds_read_b64_tr_b16 v[184:185], v217 offset:8192
    v_mfma_f32_16x16x32_bf16 v[152:155], v[172:175], v[40:43], v[152:155]
    ds_read_b64_tr_b16 v[186:187], v217 offset:9216
    s_waitcnt lgkmcnt(6)
    v_mfma_f32_16x16x32_bf16 v[156:159], v[176:179], v[36:39], v[156:159]
    ds_read_b64_tr_b16 v[188:189], v218 offset:8192
    v_mfma_f32_16x16x32_bf16 v[160:163], v[176:179], v[40:43], v[160:163]
    ds_read_b64_tr_b16 v[190:191], v218 offset:9216
    s_add_u32 m0, s58, 1024
    s_nop 0
    buffer_load_dwordx4 v5, s[4:7], s2 offen lds
    v_mfma_f32_16x16x32_bf16 v[196:199], v[164:167], v[16:19], v[196:199]
    ds_read_b64_tr_b16 v[192:193], v219 offset:8192
    v_mfma_f32_16x16x32_bf16 v[200:203], v[16:19], v[36:39], v[200:203]
    ds_read_b64_tr_b16 v[194:195], v219 offset:9216
    v_mfma_f32_16x16x32_bf16 v[204:207], v[36:39], v[36:39], v[204:207]
    s_waitcnt vmcnt(6)
    s_barrier
    s_cmp_lg_u32 s45, 0
    s_cbranch_scc1 L_nw_2
    s_and_b32 s52, s61, 15
    s_lshl_b32 s52, s52, 7
    s_lshr_b32 s53, s61, 4
    s_lshl_b32 s54, s53, 2
    s_add_u32 s52, s52, s54
    s_add_u32 s52, s52, 8192
    s_cmp_ge_u32 s53, 14
    s_cselect_b32 s53, 1073741824, 0
    s_add_u32 s52, s52, s53
    s_mov_b64 exec, 1
    buffer_store_dword v14, v15, s[8:11], s52 offen sc1
    s_mov_b64 exec, -1
L_nw_2:
    s_waitcnt lgkmcnt(7)
    v_mfma_f32_16x16x32_bf16 v[132:135], v[180:183], v[44:47], v[132:135]
    ds_read_b128 v[52:55], v12 offset:32768
    s_waitcnt lgkmcnt(7)
    v_mfma_f32_16x16x32_bf16 v[136:139], v[180:183], v[48:51], v[136:139]
    ds_read_b64_tr_b16 v[164:165], v216 offset:16384
    s_waitcnt lgkmcnt(6)
    v_mfma_f32_16x16x32_bf16 v[140:143], v[184:187], v[44:47], v[140:143]
    ds_read_b64_tr_b16 v[166:167], v216 offset:17408
    v_mfma_f32_16x16x32_bf16 v[144:147], v[184:187], v[48:51], v[144:147]
    ds_read_b128 v[56:59], v12 offset:34816
    s_mul_i32 s2, s75, 4294049792
    s_add_u32 s2, s2, 1146880
    s_add_u32 m0, s58, 49152
    s_nop 0
    buffer_load_dwordx4 v6, s[12:15], s2 offen lds
    s_waitcnt lgkmcnt(6)
    v_mfma_f32_16x16x32_bf16 v[148:151], v[188:191], v[44:47], v[148:151]
    ds_read_b64_tr_b16 v[168:169], v217 offset:16384
    v_mfma_f32_16x16x32_bf16 v[152:155], v[188:191], v[48:51], v[152:155]
    ds_read_b64_tr_b16 v[170:171], v217 offset:17408
    s_waitcnt lgkmcnt(6)
    v_mfma_f32_16x16x32_bf16 v[156:159], v[192:195], v[44:47], v[156:159]
    ds_read_b64_tr_b16 v[172:173], v218 offset:16384
    v_mfma_f32_16x16x32_bf16 v[160:163], v[192:195], v[48:51], v[160:163]
    ds_read_b64_tr_b16 v[174:175], v218 offset:17408
    s_add_u32 s2, s2, 14336
    s_add_u32 m0, s58, 50176
    s_nop 0
    buffer_load_dwordx4 v6, s[12:15], s2 offen lds
    v_mfma_f32_16x16x32_bf16 v[196:199], v[180:183], v[16:19], v[196:199]
    ds_read_b64_tr_b16 v[176:177], v219 offset:16384
    v_mfma_f32_16x16x32_bf16 v[200:203], v[16:19], v[44:47], v[200:203]
    ds_read_b64_tr_b16 v[178:179], v219 offset:17408
    v_mfma_f32_16x16x32_bf16 v[204:207], v[44:47], v[44:47], v[204:207]
    s_waitcnt lgkmcnt(7)
    v_mfma_f32_16x16x32_bf16 v[132:135], v[164:167], v[52:55], v[132:135]
    ds_read_b128 v[60:63], v13 offset:32768
    s_waitcnt lgkmcnt(7)
    v_mfma_f32_16x16x32_bf16 v[136:139], v[164:167], v[56:59], v[136:139]
    ds_read_b64_tr_b16 v[180:181], v216 offset:24576
    s_waitcnt lgkmcnt(6)
    v_mfma_f32_16x16x32_bf16 v[140:143], v[168:171], v[52:55], v[140:143]
    ds_read_b64_tr_b16 v[182:183], v216 offset:25600
    s_mul_i32 s2, s75, 4294966784
    s_add_u32 s2, s2, 512
    s_add_u32 m0, s58, 16384
    s_nop 0
    buffer_load_dwordx4 v4, s[4:7], s2 offen lds
    v_mfma_f32_16x16x32_bf16 v[144:147], v[168:171], v[56:59], v[144:147]
    ds_read_b128 v[64:67], v13 offset:34816
    s_waitcnt lgkmcnt(6)
    v_mfma_f32_16x16x32_bf16 v[148:151], v[172:175], v[52:55], v[148:151]
    ds_read_b64_tr_b16 v[184:185], v217 offset:24576
    v_mfma_f32_16x16x32_bf16 v[152:155], v[172:175], v[56:59], v[152:155]
    ds_read_b64_tr_b16 v[186:187], v217 offset:25600
    s_add_u32 m0, s58, 17408
    s_nop 0
    buffer_load_dwordx4 v5, s[4:7], s2 offen lds
    s_waitcnt lgkmcnt(6)
    v_mfma_f32_16x16x32_bf16 v[156:159], v[176:179], v[52:55], v[156:159]
    ds_read_b64_tr_b16 v[188:189], v218 offset:24576
    v_mfma_f32_16x16x32_bf16 v[160:163], v[176:179], v[56:59], v[160:163]
    ds_read_b64_tr_b16 v[190:191], v218 offset:25600
    v_mfma_f32_16x16x32_bf16 v[196:199], v[164:167], v[16:19], v[196:199]
    ds_read_b64_tr_b16 v[192:193], v219 offset:24576
    s_and_b32 s52, s61, 7
    s_lshl_b32 s52, s52, 7
    s_add_u32 s52, s52, 4096
    v_lshlrev_b32 v248, 2, v1
    buffer_load_dword v248, v248, s[8:11], s52 offen sc1
    v_mfma_f32_16x16x32_bf16 v[200:203], v[16:19], v[52:55], v[200:203]
    ds_read_b64_tr_b16 v[194:195], v219 offset:25600
    v_mfma_f32_16x16x32_bf16 v[204:207], v[52:55], v[52:55], v[204:207]
    s_waitcnt vmcnt(5)
    s_barrier
    s_waitcnt lgkmcnt(7)
    v_mfma_f32_16x16x32_bf16 v[132:135], v[180:183], v[60:63], v[132:135]
    ds_read_b128 v[68:71], v12 offset:0
    s_waitcnt lgkmcnt(7)
    v_mfma_f32_16x16x32_bf16 v[136:139], v[180:183], v[64:67], v[136:139]
    ds_read_b64_tr_b16 v[164:165], v216 offset:32768
    s_waitcnt lgkmcnt(6)
    v_mfma_f32_16x16x32_bf16 v[140:143], v[184:187], v[60:63], v[140:143]
    ds_read_b64_tr_b16 v[166:167], v216 offset:33792
    v_mfma_f32_16x16x32_bf16 v[144:147], v[184:187], v[64:67], v[144:147]
    ds_read_b128 v[72:75], v12 offset:2048
    s_mul_i32 s2, s75, 4294049792
    s_add_u32 s2, s2, 1376256
    s_add_u32 m0, s58, 65536
    s_nop 0
    buffer_load_dwordx4 v6, s[12:15], s2 offen lds
    s_waitcnt lgkmcnt(6)
    v_mfma_f32_16x16x32_bf16 v[148:151], v[188:191], v[60:63], v[148:151]
    ds_read_b64_tr_b16 v[168:169], v217 offset:32768
    v_mfma_f32_16x16x32_bf16 v[152:155], v[188:191], v[64:67], v[152:155]
    ds_read_b64_tr_b16 v[170:171], v217 offset:33792
    s_waitcnt lgkmcnt(6)
    v_mfma_f32_16x16x32_bf16 v[156:159], v[192:195], v[60:63], v[156:159]
    ds_read_b64_tr_b16 v[172:173], v218 offset:32768
    v_mfma_f32_16x16x32_bf16 v[160:163], v[192:195], v[64:67], v[160:163]
    ds_read_b64_tr_b16 v[174:175], v218 offset:33792
    s_add_u32 s2, s2, 14336
    s_add_u32 m0, s58, 66560
    s_nop 0
    buffer_load_dwordx4 v6, s[12:15], s2 offen lds
    v_mfma_f32_16x16x32_bf16 v[196:199], v[180:183], v[16:19], v[196:199]
    ds_read_b64_tr_b16 v[176:177], v219 offset:32768
    v_mfma_f32_16x16x32_bf16 v[200:203], v[16:19], v[60:63], v[200:203]
    ds_read_b64_tr_b16 v[178:179], v219 offset:33792
    v_mfma_f32_16x16x32_bf16 v[204:207], v[60:63], v[60:63], v[204:207]
    s_waitcnt lgkmcnt(7)
    v_mfma_f32_16x16x32_bf16 v[132:135], v[164:167], v[68:71], v[132:135]
    ds_read_b128 v[76:79], v13 offset:0
    s_waitcnt lgkmcnt(7)
    v_mfma_f32_16x16x32_bf16 v[136:139], v[164:167], v[72:75], v[136:139]
    ds_read_b64_tr_b16 v[180:181], v216 offset:40960
    s_waitcnt lgkmcnt(6)
    v_mfma_f32_16x16x32_bf16 v[140:143], v[168:171], v[68:71], v[140:143]
    ds_read_b64_tr_b16 v[182:183], v216 offset:41984
    v_mfma_f32_16x16x32_bf16 v[144:147], v[168:171], v[72:75], v[144:147]
    ds_read_b128 v[80:83], v13 offset:2048
    s_mul_i32 s2, s75, 4294966784
    s_add_u32 s2, s2, 640
    s_add_u32 m0, s58, 32768
    s_nop 0
    buffer_load_dwordx4 v4, s[4:7], s2 offen lds
    s_waitcnt lgkmcnt(6)
    v_mfma_f32_16x16x32_bf16 v[148:151], v[172:175], v[68:71], v[148:151]
    ds_read_b64_tr_b16 v[184:185], v217 offset:40960
    v_mfma_f32_16x16x32_bf16 v[152:155], v[172:175], v[72:75], v[152:155]
    ds_read_b64_tr_b16 v[186:187], v217 offset:41984
    s_waitcnt lgkmcnt(6)
    v_mfma_f32_16x16x32_bf16 v[156:159], v[176:179], v[68:71], v[156:159]
    ds_read_b64_tr_b16 v[188:189], v218 offset:40960
    v_mfma_f32_16x16x32_bf16 v[160:163], v[176:179], v[72:75], v[160:163]
    ds_read_b64_tr_b16 v[190:191], v218 offset:41984
    s_add_u32 m0, s58, 33792
    s_nop 0
    buffer_load_dwordx4 v5, s[4:7], s2 offen lds
    v_mfma_f32_16x16x32_bf16 v[196:199], v[164:167], v[16:19], v[196:199]
    ds_read_b64_tr_b16 v[192:193], v219 offset:40960
    v_mfma_f32_16x16x32_bf16 v[200:203], v[16:19], v[68:71], v[200:203]
    ds_read_b64_tr_b16 v[194:195], v219 offset:41984
    v_mfma_f32_16x16x32_bf16 v[204:207], v[68:71], v[68:71], v[204:207]
    s_waitcnt vmcnt(5)
    s_barrier
    s_waitcnt lgkmcnt(7)
    v_mfma_f32_16x16x32_bf16 v[132:135], v[180:183], v[76:79], v[132:135]
    ds_read_b128 v[84:87], v12 offset:16384
    s_waitcnt lgkmcnt(7)
    v_mfma_f32_16x16x32_bf16 v[136:139], v[180:183], v[80:83], v[136:139]
    ds_read_b64_tr_b16 v[164:165], v216 offset:49152
    s_waitcnt lgkmcnt(6)
    v_mfma_f32_16x16x32_bf16 v[140:143], v[184:187], v[76:79], v[140:143]
    ds_read_b64_tr_b16 v[166:167], v216 offset:50176
    v_mfma_f32_16x16x32_bf16 v[144:147], v[184:187], v[80:83], v[144:147]
    ds_read_b128 v[88:91], v12 offset:18432
    s_waitcnt lgkmcnt(6)
    v_mfma_f32_16x16x32_bf16 v[148:151], v[188:191], v[76:79], v[148:151]
    ds_read_b64_tr_b16 v[168:169], v217 offset:49152
    v_mfma_f32_16x16x32_bf16 v[152:155], v[188:191], v[80:83], v[152:155]
    ds_read_b64_tr_b16 v[170:171], v217 offset:50176
    s_waitcnt lgkmcnt(6)
    v_mfma_f32_16x16x32_bf16 v[156:159], v[192:195], v[76:79], v[156:159]
    ds_read_b64_tr_b16 v[172:173], v218 offset:49152
    v_mfma_f32_16x16x32_bf16 v[160:163], v[192:195], v[80:83], v[160:163]
    ds_read_b64_tr_b16 v[174:175], v218 offset:50176
    v_mfma_f32_16x16x32_bf16 v[196:199], v[180:183], v[16:19], v[196:199]
    ds_read_b64_tr_b16 v[176:177], v219 offset:49152
    v_mfma_f32_16x16x32_bf16 v[200:203], v[16:19], v[76:79], v[200:203]
    ds_read_b64_tr_b16 v[178:179], v219 offset:50176
    v_mfma_f32_16x16x32_bf16 v[204:207], v[76:79], v[76:79], v[204:207]
    s_waitcnt lgkmcnt(7)
    v_mfma_f32_16x16x32_bf16 v[132:135], v[164:167], v[84:87], v[132:135]
    ds_read_b128 v[92:95], v13 offset:16384
    s_waitcnt lgkmcnt(7)
    v_mfma_f32_16x16x32_bf16 v[136:139], v[164:167], v[88:91], v[136:139]
    ds_read_b64_tr_b16 v[180:181], v216 offset:57344
    s_waitcnt lgkmcnt(6)
    v_mfma_f32_16x16x32_bf16 v[140:143], v[168:171], v[84:87], v[140:143]
    ds_read_b64_tr_b16 v[182:183], v216 offset:58368
    v_mfma_f32_16x16x32_bf16 v[144:147], v[168:171], v[88:91], v[144:147]
    ds_read_b128 v[96:99], v13 offset:18432
    s_mul_i32 s2, s75, 4294966784
    s_add_u32 s2, s2, 768
    s_add_u32 m0, s58, 0
    s_nop 0
    buffer_load_dwordx4 v4, s[4:7], s2 offen lds
    s_waitcnt lgkmcnt(6)
    v_mfma_f32_16x16x32_bf16 v[148:151], v[172:175], v[84:87], v[148:151]
    ds_read_b64_tr_b16 v[184:185], v217 offset:57344
    v_mfma_f32_16x16x32_bf16 v[152:155], v[172:175], v[88:91], v[152:155]
    ds_read_b64_tr_b16 v[186:187], v217 offset:58368
    s_waitcnt lgkmcnt(6)
    v_mfma_f32_16x16x32_bf16 v[156:159], v[176:179], v[84:87], v[156:159]
    ds_read_b64_tr_b16 v[188:189], v218 offset:57344
    v_mfma_f32_16x16x32_bf16 v[160:163], v[176:179], v[88:91], v[160:163]
    ds_read_b64_tr_b16 v[190:191], v218 offset:58368
    s_add_u32 m0, s58, 1024
    s_nop 0
    buffer_load_dwordx4 v5, s[4:7], s2 offen lds
    v_mfma_f32_16x16x32_bf16 v[196:199], v[164:167], v[16:19], v[196:199]
    ds_read_b64_tr_b16 v[192:193], v219 offset:57344
    v_mfma_f32_16x16x32_bf16 v[200:203], v[16:19], v[84:87], v[200:203]
    ds_read_b64_tr_b16 v[194:195], v219 offset:58368
    v_mfma_f32_16x16x32_bf16 v[204:207], v[84:87], v[84:87], v[204:207]
    s_waitcnt vmcnt(6)
    v_subrev_u32 v239, s48, v248
    s_mov_b32 s70, 0
L_modep_3:
    s_mov_b32 exec_hi, 0
    v_cmp_le_u32 vcc, 16, v239
    s_nop 4
    s_cmp_eq_u64 vcc, 0
    s_cbranch_scc1 L_modeok_4
    s_add_u32 s70, s70, 1
    s_cmp_ge_u32 s70, 4000
    s_cbranch_scc1 L_modeok_4
    s_and_b32 s52, s61, 7
    s_lshl_b32 s52, s52, 7
    s_add_u32 s52, s52, 4096
    v_lshlrev_b32 v239, 2, v1
    buffer_load_dword v239, v239, s[8:11], s52 offen sc1
    s_waitcnt vmcnt(0)
    v_subrev_u32 v239, s48, v239
    s_branch L_modep_3
L_modeok_4:
    v_cmp_ne_u32 vcc, s71, v239
    s_nop 4
    s_cmp_eq_u64 vcc, 0
    s_cselect_b32 s49, 1, 0
    s_mov_b64 exec, -1
    s_waitcnt vmcnt(2)
    s_barrier
    s_waitcnt lgkmcnt(7)
    v_mfma_f32_16x16x32_bf16 v[132:135], v[180:183], v[92:95], v[132:135]
    ds_read_b128 v[100:103], v12 offset:32768
    s_waitcnt lgkmcnt(7)
    v_mfma_f32_16x16x32_bf16 v[136:139], v[180:183], v[96:99], v[136:139]
    ds_read_b64_tr_b16 v[164:165], v8 offset:49152
    s_waitcnt lgkmcnt(6)
    v_mfma_f32_16x16x32_bf16 v[140:143], v[184:187], v[92:95], v[140:143]
    ds_read_b64_tr_b16 v[166:167], v8 offset:50176
    v_mfma_f32_16x16x32_bf16 v[144:147], v[184:187], v[96:99], v[144:147]
    ds_read_b128 v[104:107], v12 offset:34816
    s_waitcnt lgkmcnt(6)
    v_mfma_f32_16x16x32_bf16 v[148:151], v[188:191], v[92:95], v[148:151]
    ds_read_b64_tr_b16 v[168:169], v9 offset:49152
    v_mfma_f32_16x16x32_bf16 v[152:155], v[188:191], v[96:99], v[152:155]
    ds_read_b64_tr_b16 v[170:171], v9 offset:50176
    s_waitcnt lgkmcnt(6)
    v_mfma_f32_16x16x32_bf16 v[156:159], v[192:195], v[92:95], v[156:159]
    ds_read_b64_tr_b16 v[172:173], v10 offset:49152
    v_mfma_f32_16x16x32_bf16 v[160:163], v[192:195], v[96:99], v[160:163]
    ds_read_b64_tr_b16 v[174:175], v10 offset:50176
    v_mfma_f32_16x16x32_bf16 v[196:199], v[180:183], v[16:19], v[196:199]
    ds_read_b64_tr_b16 v[176:177], v11 offset:49152
    v_mfma_f32_16x16x32_bf16 v[200:203], v[16:19], v[92:95], v[200:203]
    ds_read_b64_tr_b16 v[178:179], v11 offset:50176
    v_mfma_f32_16x16x32_bf16 v[204:207], v[92:95], v[92:95], v[204:207]
    s_waitcnt lgkmcnt(7)
    v_mfma_f32_16x16x32_bf16 v[132:135], v[164:167], v[100:103], v[132:135]
    ds_read_b128 v[108:111], v13 offset:32768
    s_waitcnt lgkmcnt(7)
    v_mfma_f32_16x16x32_bf16 v[136:139], v[164:167], v[104:107], v[136:139]
    ds_read_b64_tr_b16 v[180:181], v8 offset:57344
    s_waitcnt lgkmcnt(6)
    v_mfma_f32_16x16x32_bf16 v[140:143], v[168:171], v[100:103], v[140:143]
    ds_read_b64_tr_b16 v[182:183], v8 offset:58368
    v_mfma_f32_16x16x32_bf16 v[144:147], v[168:171], v[104:107], v[144:147]
    ds_read_b128 v[112:115], v13 offset:34816
    s_waitcnt lgkmcnt(6)
    v_mfma_f32_16x16x32_bf16 v[148:151], v[172:175], v[100:103], v[148:151]
    ds_read_b64_tr_b16 v[184:185], v9 offset:57344
    v_mfma_f32_16x16x32_bf16 v[152:155], v[172:175], v[104:107], v[152:155]
    ds_read_b64_tr_b16 v[186:187], v9 offset:58368
    s_waitcnt lgkmcnt(6)
    v_mfma_f32_16x16x32_bf16 v[156:159], v[176:179], v[100:103], v[156:159]
    ds_read_b64_tr_b16 v[188:189], v10 offset:57344
    v_mfma_f32_16x16x32_bf16 v[160:163], v[176:179], v[104:107], v[160:163]
    ds_read_b64_tr_b16 v[190:191], v10 offset:58368
    v_mfma_f32_16x16x32_bf16 v[196:199], v[164:167], v[16:19], v[196:199]
    ds_read_b64_tr_b16 v[192:193], v11 offset:57344
    v_mfma_f32_16x16x32_bf16 v[200:203], v[16:19], v[100:103], v[200:203]
    ds_read_b64_tr_b16 v[194:195], v11 offset:58368
    v_mfma_f32_16x16x32_bf16 v[204:207], v[100:103], v[100:103], v[204:207]
    s_cmp_lg_u32 s45, 0
    s_cbranch_scc1 L_nw_5
    v_lshlrev_b32 v222, 4, v3
    v_add_u32 v222, s47, v222
    v_mul_u32_u24 v222, 21846, v222
    v_lshrrev_b32 v222, 16, v222
    v_lshlrev_b32 v222, 7, v222
    v_lshl_add_u32 v222, v2, 2, v222
    s_mov_b32 s52, 8192
    s_mov_b32 exec_lo, 1073692671
    s_mov_b32 exec_hi, 16383
    s_mov_b32 s70, 0
L_poll_6:
    buffer_load_dword v254, v222, s[8:11], s52 offen sc1
    s_waitcnt vmcnt(0)
    v_cmp_ne_u32 vcc, s48, v254
    s_nop 4
    s_cmp_eq_u64 vcc, 0
    s_cbranch_scc1 L_polld_7
    s_add_u32 s70, s70, 1
    s_cmp_lt_u32 s70, 4000
    s_cbranch_scc1 L_poll_6
L_polld_7:
    s_mov_b64 exec, -1
L_nw_5:
    s_waitcnt vmcnt(0)
    s_barrier
    s_lshr_b32 s53, s44, 1
    s_mul_i32 s52, s53, 14336
    s_mul_i32 s56, s47, 86016
    s_add_u32 s56, s56, s52
    s_add_u32 s56, s56, 262144
    s_add_u32 s52, s52, 81920
    s_cmp_eq_u32 s53, 3
    s_cselect_b32 s52, 16384, s52
    s_and_b32 s53, s44, 1
    s_mul_i32 s53, s53, 7
    s_lshl_b32 s55, s53, 10
    s_add_u32 s55, s55, s52
    s_mul_i32 s54, s75, 6
    s_add_u32 s54, s54, s53
    s_waitcnt lgkmcnt(7)
    v_mfma_f32_16x16x32_bf16 v[132:135], v[180:183], v[108:111], v[132:135]
    ds_read_b128 v[116:119], v12 offset:0
    s_waitcnt lgkmcnt(7)
    v_mfma_f32_16x16x32_bf16 v[136:139], v[180:183], v[112:115], v[136:139]
    ds_read_b64_tr_b16 v[164:165], v216 offset:0
    s_waitcnt lgkmcnt(6)
    v_mfma_f32_16x16x32_bf16 v[140:143], v[184:187], v[108:111], v[140:143]
    ds_read_b64_tr_b16 v[166:167], v216 offset:1024
    s_add_u32 s2, s54, 0
    s_cmp_ge_u32 s2, 14
    s_cselect_b32 s57, 14, 0
    s_sub_u32 s2, s2, s57
    s_lshl_b32 s2, s2, 10
    s_add_u32 s2, s2, s56
    s_add_u32 m0, s55, 0
    s_nop 0
    buffer_load_dwordx4 v7, s[8:11], s2 offen sc1 lds
    v_mfma_f32_16x16x32_bf16 v[144:147], v[184:187], v[112:115], v[144:147]
    ds_read_b128 v[120:123], v12 offset:2048
    s_waitcnt lgkmcnt(6)
    v_mfma_f32_16x16x32_bf16 v[148:151], v[188:191], v[108:111], v[148:151]
    ds_read_b64_tr_b16 v[168:169], v217 offset:0
    v_mfma_f32_16x16x32_bf16 v[152:155], v[188:191], v[112:115], v[152:155]
    ds_read_b64_tr_b16 v[170:171], v217 offset:1024
    s_add_u32 s2, s54, 1
    s_cmp_ge_u32 s2, 14
    s_cselect_b32 s57, 14, 0
    s_sub_u32 s2, s2, s57
    s_lshl_b32 s2, s2, 10
    s_add_u32 s2, s2, s56
    s_add_u32 m0, s55, 1024
    s_nop 0
    buffer_load_dwordx4 v7, s[8:11], s2 offen sc1 lds
    s_waitcnt lgkmcnt(6)
    v_mfma_f32_16x16x32_bf16 v[156:159], v[192:195], v[108:111], v[156:159]
    ds_read_b64_tr_b16 v[172:173], v218 offset:0
    v_mfma_f32_16x16x32_bf16 v[160:163], v[192:195], v[112:115], v[160:163]
    ds_read_b64_tr_b16 v[174:175], v218 offset:1024
    v_mfma_f32_16x16x32_bf16 v[196:199], v[180:183], v[16:19], v[196:199]
    ds_read_b64_tr_b16 v[176:177], v219 offset:0
    s_add_u32 s2, s54, 2
    s_cmp_ge_u32 s2, 14
    s_cselect_b32 s57, 14, 0
    s_sub_u32 s2, s2, s57
    s_lshl_b32 s2, s2, 10
    s_add_u32 s2, s2, s56
    s_add_u32 m0, s55, 2048
    s_nop 0
    buffer_load_dwordx4 v7, s[8:11], s2 offen sc1 lds
    v_mfma_f32_16x16x32_bf16 v[200:203], v[16:19], v[108:111], v[200:203]
    ds_read_b64_tr_b16 v[178:179], v219 offset:1024
    v_mfma_f32_16x16x32_bf16 v[204:207], v[108:111], v[108:111], v[204:207]
    s_waitcnt lgkmcnt(7)
    v_mfma_f32_16x16x32_bf16 v[132:135], v[164:167], v[116:119], v[132:135]
    ds_read_b128 v[124:127], v13 offset:0
    s_waitcnt lgkmcnt(7)
    v_mfma_f32_16x16x32_bf16 v[136:139], v[164:167], v[120:123], v[136:139]
    ds_read_b64_tr_b16 v[180:181], v216 offset:8192
    s_waitcnt lgkmcnt(6)
    v_mfma_f32_16x16x32_bf16 v[140:143], v[168:171], v[116:119], v[140:143]
    ds_read_b64_tr_b16 v[182:183], v216 offset:9216
    v_mfma_f32_16x16x32_bf16 v[144:147], v[168:171], v[120:123], v[144:147]
    ds_read_b128 v[128:131], v13 offset:2048
    s_add_u32 s2, s54, 3
    s_cmp_ge_u32 s2, 14
    s_cselect_b32 s57, 14, 0
    s_sub_u32 s2, s2, s57
    s_lshl_b32 s2, s2, 10
    s_add_u32 s2, s2, s56
    s_add_u32 m0, s55, 3072
    s_nop 0
    buffer_load_dwordx4 v7, s[8:11], s2 offen sc1 lds
    s_waitcnt lgkmcnt(6)
    v_mfma_f32_16x16x32_bf16 v[148:151], v[172:175], v[116:119], v[148:151]
    ds_read_b64_tr_b16 v[184:185], v217 offset:8192
    v_mfma_f32_16x16x32_bf16 v[152:155], v[172:175], v[120:123], v[152:155]
    ds_read_b64_tr_b16 v[186:187], v217 offset:9216
    s_waitcnt lgkmcnt(6)
    v_mfma_f32_16x16x32_bf16 v[156:159], v[176:179], v[116:119], v[156:159]
    ds_read_b64_tr_b16 v[188:189], v218 offset:8192
    v_mfma_f32_16x16x32_bf16 v[160:163], v[176:179], v[120:123], v[160:163]
    ds_read_b64_tr_b16 v[190:191], v218 offset:9216
    s_add_u32 s2, s54, 4
    s_cmp_ge_u32 s2, 14
    s_cselect_b32 s57, 14, 0
    s_sub_u32 s2, s2, s57
    s_lshl_b32 s2, s2, 10
    s_add_u32 s2, s2, s56
    s_add_u32 m0, s55, 4096
    s_nop 0
    buffer_load_dwordx4 v7, s[8:11], s2 offen sc1 lds
    v_mfma_f32_16x16x32_bf16 v[196:199], v[164:167], v[16:19], v[196:199]
    ds_read_b64_tr_b16 v[192:193], v219 offset:8192
    v_mfma_f32_16x16x32_bf16 v[200:203], v[16:19], v[116:119], v[200:203]
    ds_read_b64_tr_b16 v[194:195], v219 offset:9216
    v_mfma_f32_16x16x32_bf16 v[204:207], v[116:119], v[116:119], v[204:207]
    s_waitcnt lgkmcnt(7)
    v_mfma_f32_16x16x32_bf16 v[132:135], v[180:183], v[124:127], v[132:135]
    s_waitcnt lgkmcnt(6)
    v_mfma_f32_16x16x32_bf16 v[136:139], v[180:183], v[128:131], v[136:139]
    s_waitcnt lgkmcnt(4)
    v_mfma_f32_16x16x32_bf16 v[140:143], v[184:187], v[124:127], v[140:143]
    s_add_u32 s2, s54, 5
    s_cmp_ge_u32 s2, 14
    s_cselect_b32 s57, 14, 0
    s_sub_u32 s2, s2, s57
    s_lshl_b32 s2, s2, 10
    s_add_u32 s2, s2, s56
    s_add_u32 m0, s55, 5120
    s_nop 0
    buffer_load_dwordx4 v7, s[8:11], s2 offen sc1 lds
    v_mfma_f32_16x16x32_bf16 v[144:147], v[184:187], v[128:131], v[144:147]
    s_waitcnt lgkmcnt(2)
    v_mfma_f32_16x16x32_bf16 v[148:151], v[188:191], v[124:127], v[148:151]
    v_mfma_f32_16x16x32_bf16 v[152:155], v[188:191], v[128:131], v[152:155]
    s_add_u32 s2, s54, 6
    s_cmp_ge_u32 s2, 14
    s_cselect_b32 s57, 14, 0
    s_sub_u32 s2, s2, s57
    s_lshl_b32 s2, s2, 10
    s_add_u32 s2, s2, s56
    s_add_u32 m0, s55, 6144
    s_nop 0
    buffer_load_dwordx4 v7, s[8:11], s2 offen sc1 lds
    s_waitcnt lgkmcnt(0)
    v_mfma_f32_16x16x32_bf16 v[156:159], v[192:195], v[124:127], v[156:159]
    v_mfma_f32_16x16x32_bf16 v[160:163], v[192:195], v[128:131], v[160:163]
    v_mfma_f32_16x16x32_bf16 v[196:199], v[180:183], v[16:19], v[196:199]
    v_lshlrev_b32 v238, 3, v3
    s_xor_b32 s52, s45, 0
    s_lshl_b32 s52, s52, 5
    s_lshl_b32 s53, s47, 8
    s_add_u32 s52, s52, s53
    buffer_load_dwordx2 v[8:9], v238, s[36:39], s52 offen offset:0
    s_xor_b32 s52, s45, 1
    s_lshl_b32 s52, s52, 5
    s_lshl_b32 s53, s47, 8
    s_add_u32 s52, s52, s53
    buffer_load_dwordx2 v[10:11], v238, s[36:39], s52 offen offset:0
    s_xor_b32 s52, s45, 2
    s_lshl_b32 s52, s52, 5
    s_lshl_b32 s53, s47, 8
    s_add_u32 s52, s52, s53
    buffer_load_dwordx2 v[12:13], v238, s[36:39], s52 offen offset:0
    s_xor_b32 s52, s45, 3
    s_lshl_b32 s52, s52, 5
    s_lshl_b32 s53, s47, 8
    s_add_u32 s52, s52, s53
    buffer_load_dwordx2 v[4:5], v238, s[36:39], s52 offen offset:0
    v_mfma_f32_16x16x32_bf16 v[200:203], v[16:19], v[124:127], v[200:203]
    v_mfma_f32_16x16x32_bf16 v[204:207], v[124:127], v[124:127], v[204:207]
    v_and_b32 v222, 3, v2
    v_cmp_eq_u32 s[78:79], 1, v222
    v_cmp_eq_u32 s[80:81], 2, v222
    v_cmp_eq_u32 s[82:83], 3, v222
    v_lshrrev_b32 v223, 2, v2
    v_cmp_eq_u32 s[72:73], v223, v3
    s_lshl_b32 s52, s45, 7
    s_add_u32 s52, s52, 147456
    v_lshl_add_u32 v226, v2, 2, s52
    v_mul_f32 v225, 0x3b124925, v200
    v_cndmask_b32 v224, v204, v205, s[78:79]
    v_cndmask_b32 v224, v224, v206, s[80:81]
    v_cndmask_b32 v224, v224, v207, s[82:83]
    v_mul_f32 v224, 0x3b124925, v224
    v_fma_f32 v224, -v225, v225, v224
    v_max_f32 v224, 0, v224
    v_add_f32 v224, 0x3727c5ac, v224
    v_rsq_f32 v224, v224
    s_nop 0
    v_mul_f32 v225, v225, v224
    v_sub_f32 v225, 0, v225
    s_mov_b64 exec, s[72:73]
    ds_write_b32 v226, v224
    ds_write_b32 v226, v225 offset:512
    s_mov_b64 exec, -1
    s_lshl_b32 s52, s45, 6
    s_add_u32 s52, s52, 157696
    v_lshlrev_b32 v226, 4, v3
    v_add_u32 v226, s52, v226
    v_cmp_eq_u32 vcc, 0, v2
    s_nop 1
    s_mov_b64 exec, vcc
    ds_write_b128 v226, v[196:199]
    s_mov_b64 exec, -1
    s_waitcnt vmcnt(4)
    s_waitcnt lgkmcnt(0)
    s_barrier
    s_lshl_b32 s52, s45, 7
    s_add_u32 s52, s52, 147456
    v_lshl_add_u32 v220, v2, 2, s52
    ds_read_b32 v200, v220 offset:0
    ds_read_b32 v202, v220 offset:512
    ds_read_b32 v201, v220 offset:64
    ds_read_b32 v203, v220 offset:576
    s_mul_i32 s52, s45, 14336
    s_add_u32 s52, s52, 81920
    s_cmp_eq_u32 s45, 3
    s_cselect_b32 s52, 16384, s52
    v_add_u32 v221, s52, v7
    s_lshr_b32 s52, s44, 2
    s_mul_i32 s52, s52, 14336
    s_mul_i32 s56, s47, 86016
    s_add_u32 s56, s56, s52
    s_add_u32 s56, s56, 319488
    s_lshl_b32 s53, s45, 2
    s_lshl_b32 s55, s53, 10
    s_add_u32 s55, s55, s52
    s_mul_i32 s54, s75, 6
    s_add_u32 s54, s54, s53
    v_add_u32 v220, 81920, v7
    v_add_u32 v251, 96256, v7
    v_mov_b32 v204, 0
    v_mov_b32 v205, 0
    v_mov_b32 v206, 0
    v_mov_b32 v207, 0
    v_mov_b32 v208, 0
    v_mov_b32 v209, 0
    v_mov_b32 v210, 0
    v_mov_b32 v211, 0
    v_mov_b32 v212, 0
    v_mov_b32 v213, 0
    v_mov_b32 v214, 0
    v_mov_b32 v215, 0
    v_mov_b32 v216, 0
    v_mov_b32 v217, 0
    v_mov_b32 v218, 0
    v_mov_b32 v219, 0
    v_mov_b32 v196, 0
    v_mov_b32 v197, 0
    v_mov_b32 v198, 0
    v_mov_b32 v199, 0
    ds_read_b128 v[164:167], v220 offset:0
    ds_read_b128 v[168:171], v251 offset:0
    ds_read_b128 v[188:191], v221 offset:0
    ds_read_b128 v[172:175], v220 offset:1024
    ds_read_b128 v[176:179], v251 offset:1024
    s_waitcnt lgkmcnt(4)
    v_mfma_f32_16x16x32_bf16 v[204:207], v[164:167], v[20:23], v[204:207]
    ds_read_b128 v[180:183], v220 offset:2048
    v_mfma_f32_16x16x32_bf16 v[208:211], v[164:167], v[24:27], v[208:211]
    ds_read_b128 v[184:187], v251 offset:2048
    s_add_u32 s2, s54, 0
    s_cmp_ge_u32 s2, 14
    s_cselect_b32 s57, 14, 0
    s_sub_u32 s2, s2, s57
    s_lshl_b32 s2, s2, 10
    s_add_u32 s2, s2, s56
    s_add_u32 m0, s55, 49152
    s_nop 0
    buffer_load_dwordx4 v7, s[8:11], s2 offen sc1 lds
    s_waitcnt lgkmcnt(5)
    v_mfma_f32_16x16x32_bf16 v[212:215], v[168:171], v[20:23], v[212:215]
    ds_read_b128 v[192:195], v221 offset:1024
    v_mfma_f32_16x16x32_bf16 v[216:219], v[168:171], v[24:27], v[216:219]
    s_add_u32 s2, s54, 1
    s_cmp_ge_u32 s2, 14
    s_cselect_b32 s57, 14, 0
    s_sub_u32 s2, s2, s57
    s_lshl_b32 s2, s2, 10
    s_add_u32 s2, s2, s56
    s_add_u32 m0, s55, 50176
    s_nop 0
    buffer_load_dwordx4 v7, s[8:11], s2 offen sc1 lds
    s_waitcnt lgkmcnt(5)
    v_mfma_f32_16x16x32_bf16 v[196:199], v[188:191], v[16:19], v[196:199]
    s_waitcnt lgkmcnt(4)
    v_mfma_f32_16x16x32_bf16 v[204:207], v[172:175], v[28:31], v[204:207]
    ds_read_b128 v[164:167], v220 offset:3072
    v_mfma_f32_16x16x32_bf16 v[208:211], v[172:175], v[32:35], v[208:211]
    ds_read_b128 v[168:171], v251 offset:3072
    s_add_u32 s2, s54, 2
    s_cmp_ge_u32 s2, 14
    s_cselect_b32 s57, 14, 0
    s_sub_u32 s2, s2, s57
    s_lshl_b32 s2, s2, 10
    s_add_u32 s2, s2, s56
    s_add_u32 s57, s55, 51200
    s_cmp_eq_u32 s45, 3
    s_cselect_b32 m0, 80896, s57
    s_nop 0
    buffer_load_dwordx4 v7, s[8:11], s2 offen sc1 lds
    s_waitcnt lgkmcnt(5)
    v_mfma_f32_16x16x32_bf16 v[212:215], v[176:179], v[28:31], v[212:215]
    s_add_u32 s2, s54, 3
    s_cmp_ge_u32 s2, 14
    s_cselect_b32 s57, 14, 0
    s_sub_u32 s2, s2, s57
    s_lshl_b32 s2, s2, 10
    s_add_u32 s2, s2, s56
    s_add_u32 s57, s55, 52224
    s_cmp_eq_u32 s45, 3
    s_cselect_b32 m0, 80896, s57
    s_nop 0
    buffer_load_dwordx4 v7, s[8:11], s2 offen sc1 lds
    v_mfma_f32_16x16x32_bf16 v[216:219], v[176:179], v[32:35], v[216:219]
    s_waitcnt lgkmcnt(4)
    v_mfma_f32_16x16x32_bf16 v[204:207], v[180:183], v[36:39], v[204:207]
    ds_read_b128 v[172:175], v220 offset:4096
    v_mfma_f32_16x16x32_bf16 v[208:211], v[180:183], v[40:43], v[208:211]
    ds_read_b128 v[176:179], v251 offset:4096
    s_xor_b32 s52, s45, 0
    s_lshl_b32 s52, s52, 6
    s_add_u32 s52, s52, 157696
    v_lshl_add_u32 v230, v3, 4, s52
    ds_read_b128 v[222:225], v230
    s_waitcnt lgkmcnt(6)
    v_mfma_f32_16x16x32_bf16 v[212:215], v[184:187], v[36:39], v[212:215]
    ds_read_b128 v[188:191], v221 offset:2048
    s_xor_b32 s52, s45, 1
    s_lshl_b32 s52, s52, 6
    s_add_u32 s52, s52, 157696
    v_lshl_add_u32 v230, v3, 4, s52
    ds_read_b128 v[226:229], v230
    v_mfma_f32_16x16x32_bf16 v[216:219], v[184:187], v[40:43], v[216:219]
    s_waitcnt vmcnt(7)
    v_lshlrev_b32 v240, 16, v8
    v_and_b32 v241, 0xffff0000, v8
    v_lshlrev_b32 v242, 16, v9
    v_and_b32 v243, 0xffff0000, v9
    s_waitcnt lgkmcnt(7)
    v_mfma_f32_16x16x32_bf16 v[196:199], v[192:195], v[16:19], v[196:199]
    s_waitcnt lgkmcnt(6)
    v_mfma_f32_16x16x32_bf16 v[204:207], v[164:167], v[44:47], v[204:207]
    ds_read_b128 v[180:183], v220 offset:5120
    v_mfma_f32_16x16x32_bf16 v[208:211], v[164:167], v[48:51], v[208:211]
    ds_read_b128 v[184:187], v251 offset:5120
    s_waitcnt lgkmcnt(4)
    v_fma_f32 v230, v202, v222, v240
    v_fma_f32 v231, v202, v223, v241
    v_fma_f32 v132, v200, v132, v230
    v_fma_f32 v133, v200, v133, v231
    v_max_f32 v132, 0, v132
    v_max_f32 v133, 0, v133
    v_mul_f32 v132, v132, v132
    v_mul_f32 v133, v133, v133
    v_cvt_pk_bf16_f32 v232, v132, v133
    v_mfma_f32_16x16x32_bf16 v[212:215], v[168:171], v[44:47], v[212:215]
    v_fma_f32 v230, v202, v224, v242
    v_fma_f32 v231, v202, v225, v243
    v_fma_f32 v134, v200, v134, v230
    v_fma_f32 v135, v200, v135, v231
    v_max_f32 v134, 0, v134
    v_max_f32 v135, 0, v135
    v_mul_f32 v134, v134, v134
    v_mul_f32 v135, v135, v135
    v_cvt_pk_bf16_f32 v233, v134, v135
    v_mfma_f32_16x16x32_bf16 v[216:219], v[168:171], v[48:51], v[216:219]
    v_mfma_f32_16x16x32_bf16 v[204:207], v[172:175], v[52:55], v[204:207]
    ds_read_b128 v[164:167], v220 offset:6144
    v_mfma_f32_16x16x32_bf16 v[208:211], v[172:175], v[56:59], v[208:211]
    ds_read_b128 v[168:171], v251 offset:6144
    s_mul_i32 s2, s75, 401408
    s_add_u32 s2, s2, 0
    s_add_u32 s2, s2, s3
    s_add_u32 m0, s59, 0
    s_nop 0
    buffer_load_dwordx4 v252, s[16:19], s2 offen lds
    v_mfma_f32_16x16x32_bf16 v[212:215], v[176:179], v[52:55], v[212:215]
    ds_read_b128 v[192:195], v221 offset:3072
    v_fma_f32 v230, v203, v222, v240
    v_fma_f32 v231, v203, v223, v241
    v_fma_f32 v136, v201, v136, v230
    v_fma_f32 v137, v201, v137, v231
    v_max_f32 v136, 0, v136
    v_max_f32 v137, 0, v137
    v_mul_f32 v136, v136, v136
    v_mul_f32 v137, v137, v137
    v_cvt_pk_bf16_f32 v236, v136, v137
    v_mfma_f32_16x16x32_bf16 v[216:219], v[176:179], v[56:59], v[216:219]
    v_fma_f32 v230, v203, v224, v242
    v_fma_f32 v231, v203, v225, v243
    v_fma_f32 v138, v201, v138, v230
    v_fma_f32 v139, v201, v139, v231
    v_max_f32 v138, 0, v138
    v_max_f32 v139, 0, v139
    v_mul_f32 v138, v138, v138
    v_mul_f32 v139, v139, v139
    v_cvt_pk_bf16_f32 v237, v138, v139
    s_waitcnt lgkmcnt(6)
    v_mfma_f32_16x16x32_bf16 v[196:199], v[188:191], v[16:19], v[196:199]
    s_waitcnt lgkmcnt(4)
    v_mfma_f32_16x16x32_bf16 v[204:207], v[180:183], v[60:63], v[204:207]
    ds_read_b128 v[172:175], v220 offset:7168
    v_mfma_f32_16x16x32_bf16 v[208:211], v[180:183], v[64:67], v[208:211]
    ds_read_b128 v[176:179], v251 offset:7168
    s_xor_b32 s52, s45, 2
    s_lshl_b32 s52, s52, 6
    s_add_u32 s52, s52, 157696
    v_lshl_add_u32 v230, v3, 4, s52
    ds_read_b128 v[222:225], v230
    s_waitcnt lgkmcnt(6)
    v_mfma_f32_16x16x32_bf16 v[212:215], v[184:187], v[60:63], v[212:215]
    s_waitcnt vmcnt(7)
    v_lshlrev_b32 v240, 16, v10
    v_and_b32 v241, 0xffff0000, v10
    v_lshlrev_b32 v242, 16, v11
    v_and_b32 v243, 0xffff0000, v11
    v_mfma_f32_16x16x32_bf16 v[216:219], v[184:187], v[64:67], v[216:219]
    s_waitcnt lgkmcnt(5)
    v_mfma_f32_16x16x32_bf16 v[204:207], v[164:167], v[68:71], v[204:207]
    ds_read_b128 v[180:183], v220 offset:8192
    v_mfma_f32_16x16x32_bf16 v[208:211], v[164:167], v[72:75], v[208:211]
    ds_read_b128 v[184:187], v251 offset:8192
    v_fma_f32 v230, v202, v226, v240
    v_fma_f32 v231, v202, v227, v241
    v_fma_f32 v140, v200, v140, v230
    v_fma_f32 v141, v200, v141, v231
    v_max_f32 v140, 0, v140
    v_max_f32 v141, 0, v141
    v_mul_f32 v140, v140, v140
    v_mul_f32 v141, v141, v141
    v_cvt_pk_bf16_f32 v234, v140, v141
    s_waitcnt lgkmcnt(6)
    v_mfma_f32_16x16x32_bf16 v[212:215], v[168:171], v[68:71], v[212:215]
    ds_read_b128 v[188:191], v221 offset:4096
    s_mul_i32 s2, s75, 401408
    s_add_u32 s2, s2, 57344
    s_add_u32 s2, s2, s3
    s_add_u32 m0, s59, 8192
    s_nop 0
    buffer_load_dwordx4 v252, s[16:19], s2 offen lds
    v_mfma_f32_16x16x32_bf16 v[216:219], v[168:171], v[72:75], v[216:219]
    v_fma_f32 v230, v202, v228, v242
    v_fma_f32 v231, v202, v229, v243
    v_fma_f32 v142, v200, v142, v230
    v_fma_f32 v143, v200, v143, v231
    v_max_f32 v142, 0, v142
    v_max_f32 v143, 0, v143
    v_mul_f32 v142, v142, v142
    v_mul_f32 v143, v143, v143
    v_cvt_pk_bf16_f32 v235, v142, v143
    s_waitcnt lgkmcnt(6)
    v_mfma_f32_16x16x32_bf16 v[196:199], v[192:195], v[16:19], v[196:199]
    s_waitcnt lgkmcnt(5)
    v_mfma_f32_16x16x32_bf16 v[204:207], v[172:175], v[76:79], v[204:207]
    ds_read_b128 v[164:167], v220 offset:9216
    v_mfma_f32_16x16x32_bf16 v[208:211], v[172:175], v[80:83], v[208:211]
    ds_read_b128 v[168:171], v251 offset:9216
    v_fma_f32 v230, v203, v226, v240
    v_fma_f32 v231, v203, v227, v241
    v_fma_f32 v144, v201, v144, v230
    v_fma_f32 v145, v201, v145, v231
    v_max_f32 v144, 0, v144
    v_max_f32 v145, 0, v145
    v_mul_f32 v144, v144, v144
    v_mul_f32 v145, v145, v145
    v_cvt_pk_bf16_f32 v238, v144, v145
    s_waitcnt lgkmcnt(6)
    v_mfma_f32_16x16x32_bf16 v[212:215], v[176:179], v[76:79], v[212:215]
    v_fma_f32 v230, v203, v228, v242
    v_fma_f32 v231, v203, v229, v243
    v_fma_f32 v146, v201, v146, v230
    v_fma_f32 v147, v201, v147, v231
    v_max_f32 v146, 0, v146
    v_max_f32 v147, 0, v147
    v_mul_f32 v146, v146, v146
    v_mul_f32 v147, v147, v147
    v_cvt_pk_bf16_f32 v239, v146, v147
    v_mfma_f32_16x16x32_bf16 v[216:219], v[176:179], v[80:83], v[216:219]
    s_waitcnt lgkmcnt(4)
    v_mfma_f32_16x16x32_bf16 v[204:207], v[180:183], v[84:87], v[204:207]
    ds_read_b128 v[172:175], v220 offset:10240
    v_mfma_f32_16x16x32_bf16 v[208:211], v[180:183], v[88:91], v[208:211]
    ds_read_b128 v[176:179], v251 offset:10240
    s_xor_b32 s52, s45, 3
    s_lshl_b32 s52, s52, 6
    s_add_u32 s52, s52, 157696
    v_lshl_add_u32 v230, v3, 4, s52
    ds_read_b128 v[226:229], v230
    s_waitcnt lgkmcnt(6)
    v_mfma_f32_16x16x32_bf16 v[212:215], v[184:187], v[84:87], v[212:215]
    ds_read_b128 v[192:195], v221 offset:5120
    v_mfma_f32_16x16x32_bf16 v[216:219], v[184:187], v[88:91], v[216:219]
    s_bitcmp1_b32 s45, 0
    s_cbranch_scc0 L_noswap_8
    v_swap_b32 v232, v234
    v_swap_b32 v233, v235
    v_swap_b32 v236, v238
    v_swap_b32 v237, v239
L_noswap_8:
    s_mul_i32 s52, s46, 458752
    s_mul_i32 s57, s45, 114688
    s_add_u32 s52, s52, s57
    s_lshl_b32 s57, s47, 12
    s_add_u32 s52, s52, s57
    s_add_u32 s52, s52, 5242880
    s_lshr_b32 s53, s45, 1
    s_xor_b32 s53, s53, 0
    s_lshl_b32 s53, s53, 10
    s_add_u32 s52, s52, s53
    s_add_u32 s53, s52, 57344
    buffer_store_dwordx4 v[232:235], v7, s[8:11], s52 offen sc1
    buffer_store_dwordx4 v[236:239], v7, s[8:11], s53 offen sc1
    s_waitcnt lgkmcnt(6)
    v_mfma_f32_16x16x32_bf16 v[196:199], v[188:191], v[16:19], v[196:199]
    s_waitcnt lgkmcnt(5)
    v_mfma_f32_16x16x32_bf16 v[204:207], v[164:167], v[92:95], v[204:207]
    ds_read_b128 v[180:183], v220 offset:11264
    v_mfma_f32_16x16x32_bf16 v[208:211], v[164:167], v[96:99], v[208:211]
    ds_read_b128 v[184:187], v251 offset:11264
    s_mul_i32 s2, s75, 401408
    s_add_u32 s2, s2, 114688
    s_add_u32 s2, s2, s3
    s_add_u32 m0, s59, 32768
    s_nop 0
    buffer_load_dwordx4 v252, s[16:19], s2 offen lds
    s_waitcnt lgkmcnt(6)
    v_mfma_f32_16x16x32_bf16 v[212:215], v[168:171], v[92:95], v[212:215]
    s_waitcnt vmcnt(10)
    v_lshlrev_b32 v240, 16, v12
    v_and_b32 v241, 0xffff0000, v12
    v_lshlrev_b32 v242, 16, v13
    v_and_b32 v243, 0xffff0000, v13
    v_mfma_f32_16x16x32_bf16 v[216:219], v[168:171], v[96:99], v[216:219]
    v_fma_f32 v230, v202, v222, v240
    v_fma_f32 v231, v202, v223, v241
    v_fma_f32 v148, v200, v148, v230
    v_fma_f32 v149, v200, v149, v231
    v_max_f32 v148, 0, v148
    v_max_f32 v149, 0, v149
    v_mul_f32 v148, v148, v148
    v_mul_f32 v149, v149, v149
    v_cvt_pk_bf16_f32 v232, v148, v149
    s_waitcnt lgkmcnt(5)
    v_mfma_f32_16x16x32_bf16 v[204:207], v[172:175], v[100:103], v[204:207]
    ds_read_b128 v[164:167], v220 offset:12288
    v_mfma_f32_16x16x32_bf16 v[208:211], v[172:175], v[104:107], v[208:211]
    ds_read_b128 v[168:171], v251 offset:12288
    v_fma_f32 v230, v202, v224, v242
    v_fma_f32 v231, v202, v225, v243
    v_fma_f32 v150, v200, v150, v230
    v_fma_f32 v151, v200, v151, v231
    v_max_f32 v150, 0, v150
    v_max_f32 v151, 0, v151
    v_mul_f32 v150, v150, v150
    v_mul_f32 v151, v151, v151
    v_cvt_pk_bf16_f32 v233, v150, v151
    s_waitcnt lgkmcnt(6)
    v_mfma_f32_16x16x32_bf16 v[212:215], v[176:179], v[100:103], v[212:215]
    ds_read_b128 v[188:191], v221 offset:6144
    v_mfma_f32_16x16x32_bf16 v[216:219], v[176:179], v[104:107], v[216:219]
    v_fma_f32 v230, v203, v222, v240
    v_fma_f32 v231, v203, v223, v241
    v_fma_f32 v152, v201, v152, v230
    v_fma_f32 v153, v201, v153, v231
    v_max_f32 v152, 0, v152
    v_max_f32 v153, 0, v153
    v_mul_f32 v152, v152, v152
    v_mul_f32 v153, v153, v153
    v_cvt_pk_bf16_f32 v236, v152, v153
    s_waitcnt lgkmcnt(5)
    v_mfma_f32_16x16x32_bf16 v[196:199], v[192:195], v[16:19], v[196:199]
    s_waitcnt lgkmcnt(4)
    v_mfma_f32_16x16x32_bf16 v[204:207], v[180:183], v[108:111], v[204:207]
    ds_read_b128 v[172:175], v220 offset:13312
    v_mfma_f32_16x16x32_bf16 v[208:211], v[180:183], v[112:115], v[208:211]
    ds_read_b128 v[176:179], v251 offset:13312
    v_fma_f32 v230, v203, v224, v242
    v_fma_f32 v231, v203, v225, v243
    v_fma_f32 v154, v201, v154, v230
    v_fma_f32 v155, v201, v155, v231
    v_max_f32 v154, 0, v154
    v_max_f32 v155, 0, v155
    v_mul_f32 v154, v154, v154
    v_mul_f32 v155, v155, v155
    v_cvt_pk_bf16_f32 v237, v154, v155
    s_waitcnt lgkmcnt(5)
    v_mfma_f32_16x16x32_bf16 v[212:215], v[184:187], v[108:111], v[212:215]
    s_mul_i32 s2, s75, 401408
    s_add_u32 s2, s2, 172032
    s_add_u32 s2, s2, s3
    s_add_u32 m0, s59, 40960
    s_nop 0
    buffer_load_dwordx4 v252, s[16:19], s2 offen lds
    v_mfma_f32_16x16x32_bf16 v[216:219], v[184:187], v[112:115], v[216:219]
    s_waitcnt vmcnt(10)
    v_lshlrev_b32 v240, 16, v4
    v_and_b32 v241, 0xffff0000, v4
    v_lshlrev_b32 v242, 16, v5
    v_and_b32 v243, 0xffff0000, v5
    s_waitcnt lgkmcnt(4)
    v_mfma_f32_16x16x32_bf16 v[204:207], v[164:167], v[116:119], v[204:207]
    v_mfma_f32_16x16x32_bf16 v[208:211], v[164:167], v[120:123], v[208:211]
    v_fma_f32 v230, v202, v226, v240
    v_fma_f32 v231, v202, v227, v241
    v_fma_f32 v156, v200, v156, v230
    v_fma_f32 v157, v200, v157, v231
    v_max_f32 v156, 0, v156
    v_max_f32 v157, 0, v157
    v_mul_f32 v156, v156, v156
    v_mul_f32 v157, v157, v157
    v_cvt_pk_bf16_f32 v234, v156, v157
    s_waitcnt lgkmcnt(3)
    v_mfma_f32_16x16x32_bf16 v[212:215], v[168:171], v[116:119], v[212:215]
    v_mfma_f32_16x16x32_bf16 v[216:219], v[168:171], v[120:123], v[216:219]
    v_fma_f32 v230, v202, v228, v242
    v_fma_f32 v231, v202, v229, v243
    v_fma_f32 v158, v200, v158, v230
    v_fma_f32 v159, v200, v159, v231
    v_max_f32 v158, 0, v158
    v_max_f32 v159, 0, v159
    v_mul_f32 v158, v158, v158
    v_mul_f32 v159, v159, v159
    v_cvt_pk_bf16_f32 v235, v158, v159
    s_waitcnt lgkmcnt(2)
    v_mfma_f32_16x16x32_bf16 v[196:199], v[188:191], v[16:19], v[196:199]
    s_waitcnt lgkmcnt(1)
    v_mfma_f32_16x16x32_bf16 v[204:207], v[172:175], v[124:127], v[204:207]
    v_mfma_f32_16x16x32_bf16 v[208:211], v[172:175], v[128:131], v[208:211]
    v_fma_f32 v230, v203, v226, v240
    v_fma_f32 v231, v203, v227, v241
    v_fma_f32 v160, v201, v160, v230
    v_fma_f32 v161, v201, v161, v231
    v_max_f32 v160, 0, v160
    v_max_f32 v161, 0, v161
    v_mul_f32 v160, v160, v160
    v_mul_f32 v161, v161, v161
    v_cvt_pk_bf16_f32 v238, v160, v161
    s_waitcnt lgkmcnt(0)
    v_mfma_f32_16x16x32_bf16 v[212:215], v[176:179], v[124:127], v[212:215]
    v_fma_f32 v230, v203, v228, v242
    v_fma_f32 v231, v203, v229, v243
    v_fma_f32 v162, v201, v162, v230
    v_fma_f32 v163, v201, v163, v231
    v_max_f32 v162, 0, v162
    v_max_f32 v163, 0, v163
    v_mul_f32 v162, v162, v162
    v_mul_f32 v163, v163, v163
    v_cvt_pk_bf16_f32 v239, v162, v163
    v_mfma_f32_16x16x32_bf16 v[216:219], v[176:179], v[128:131], v[216:219]
    s_bitcmp1_b32 s45, 0
    s_cbranch_scc0 L_noswap_9
    v_swap_b32 v232, v234
    v_swap_b32 v233, v235
    v_swap_b32 v236, v238
    v_swap_b32 v237, v239
L_noswap_9:
    s_mul_i32 s52, s46, 458752
    s_mul_i32 s57, s45, 114688
    s_add_u32 s52, s52, s57
    s_lshl_b32 s57, s47, 12
    s_add_u32 s52, s52, s57
    s_add_u32 s52, s52, 5242880
    s_lshr_b32 s53, s45, 1
    s_xor_b32 s53, s53, 1
    s_lshl_b32 s53, s53, 10
    s_add_u32 s52, s52, s53
    s_add_u32 s53, s52, 57344
    buffer_store_dwordx4 v[232:235], v7, s[8:11], s52 offen sc1
    buffer_store_dwordx4 v[236:239], v7, s[8:11], s53 offen sc1
    s_lshl_b32 s52, s45, 6
    s_add_u32 s52, s52, 158208
    v_lshl_add_u32 v220, v3, 4, s52
    v_cmp_eq_u32 vcc, 0, v2
    s_nop 1
    s_mov_b64 exec, vcc
    ds_write_b128 v220, v[196:199]
    s_mov_b64 exec, -1
    s_waitcnt vmcnt(8)
    s_waitcnt lgkmcnt(0)
    s_barrier
    v_add_u32 v220, 49152, v7
    v_mov_b32 v230, 0
    v_mov_b32 v231, 0
    v_mov_b32 v232, 0
    v_mov_b32 v233, 0
    v_mov_b32 v234, 0
    v_mov_b32 v235, 0
    v_mov_b32 v236, 0
    v_mov_b32 v237, 0
    s_and_b32 s53, s45, 1
    s_mul_i32 s53, s53, 14336
    s_lshr_b32 s54, s45, 1
    s_mul_i32 s54, s54, 7168
    s_add_u32 s53, s53, s54
    s_add_u32 s53, s53, 49152
    v_add_u32 v221, s53, v7
    v_mov_b32 v196, 0
    v_mov_b32 v197, 0
    v_mov_b32 v198, 0
    v_mov_b32 v199, 0
    ds_read_b128 v[164:167], v220 offset:0
    ds_read_b128 v[168:171], v220 offset:14336
    ds_read_b128 v[180:183], v221 offset:0
    s_waitcnt lgkmcnt(2)
    v_mfma_f32_16x16x32_bf16 v[230:233], v[164:167], v[20:23], v[230:233]
    s_waitcnt lgkmcnt(1)
    v_mfma_f32_16x16x32_bf16 v[234:237], v[168:171], v[20:23], v[234:237]
    s_waitcnt lgkmcnt(0)
    v_mfma_f32_16x16x32_bf16 v[196:199], v[180:183], v[16:19], v[196:199]
    ds_read_b128 v[172:175], v220 offset:1024
    ds_read_b128 v[176:179], v220 offset:15360
    v_lshlrev_b32 v251, 4, v3
    v_add_u32 v251, 158208, v251
    ds_read_b128 v[148:151], v251 offset:0
    ds_read_b128 v[156:159], v251 offset:256
    s_waitcnt lgkmcnt(3)
    v_mfma_f32_16x16x32_bf16 v[230:233], v[172:175], v[28:31], v[230:233]
    s_waitcnt lgkmcnt(2)
    v_mfma_f32_16x16x32_bf16 v[234:237], v[176:179], v[28:31], v[234:237]
    ds_read_b128 v[164:167], v220 offset:2048
    ds_read_b128 v[168:171], v220 offset:16384
    ds_read_b128 v[184:187], v221 offset:1024
    ds_read_b128 v[152:155], v251 offset:64
    ds_read_b128 v[160:163], v251 offset:320
    s_waitcnt lgkmcnt(5)
    v_add_f32 v148, v148, v156
    v_add_f32 v149, v149, v157
    v_add_f32 v150, v150, v158
    s_waitcnt lgkmcnt(4)
    v_mfma_f32_16x16x32_bf16 v[230:233], v[164:167], v[36:39], v[230:233]
    s_waitcnt lgkmcnt(3)
    v_mfma_f32_16x16x32_bf16 v[234:237], v[168:171], v[36:39], v[234:237]
    s_waitcnt lgkmcnt(2)
    v_mfma_f32_16x16x32_bf16 v[196:199], v[184:187], v[16:19], v[196:199]
    ds_read_b128 v[172:175], v220 offset:3072
    ds_read_b128 v[176:179], v220 offset:17408
    v_add_f32 v151, v151, v159
    s_waitcnt lgkmcnt(2)
    v_add_f32 v152, v152, v160
    v_add_f32 v153, v153, v161
    v_add_f32 v154, v154, v162
    v_add_f32 v155, v155, v163
    s_mul_i32 s2, s75, 401408
    s_add_u32 s2, s2, 229376
    s_add_u32 s2, s2, s3
    s_add_u32 m0, s59, 81920
    s_nop 0
    buffer_load_dwordx4 v252, s[16:19], s2 offen lds
    s_waitcnt lgkmcnt(1)
    v_mfma_f32_16x16x32_bf16 v[230:233], v[172:175], v[44:47], v[230:233]
    s_waitcnt lgkmcnt(0)
    v_mfma_f32_16x16x32_bf16 v[234:237], v[176:179], v[44:47], v[234:237]
    ds_read_b128 v[164:167], v220 offset:4096
    ds_read_b128 v[168:171], v220 offset:18432
    ds_read_b128 v[180:183], v221 offset:2048
    s_lshl_b32 s55, s45, 10
    s_add_u32 s55, s55, 159744
    v_add_u32 v238, s55, v7
    v_mul_f32 v208, v201, v208
    v_fma_f32 v208, v203, v148, v208
    s_mul_i32 s2, s75, 401408
    s_add_u32 s2, s2, 286720
    s_add_u32 s2, s2, s3
    s_add_u32 m0, s59, 90112
    s_nop 0
    buffer_load_dwordx4 v252, s[16:19], s2 offen lds
    s_waitcnt lgkmcnt(2)
    v_mfma_f32_16x16x32_bf16 v[230:233], v[164:167], v[52:55], v[230:233]
    s_waitcnt lgkmcnt(1)
    v_mfma_f32_16x16x32_bf16 v[234:237], v[168:171], v[52:55], v[234:237]
    s_waitcnt lgkmcnt(0)
    v_mfma_f32_16x16x32_bf16 v[196:199], v[180:183], v[16:19], v[196:199]
    ds_read_b128 v[172:175], v220 offset:5120
    ds_read_b128 v[176:179], v220 offset:19456
    v_mul_f32 v209, v201, v209
    v_fma_f32 v209, v203, v149, v209
    v_mul_f32 v210, v201, v210
    v_fma_f32 v210, v203, v150, v210
    v_mul_f32 v211, v201, v211
    s_mul_i32 s2, s75, 401408
    s_add_u32 s2, s2, 344064
    s_add_u32 s2, s2, s3
    s_add_u32 m0, s59, 98304
    s_nop 0
    buffer_load_dwordx4 v252, s[16:19], s2 offen lds
    s_waitcnt lgkmcnt(1)
    v_mfma_f32_16x16x32_bf16 v[230:233], v[172:175], v[60:63], v[230:233]
    s_waitcnt lgkmcnt(0)
    v_mfma_f32_16x16x32_bf16 v[234:237], v[176:179], v[60:63], v[234:237]
    ds_read_b128 v[164:167], v220 offset:6144
    ds_read_b128 v[168:171], v220 offset:20480
    ds_read_b128 v[184:187], v221 offset:3072
    v_fma_f32 v211, v203, v151, v211
    v_cvt_pk_bf16_f32 v132, v208, v209
    v_cvt_pk_bf16_f32 v133, v210, v211
    v_mul_f32 v216, v201, v216
    v_fma_f32 v216, v203, v152, v216
    s_mul_i32 s2, s75, 4294565888
    s_add_u32 s2, s2, 401408
    s_add_u32 s2, s2, s3
    s_add_u32 m0, s59, 106496
    s_nop 0
    buffer_load_dwordx4 v252, s[16:19], s2 offen lds
    s_waitcnt lgkmcnt(2)
    v_mfma_f32_16x16x32_bf16 v[230:233], v[164:167], v[68:71], v[230:233]
    s_waitcnt lgkmcnt(1)
    v_mfma_f32_16x16x32_bf16 v[234:237], v[168:171], v[68:71], v[234:237]
    s_waitcnt lgkmcnt(0)
    v_mfma_f32_16x16x32_bf16 v[196:199], v[184:187], v[16:19], v[196:199]
    ds_read_b128 v[172:175], v220 offset:7168
    ds_read_b128 v[176:179], v220 offset:21504
    v_mul_f32 v217, v201, v217
    v_fma_f32 v217, v203, v153, v217
    v_mul_f32 v218, v201, v218
    v_fma_f32 v218, v203, v154, v218
    s_waitcnt vmcnt(4)
    s_lshl_b32 s52, s46, 9
    s_lshl_b32 s57, s47, 5
    s_add_u32 s52, s52, s57
    s_lshl_b32 s57, s44, 2
    s_add_u32 s52, s52, s57
    s_add_u32 s52, s52, 12288
    s_mov_b64 exec, 1
    s_cmp_eq_u32 s49, 0
    s_cbranch_scc1 L_slow_10
    buffer_store_dword v14, v15, s[8:11], s52 offen
    s_branch L_mdone_11
L_slow_10:
    buffer_store_dword v14, v15, s[8:11], s52 offen sc1
L_mdone_11:
    s_mov_b64 exec, -1
    s_mul_i32 s2, s75, 4294565888
    s_add_u32 s2, s2, 458752
    s_add_u32 s2, s2, s3
    s_add_u32 m0, s59, 114688
    s_nop 0
    buffer_load_dwordx4 v252, s[16:19], s2 offen lds
    s_waitcnt lgkmcnt(1)
    v_mfma_f32_16x16x32_bf16 v[230:233], v[172:175], v[76:79], v[230:233]
    s_waitcnt lgkmcnt(0)
    v_mfma_f32_16x16x32_bf16 v[234:237], v[176:179], v[76:79], v[234:237]
    ds_read_b128 v[164:167], v220 offset:8192
    ds_read_b128 v[168:171], v220 offset:22528
    ds_read_b128 v[180:183], v221 offset:4096
    v_mul_f32 v219, v201, v219
    v_fma_f32 v219, v203, v155, v219
    v_cvt_pk_bf16_f32 v134, v216, v217
    v_cvt_pk_bf16_f32 v135, v218, v219
    ds_write_b128 v238, v[132:135]
    s_mul_i32 s2, s75, 4294565888
    s_add_u32 s2, s2, 516096
    s_add_u32 s2, s2, s3
    s_add_u32 m0, s59, 122880
    s_nop 0
    buffer_load_dwordx4 v252, s[16:19], s2 offen lds
    s_waitcnt lgkmcnt(3)
    v_mfma_f32_16x16x32_bf16 v[230:233], v[164:167], v[84:87], v[230:233]
    s_waitcnt lgkmcnt(2)
    v_mfma_f32_16x16x32_bf16 v[234:237], v[168:171], v[84:87], v[234:237]
    s_waitcnt lgkmcnt(1)
    v_mfma_f32_16x16x32_bf16 v[196:199], v[180:183], v[16:19], v[196:199]
    ds_read_b128 v[172:175], v220 offset:9216
    ds_read_b128 v[176:179], v220 offset:23552
    v_mul_f32 v204, v200, v204
    v_fma_f32 v204, v202, v148, v204
    v_mul_f32 v205, v200, v205
    v_fma_f32 v205, v202, v149, v205
    v_mul_f32 v206, v200, v206
    s_mul_i32 s2, s75, 4294565888
    s_add_u32 s2, s2, 573440
    s_add_u32 s2, s2, s3
    s_add_u32 m0, s59, 16384
    s_nop 0
    buffer_load_dwordx4 v252, s[16:19], s2 offen lds
    s_waitcnt lgkmcnt(1)
    v_mfma_f32_16x16x32_bf16 v[230:233], v[172:175], v[92:95], v[230:233]
    s_waitcnt lgkmcnt(0)
    v_mfma_f32_16x16x32_bf16 v[234:237], v[176:179], v[92:95], v[234:237]
    ds_read_b128 v[164:167], v220 offset:10240
    ds_read_b128 v[168:171], v220 offset:24576
    ds_read_b128 v[184:187], v221 offset:5120
    v_fma_f32 v206, v202, v150, v206
    v_mul_f32 v207, v200, v207
    v_fma_f32 v207, v202, v151, v207
    v_cvt_pk_bf16_f32 v244, v204, v205
    v_cvt_pk_bf16_f32 v245, v206, v207
    s_mul_i32 s2, s75, 4294565888
    s_add_u32 s2, s2, 630784
    s_add_u32 s2, s2, s3
    s_add_u32 m0, s59, 24576
    s_nop 0
    buffer_load_dwordx4 v252, s[16:19], s2 offen lds
    s_waitcnt lgkmcnt(2)
    v_mfma_f32_16x16x32_bf16 v[230:233], v[164:167], v[100:103], v[230:233]
    s_waitcnt lgkmcnt(1)
    v_mfma_f32_16x16x32_bf16 v[234:237], v[168:171], v[100:103], v[234:237]
    s_waitcnt lgkmcnt(0)
    v_mfma_f32_16x16x32_bf16 v[196:199], v[184:187], v[16:19], v[196:199]
    ds_read_b128 v[172:175], v220 offset:11264
    ds_read_b128 v[176:179], v220 offset:25600
    v_mul_f32 v212, v200, v212
    v_fma_f32 v212, v202, v152, v212
    v_mul_f32 v213, v200, v213
    v_fma_f32 v213, v202, v153, v213
    v_mul_f32 v214, v200, v214
    s_waitcnt lgkmcnt(1)
    v_mfma_f32_16x16x32_bf16 v[230:233], v[172:175], v[108:111], v[230:233]
    s_waitcnt lgkmcnt(0)
    v_mfma_f32_16x16x32_bf16 v[234:237], v[176:179], v[108:111], v[234:237]
    ds_read_b128 v[164:167], v220 offset:12288
    ds_read_b128 v[168:171], v220 offset:26624
    ds_read_b128 v[180:183], v221 offset:6144
    v_fma_f32 v214, v202, v154, v214
    v_mul_f32 v215, v200, v215
    v_fma_f32 v215, v202, v155, v215
    v_cvt_pk_bf16_f32 v246, v212, v213
    v_cvt_pk_bf16_f32 v247, v214, v215
    s_waitcnt lgkmcnt(2)
    v_mfma_f32_16x16x32_bf16 v[230:233], v[164:167], v[116:119], v[230:233]
    s_waitcnt lgkmcnt(1)
    v_mfma_f32_16x16x32_bf16 v[234:237], v[168:171], v[116:119], v[234:237]
    s_waitcnt lgkmcnt(0)
    v_mfma_f32_16x16x32_bf16 v[196:199], v[180:183], v[16:19], v[196:199]
    ds_read_b128 v[172:175], v220 offset:13312
    ds_read_b128 v[176:179], v220 offset:27648
    s_waitcnt lgkmcnt(1)
    v_mfma_f32_16x16x32_bf16 v[230:233], v[172:175], v[124:127], v[230:233]
    s_waitcnt lgkmcnt(0)
    v_mfma_f32_16x16x32_bf16 v[234:237], v[176:179], v[124:127], v[234:237]
    s_lshl_b32 s52, s45, 6
    s_add_u32 s52, s52, 158720
    v_lshl_add_u32 v220, v3, 4, s52
    v_cmp_eq_u32 vcc, 0, v2
    s_nop 1
    s_mov_b64 exec, vcc
    ds_write_b128 v220, v[196:199]
    s_mov_b64 exec, -1
    v_lshrrev_b32 v208, 1, v1
    v_lshlrev_b32 v208, 5, v208
    v_and_b32 v209, 1, v1
    v_lshl_add_u32 v208, v209, 4, v208
    s_lshl_b32 s52, s46, 9
    s_mul_i32 s57, s50, 224
    s_add_u32 s52, s52, s57
    s_lshl_b32 s57, s45, 2
    s_add_u32 s52, s52, s57
    s_add_u32 s52, s52, 12288
    v_add_u32 v208, s52, v208
    buffer_load_dword v248, v208, s[8:11], 0 offen sc1
    s_xor_b32 s53, s50, 0
    s_mul_i32 s52, s46, 458752
    s_mul_i32 s57, s45, 114688
    s_add_u32 s52, s52, s57
    s_mul_i32 s57, s53, 57344
    s_add_u32 s52, s52, s57
    s_mul_i32 s57, s50, 28672
    s_add_u32 s52, s52, s57
    s_add_u32 s52, s52, 5242880
    s_mov_b32 s68, s52
    s_xor_b32 s53, s50, 1
    s_mul_i32 s52, s46, 458752
    s_mul_i32 s57, s45, 114688
    s_add_u32 s52, s52, s57
    s_mul_i32 s57, s53, 57344
    s_add_u32 s52, s52, s57
    s_mul_i32 s57, s50, 28672
    s_add_u32 s52, s52, s57
    s_add_u32 s52, s52, 5242880
    s_mov_b32 s69, s52
    s_waitcnt lgkmcnt(0)
    s_barrier
    s_waitcnt vmcnt(0)
    v_mov_b32 v254, v248
    s_mov_b32 exec_lo, 16383
    s_mov_b32 exec_hi, 0
    v_cmp_ne_u32 vcc, s48, v254
    s_mov_b64 exec, -1
    s_nop 0
    s_cmp_eq_u64 vcc, 0
    s_cbranch_scc1 L_eok_12
    s_mov_b32 s52, 0
    s_mov_b32 exec_lo, 16383
    s_mov_b32 exec_hi, 0
    s_mov_b32 s70, 0
L_poll_13:
    buffer_load_dword v254, v208, s[8:11], s52 offen sc1
    s_waitcnt vmcnt(0)
    v_cmp_ne_u32 vcc, s48, v254
    s_nop 4
    s_cmp_eq_u64 vcc, 0
    s_cbranch_scc1 L_polld_14
    s_add_u32 s70, s70, 1
    s_cmp_lt_u32 s70, 4000
    s_cbranch_scc1 L_poll_13
L_polld_14:
    s_mov_b64 exec, -1
L_eok_12:
    v_mov_b32 v116, v244
    v_mov_b32 v117, v245
    v_mov_b32 v118, v246
    v_mov_b32 v119, v247
    v_lshrrev_b32 v243, 2, v2
    v_lshl_add_u32 v243, v3, 2, v243
    v_mul_u32_u24 v243, 56, v243
    v_and_b32 v244, 3, v1
    v_lshl_add_u32 v243, v244, 3, v243
    v_add_u32 v243, 155648, v243
    ds_read_b64_tr_b16 v[104:105], v243 offset:0
    ds_read_b64_tr_b16 v[106:107], v243 offset:896
    ds_read_b64_tr_b16 v[108:109], v243 offset:32
    ds_read_b64_tr_b16 v[110:111], v243 offset:928
    v_lshlrev_b32 v220, 4, v3
    v_add_u32 v220, 158720, v220
    ds_read_b128 v[84:87], v220 offset:0
    ds_read_b128 v[92:95], v220 offset:128
    ds_read_b128 v[88:91], v220 offset:64
    ds_read_b128 v[96:99], v220 offset:192
    s_waitcnt lgkmcnt(2)
    v_add_f32 v84, v84, v92
    v_add_f32 v85, v85, v93
    v_add_f32 v86, v86, v94
    v_add_f32 v87, v87, v95
    s_waitcnt lgkmcnt(0)
    v_add_f32 v88, v88, v96
    v_add_f32 v89, v89, v97
    v_add_f32 v90, v90, v98
    v_add_f32 v91, v91, v99
    v_mul_f32 v230, v200, v230
    v_fma_f32 v230, v202, v84, v230
    v_mul_f32 v231, v200, v231
    v_fma_f32 v231, v202, v85, v231
    v_mul_f32 v232, v200, v232
    v_fma_f32 v232, v202, v86, v232
    v_mul_f32 v233, v200, v233
    v_fma_f32 v233, v202, v87, v233
    v_cvt_pk_bf16_f32 v120, v230, v231
    v_cvt_pk_bf16_f32 v121, v232, v233
    v_mul_f32 v234, v200, v234
    v_fma_f32 v234, v202, v88, v234
    v_mul_f32 v235, v200, v235
    v_fma_f32 v235, v202, v89, v235
    v_mul_f32 v236, v200, v236
    v_fma_f32 v236, v202, v90, v236
    v_mul_f32 v237, v200, v237
    v_fma_f32 v237, v202, v91, v237
    v_cvt_pk_bf16_f32 v122, v234, v235
    v_cvt_pk_bf16_f32 v123, v236, v237
    v_cndmask_b32 v106, v106, v15, s[62:63]
    v_cndmask_b32 v107, v107, v15, s[62:63]
    v_cndmask_b32 v110, v110, v15, s[62:63]
    v_cndmask_b32 v111, v111, v15, s[62:63]
    v_lshrrev_b32 v220, 1, v2
    v_and_b32 v220, 3, v220
    v_lshlrev_b32 v221, 7, v2
    v_lshl_add_u32 v221, v3, 3, v221
    s_lshl_b32 s52, s45, 12
    s_add_u32 s52, s52, 131072
    v_add_u32 v221, s52, v221
    v_xor_b32 v196, 0, v220
    v_lshl_add_u32 v204, v196, 5, v221
    v_xor_b32 v196, 1, v220
    v_lshl_add_u32 v205, v196, 5, v221
    v_xor_b32 v196, 2, v220
    v_lshl_add_u32 v206, v196, 5, v221
    v_xor_b32 v196, 3, v220
    v_lshl_add_u32 v207, v196, 5, v221
    v_mfma_f32_16x16x32_bf16 v[84:87], v[104:107], v[116:119], 0
    v_mfma_f32_16x16x32_bf16 v[88:91], v[108:111], v[116:119], 0
    s_nop 6
    v_max3_f32 v222, v84, v85, v86
    v_max3_f32 v224, v88, v89, v90
    v_min3_f32 v223, v84, v85, v86
    v_min3_f32 v225, v88, v89, v90
    v_max_f32 v222, v222, v87
    v_max_f32 v224, v224, v91
    v_min_f32 v223, v223, v87
    v_min_f32 v225, v225, v91
    v_mov_b32 v226, 0x7149f2ca
    v_cndmask_b32 v224, v224, v222, s[62:63]
    v_cndmask_b32 v225, v225, v223, s[62:63]
    s_mov_b32 s56, 0x3fb8aa3b
    v_max_f32 v222, v222, v224
    v_min_f32 v223, v223, v225
    v_mul_f32 v222, 0x3fb8aa3b, v222
    v_mul_f32 v223, 0xbfb8aa3b, v223
    s_nop 1
    v_permlane32_swap_b32 v222, v223
    s_mul_i32 s2, s75, 14336
    s_add_u32 s2, s2, 0
    s_add_u32 s57, s2, s69
    s_add_u32 s2, s2, s68
    buffer_load_dwordx4 v[20:23], v7, s[8:11], s2 offen sc1
    buffer_load_dwordx4 v[24:27], v7, s[8:11], s57 offen sc1
    v_max_f32 v222, v222, v223
    v_mov_b32 v224, v222
    s_nop 1
    v_permlane16_swap_b32 v222, v224
    v_max_f32 v222, v222, v224
    v_mov_b32 v223, v222
    s_nop 1
    v_permlane32_swap_b32 v222, v223
    v_cndmask_b32 v224, v222, v226, s[62:63]
    v_cndmask_b32 v225, v223, v226, s[62:63]
    v_fma_f32 v227, v84, s56, -v222
    v_fma_f32 v235, -v84, s56, -v223
    v_fma_f32 v228, v85, s56, -v222
    v_fma_f32 v236, -v85, s56, -v223
    v_fma_f32 v229, v86, s56, -v222
    v_fma_f32 v237, -v86, s56, -v223
    v_fma_f32 v230, v87, s56, -v222
    v_fma_f32 v238, -v87, s56, -v223
    v_fma_f32 v231, v88, s56, -v224
    v_fma_f32 v239, -v88, s56, -v225
    s_mul_i32 s2, s75, 14336
    s_add_u32 s2, s2, 2048
    s_add_u32 s57, s2, s69
    s_add_u32 s2, s2, s68
    buffer_load_dwordx4 v[28:31], v7, s[8:11], s2 offen sc1
    buffer_load_dwordx4 v[32:35], v7, s[8:11], s57 offen sc1
    v_fma_f32 v232, v89, s56, -v224
    v_fma_f32 v240, -v89, s56, -v225
    v_fma_f32 v233, v90, s56, -v224
    v_fma_f32 v241, -v90, s56, -v225
    v_fma_f32 v234, v91, s56, -v224
    v_fma_f32 v242, -v91, s56, -v225
    v_exp_f32 v227, v227
    v_exp_f32 v235, v235
    v_exp_f32 v228, v228
    v_exp_f32 v236, v236
    v_exp_f32 v229, v229
    v_exp_f32 v237, v237
    v_exp_f32 v230, v230
    v_exp_f32 v238, v238
    v_exp_f32 v231, v231
    v_exp_f32 v239, v239
    v_exp_f32 v232, v232
    v_exp_f32 v240, v240
    v_exp_f32 v233, v233
    s_mul_i32 s2, s75, 14336
    s_add_u32 s2, s2, 4096
    s_add_u32 s57, s2, s69
    s_add_u32 s2, s2, s68
    buffer_load_dwordx4 v[36:39], v7, s[8:11], s2 offen sc1
    buffer_load_dwordx4 v[40:43], v7, s[8:11], s57 offen sc1
    v_exp_f32 v241, v241
    v_exp_f32 v234, v234
    v_exp_f32 v242, v242
    v_add_f32 v222, v227, v228
    v_add_f32 v223, v235, v236
    v_add_f32 v224, v229, v230
    v_add_f32 v225, v237, v238
    v_add_f32 v222, v222, v231
    v_add_f32 v223, v223, v239
    v_add_f32 v224, v224, v232
    v_add_f32 v225, v225, v240
    v_add_f32 v222, v222, v233
    v_add_f32 v223, v223, v241
    v_add_f32 v224, v224, v234
    v_add_f32 v225, v225, v242
    v_add_f32 v222, v222, v224
    v_add_f32 v223, v223, v225
    s_nop 1
    v_permlane32_swap_b32 v222, v223
    s_mul_i32 s2, s75, 14336
    s_add_u32 s2, s2, 6144
    s_add_u32 s57, s2, s69
    s_add_u32 s2, s2, s68
    buffer_load_dwordx4 v[44:47], v7, s[8:11], s2 offen sc1
    buffer_load_dwordx4 v[48:51], v7, s[8:11], s57 offen sc1
    v_add_f32 v222, v222, v223
    v_mov_b32 v224, v222
    s_nop 1
    v_permlane16_swap_b32 v222, v224
    v_add_f32 v222, v222, v224
    v_mov_b32 v223, v222
    s_nop 1
    v_permlane32_swap_b32 v222, v223
    v_rcp_f32 v222, v222
    v_rcp_f32 v223, v223
    v_mul_f32 v227, v222, v227
    v_mul_f32 v235, v223, v235
    v_mul_f32 v228, v222, v228
    v_mul_f32 v236, v223, v236
    v_mul_f32 v229, v222, v229
    v_mul_f32 v237, v223, v237
    v_mul_f32 v230, v222, v230
    v_mul_f32 v238, v223, v238
    v_mul_f32 v231, v222, v231
    v_mul_f32 v239, v223, v239
    s_mul_i32 s2, s75, 14336
    s_add_u32 s2, s2, 8192
    s_add_u32 s57, s2, s69
    s_add_u32 s2, s2, s68
    buffer_load_dwordx4 v[52:55], v7, s[8:11], s2 offen sc1
    buffer_load_dwordx4 v[56:59], v7, s[8:11], s57 offen sc1
    v_mul_f32 v232, v222, v232
    v_mul_f32 v240, v223, v240
    v_mul_f32 v233, v222, v233
    v_mul_f32 v241, v223, v241
    v_mul_f32 v234, v222, v234
    v_mul_f32 v242, v223, v242
    v_cvt_pk_bf16_f32 v92, v227, v228
    v_cvt_pk_bf16_f32 v96, v235, v236
    v_cvt_pk_bf16_f32 v93, v229, v230
    v_cvt_pk_bf16_f32 v97, v237, v238
    v_cvt_pk_bf16_f32 v94, v231, v232
    v_cvt_pk_bf16_f32 v98, v239, v240
    v_cvt_pk_bf16_f32 v95, v233, v234
    v_cvt_pk_bf16_f32 v99, v241, v242
    ds_write_b64 v204, v[92:93] offset:0
    ds_write_b64 v205, v[94:95] offset:0
    ds_write_b64 v206, v[96:97] offset:0
    ds_write_b64 v207, v[98:99] offset:0
    s_waitcnt lgkmcnt(0)
    s_barrier
    v_lshrrev_b32 v222, 2, v2
    v_lshl_add_u32 v223, v3, 2, v222
    v_lshrrev_b32 v224, 1, v223
    v_and_b32 v224, 3, v224
    s_lshr_b32 s52, s44, 1
    v_xor_b32 v224, s52, v224
    v_lshlrev_b32 v223, 7, v223
    v_lshl_add_u32 v223, v224, 5, v223
    v_and_b32 v224, 3, v1
    v_lshl_add_u32 v223, v224, 3, v223
    v_add_u32 v223, 131072, v223
    s_and_b32 s52, s44, 1
    s_lshl_b32 s52, s52, 10
    s_add_u32 s52, s52, 147456
    v_add_u32 v224, s52, v7
    ds_read_b64_tr_b16 v[84:85], v223 offset:0
    ds_read_b64_tr_b16 v[86:87], v223 offset:2048
    ds_read_b128 v[112:115], v224 offset:0
    ds_read_b64_tr_b16 v[88:89], v223 offset:4096
    ds_read_b64_tr_b16 v[90:91], v223 offset:6144
    ds_read_b128 v[116:119], v224 offset:2048
    ds_read_b64_tr_b16 v[92:93], v223 offset:8192
    ds_read_b64_tr_b16 v[94:95], v223 offset:10240
    ds_read_b128 v[124:127], v224 offset:4096
    ds_read_b64_tr_b16 v[96:97], v223 offset:12288
    ds_read_b64_tr_b16 v[98:99], v223 offset:14336
    ds_read_b128 v[128:131], v224 offset:6144
    s_waitcnt lgkmcnt(9)
    v_mfma_f32_16x16x32_bf16 v[226:229], v[84:87], v[112:115], 0
    s_waitcnt lgkmcnt(6)
    v_mfma_f32_16x16x32_bf16 v[226:229], v[88:91], v[116:119], v[226:229]
    s_waitcnt lgkmcnt(3)
    v_mfma_f32_16x16x32_bf16 v[226:229], v[92:95], v[124:127], v[226:229]
    s_waitcnt lgkmcnt(0)
    v_mfma_f32_16x16x32_bf16 v[226:229], v[96:99], v[128:131], v[226:229]
    s_lshl_b32 s52, s47, 17
    s_lshl_b32 s57, s46, 13
    s_add_u32 s52, s52, s57
    s_lshl_b32 s57, s44, 10
    s_add_u32 s52, s52, s57
    s_add_u32 s52, s52, 2097152
    s_nop 1
    v_bfi_b32 v226, s74, v14, v226
    buffer_store_dwordx4 v[226:229], v7, s[8:11], s52 offen sc1
    v_lshrrev_b32 v232, 2, v2
    v_lshl_add_u32 v233, v3, 2, v232
    v_lshrrev_b32 v234, 1, v233
    v_and_b32 v234, 3, v234
    v_lshlrev_b32 v233, 7, v233
    v_and_b32 v235, 3, v1
    v_lshl_add_u32 v233, v235, 3, v233
    v_xor_b32 v235, 0, v234
    v_lshl_add_u32 v8, v235, 5, v233
    v_add_u32 v216, 0x10000, v8
    v_xor_b32 v235, 1, v234
    v_lshl_add_u32 v9, v235, 5, v233
    v_add_u32 v217, 0x10000, v9
    v_xor_b32 v235, 2, v234
    v_lshl_add_u32 v10, v235, 5, v233
    v_add_u32 v218, 0x10000, v10
    v_xor_b32 v235, 3, v234
    v_lshl_add_u32 v11, v235, 5, v233
    v_add_u32 v219, 0x10000, v11
    v_mov_b32 v132, 0
    v_mov_b32 v133, 0
    v_mov_b32 v134, 0
    v_mov_b32 v135, 0
    v_mov_b32 v136, 0
    v_mov_b32 v137, 0
    v_mov_b32 v138, 0
    v_mov_b32 v139, 0
    v_mov_b32 v140, 0
    v_mov_b32 v141, 0
    v_mov_b32 v142, 0
    v_mov_b32 v143, 0
    v_mov_b32 v144, 0
    v_mov_b32 v145, 0
    v_mov_b32 v146, 0
    v_mov_b32 v147, 0
    v_mov_b32 v148, 0
    v_mov_b32 v149, 0
    v_mov_b32 v150, 0
    v_mov_b32 v151, 0
    v_mov_b32 v152, 0
    v_mov_b32 v153, 0
    v_mov_b32 v154, 0
    v_mov_b32 v155, 0
    v_mov_b32 v156, 0
    v_mov_b32 v157, 0
    v_mov_b32 v158, 0
    v_mov_b32 v159, 0
    v_mov_b32 v160, 0
    v_mov_b32 v161, 0
    v_mov_b32 v162, 0
    v_mov_b32 v163, 0
    s_lshr_b32 s52, s44, 1
    s_lshl_b32 s52, s52, 1
    s_add_u32 s52, s52, s50
    s_lshl_b32 s52, s52, 4
    s_and_b32 s53, s44, 1
    s_lshl_b32 s53, s53, 3
    s_add_u32 s52, s52, s53
    s_lshl_b32 s53, s46, 7
    s_add_u32 s52, s52, s53
    v_lshrrev_b32 v236, 3, v1
    v_and_b32 v237, 7, v1
    v_xor_b32 v237, v237, v236
    v_add_u32 v236, s52, v236
    v_mul_u32_u24 v236, 896, v236
    v_lshl_add_u32 v4, v237, 4, v236
    s_lshl_b32 s52, s51, 7
    v_add_u32 v4, s52, v4
    v_lshlrev_b32 v5, 3, v3
    ds_read_b64_tr_b16 v[164:165], v8 offset:0
    ds_read_b64_tr_b16 v[166:167], v8 offset:2048
    ds_read_b64_tr_b16 v[168:169], v9 offset:0
    ds_read_b64_tr_b16 v[170:171], v9 offset:2048
    ds_read_b64_tr_b16 v[172:173], v10 offset:0
    ds_read_b64_tr_b16 v[174:175], v10 offset:2048
    ds_read_b64_tr_b16 v[176:177], v11 offset:0
    ds_read_b64_tr_b16 v[178:179], v11 offset:2048
    s_waitcnt vmcnt(10) lgkmcnt(6)
    v_mfma_f32_16x16x32_bf16 v[132:135], v[164:167], v[20:23], v[132:135]
    ds_read_b64_tr_b16 v[180:181], v8 offset:8192
    s_waitcnt vmcnt(9)
    v_mfma_f32_16x16x32_bf16 v[136:139], v[164:167], v[24:27], v[136:139]
    ds_read_b64_tr_b16 v[182:183], v8 offset:10240
    s_mul_i32 s2, s75, 4294565888
    s_add_u32 s2, s2, 688128
    s_add_u32 s2, s2, s3
    s_add_u32 m0, s59, 49152
    s_nop 0
    buffer_load_dwordx4 v252, s[16:19], s2 offen lds
    s_waitcnt lgkmcnt(6)
    v_mfma_f32_16x16x32_bf16 v[140:143], v[168:171], v[20:23], v[140:143]
    ds_read_b64_tr_b16 v[184:185], v9 offset:8192
    v_mfma_f32_16x16x32_bf16 v[144:147], v[168:171], v[24:27], v[144:147]
    ds_read_b64_tr_b16 v[186:187], v9 offset:10240
    s_mul_i32 s2, s75, 4294565888
    s_add_u32 s2, s2, 745472
    s_add_u32 s2, s2, s3
    s_add_u32 m0, s59, 57344
    s_nop 0
    buffer_load_dwordx4 v252, s[16:19], s2 offen lds
    s_waitcnt lgkmcnt(6)
    v_mfma_f32_16x16x32_bf16 v[148:151], v[172:175], v[20:23], v[148:151]
    ds_read_b64_tr_b16 v[188:189], v10 offset:8192
    s_mul_i32 s2, s75, 14336
    s_add_u32 s2, s2, 10240
    s_add_u32 s57, s2, s69
    s_add_u32 s2, s2, s68
    buffer_load_dwordx4 v[60:63], v7, s[8:11], s2 offen sc1
    buffer_load_dwordx4 v[64:67], v7, s[8:11], s57 offen sc1
    v_mfma_f32_16x16x32_bf16 v[152:155], v[172:175], v[24:27], v[152:155]
    ds_read_b64_tr_b16 v[190:191], v10 offset:10240
    s_waitcnt lgkmcnt(6)
    v_mfma_f32_16x16x32_bf16 v[156:159], v[176:179], v[20:23], v[156:159]
    ds_read_b64_tr_b16 v[192:193], v11 offset:8192
    v_mfma_f32_16x16x32_bf16 v[84:87], v[104:107], v[120:123], 0
    v_mfma_f32_16x16x32_bf16 v[88:91], v[108:111], v[120:123], 0
    s_nop 6
    v_max3_f32 v222, v84, v85, v86
    v_max3_f32 v224, v88, v89, v90
    v_min3_f32 v223, v84, v85, v86
    v_min3_f32 v225, v88, v89, v90
    v_max_f32 v222, v222, v87
    v_max_f32 v224, v224, v91
    v_min_f32 v223, v223, v87
    v_min_f32 v225, v225, v91
    v_mov_b32 v226, 0x7149f2ca
    v_cndmask_b32 v224, v224, v222, s[62:63]
    v_cndmask_b32 v225, v225, v223, s[62:63]
    s_mov_b32 s56, 0x3fb8aa3b
    v_max_f32 v222, v222, v224
    v_mfma_f32_16x16x32_bf16 v[160:163], v[176:179], v[24:27], v[160:163]
    ds_read_b64_tr_b16 v[194:195], v11 offset:10240
    s_waitcnt vmcnt(12) lgkmcnt(6)
    v_mfma_f32_16x16x32_bf16 v[132:135], v[180:183], v[28:31], v[132:135]
    ds_read_b64_tr_b16 v[164:165], v8 offset:32768
    s_waitcnt vmcnt(11)
    v_mfma_f32_16x16x32_bf16 v[136:139], v[180:183], v[32:35], v[136:139]
    ds_read_b64_tr_b16 v[166:167], v8 offset:34816
    s_mov_b32 s2, 100352
    s_add_u32 m0, s59, 65536
    s_nop 0
    buffer_load_dwordx4 v253, s[20:23], s2 offen lds
    s_waitcnt lgkmcnt(6)
    v_mfma_f32_16x16x32_bf16 v[140:143], v[184:187], v[28:31], v[140:143]
    ds_read_b64_tr_b16 v[168:169], v9 offset:32768
    v_mfma_f32_16x16x32_bf16 v[144:147], v[184:187], v[32:35], v[144:147]
    ds_read_b64_tr_b16 v[170:171], v9 offset:34816
    s_mov_b32 s2, 150528
    s_add_u32 m0, s59, 73728
    s_nop 0
    buffer_load_dwordx4 v253, s[20:23], s2 offen lds
    s_waitcnt lgkmcnt(6)
    v_mfma_f32_16x16x32_bf16 v[148:151], v[188:191], v[28:31], v[148:151]
    ds_read_b64_tr_b16 v[172:173], v10 offset:32768
    s_mul_i32 s2, s75, 14336
    s_add_u32 s2, s2, 12288
    s_add_u32 s57, s2, s69
    s_add_u32 s2, s2, s68
    buffer_load_dwordx4 v[68:71], v7, s[8:11], s2 offen sc1
    buffer_load_dwordx4 v[72:75], v7, s[8:11], s57 offen sc1
    v_mfma_f32_16x16x32_bf16 v[152:155], v[188:191], v[32:35], v[152:155]
    ds_read_b64_tr_b16 v[174:175], v10 offset:34816
    s_waitcnt lgkmcnt(6)
    v_mfma_f32_16x16x32_bf16 v[156:159], v[192:195], v[28:31], v[156:159]
    ds_read_b64_tr_b16 v[176:177], v11 offset:32768
    v_min_f32 v223, v223, v225
    v_mul_f32 v222, 0x3fb8aa3b, v222
    v_mul_f32 v223, 0xbfb8aa3b, v223
    s_nop 1
    v_permlane32_swap_b32 v222, v223
    v_max_f32 v222, v222, v223
    v_mov_b32 v224, v222
    s_nop 1
    v_permlane16_swap_b32 v222, v224
    v_max_f32 v222, v222, v224
    v_mov_b32 v223, v222
    s_nop 1
    v_permlane32_swap_b32 v222, v223
    v_cndmask_b32 v224, v222, v226, s[62:63]
    v_cndmask_b32 v225, v223, v226, s[62:63]
    v_fma_f32 v227, v84, s56, -v222
    v_fma_f32 v235, -v84, s56, -v223
    v_fma_f32 v228, v85, s56, -v222
    v_mfma_f32_16x16x32_bf16 v[160:163], v[192:195], v[32:35], v[160:163]
    ds_read_b64_tr_b16 v[178:179], v11 offset:34816
    s_waitcnt vmcnt(14) lgkmcnt(6)
    v_mfma_f32_16x16x32_bf16 v[132:135], v[164:167], v[36:39], v[132:135]
    ds_read_b64_tr_b16 v[180:181], v8 offset:40960
    s_waitcnt vmcnt(13)
    v_mfma_f32_16x16x32_bf16 v[136:139], v[164:167], v[40:43], v[136:139]
    ds_read_b64_tr_b16 v[182:183], v8 offset:43008
    s_waitcnt lgkmcnt(6)
    v_mfma_f32_16x16x32_bf16 v[140:143], v[168:171], v[36:39], v[140:143]
    ds_read_b64_tr_b16 v[184:185], v9 offset:40960
    s_mul_i32 s2, s75, 4294952960
    s_add_u32 s2, s2, 14336
    s_add_u32 s57, s2, s69
    s_add_u32 s2, s2, s68
    buffer_load_dwordx4 v[76:79], v7, s[8:11], s2 offen sc1
    buffer_load_dwordx4 v[80:83], v7, s[8:11], s57 offen sc1
    v_mfma_f32_16x16x32_bf16 v[144:147], v[168:171], v[40:43], v[144:147]
    ds_read_b64_tr_b16 v[186:187], v9 offset:43008
    s_waitcnt lgkmcnt(6)
    v_mfma_f32_16x16x32_bf16 v[148:151], v[172:175], v[36:39], v[148:151]
    ds_read_b64_tr_b16 v[188:189], v10 offset:40960
    v_mfma_f32_16x16x32_bf16 v[152:155], v[172:175], v[40:43], v[152:155]
    ds_read_b64_tr_b16 v[190:191], v10 offset:43008
    v_fma_f32 v236, -v85, s56, -v223
    v_fma_f32 v229, v86, s56, -v222
    v_fma_f32 v237, -v86, s56, -v223
    v_fma_f32 v230, v87, s56, -v222
    v_fma_f32 v238, -v87, s56, -v223
    v_fma_f32 v231, v88, s56, -v224
    v_fma_f32 v239, -v88, s56, -v225
    v_fma_f32 v232, v89, s56, -v224
    v_fma_f32 v240, -v89, s56, -v225
    v_fma_f32 v233, v90, s56, -v224
    v_fma_f32 v241, -v90, s56, -v225
    v_fma_f32 v234, v91, s56, -v224
    v_fma_f32 v242, -v91, s56, -v225
    v_exp_f32 v227, v227
    v_exp_f32 v235, v235
    s_waitcnt lgkmcnt(6)
    v_mfma_f32_16x16x32_bf16 v[156:159], v[176:179], v[36:39], v[156:159]
    ds_read_b64_tr_b16 v[192:193], v11 offset:40960
    v_mfma_f32_16x16x32_bf16 v[160:163], v[176:179], v[40:43], v[160:163]
    ds_read_b64_tr_b16 v[194:195], v11 offset:43008
    s_waitcnt lgkmcnt(0)
    s_barrier
    s_waitcnt vmcnt(14)
    v_mfma_f32_16x16x32_bf16 v[132:135], v[180:183], v[44:47], v[132:135]
    ds_read_b64_tr_b16 v[164:165], v216 offset:16384
    s_waitcnt vmcnt(13)
    v_mfma_f32_16x16x32_bf16 v[136:139], v[180:183], v[48:51], v[136:139]
    ds_read_b64_tr_b16 v[166:167], v216 offset:18432
    v_mfma_f32_16x16x32_bf16 v[140:143], v[184:187], v[44:47], v[140:143]
    ds_read_b64_tr_b16 v[168:169], v217 offset:16384
    s_mul_i32 s2, s75, 4294952960
    s_add_u32 s2, s2, 16384
    s_add_u32 s57, s2, s69
    s_add_u32 s2, s2, s68
    buffer_load_dwordx4 v[20:23], v7, s[8:11], s2 offen sc1
    buffer_load_dwordx4 v[24:27], v7, s[8:11], s57 offen sc1
    v_mfma_f32_16x16x32_bf16 v[144:147], v[184:187], v[48:51], v[144:147]
    ds_read_b64_tr_b16 v[170:171], v217 offset:18432
    v_mfma_f32_16x16x32_bf16 v[148:151], v[188:191], v[44:47], v[148:151]
    ds_read_b64_tr_b16 v[172:173], v218 offset:16384
    v_mfma_f32_16x16x32_bf16 v[152:155], v[188:191], v[48:51], v[152:155]
    ds_read_b64_tr_b16 v[174:175], v218 offset:18432
    v_exp_f32 v228, v228
    v_exp_f32 v236, v236
    v_exp_f32 v229, v229
    v_exp_f32 v237, v237
    v_exp_f32 v230, v230
    v_exp_f32 v238, v238
    v_exp_f32 v231, v231
    v_exp_f32 v239, v239
    v_exp_f32 v232, v232
    v_exp_f32 v240, v240
    v_exp_f32 v233, v233
    v_exp_f32 v241, v241
    v_exp_f32 v234, v234
    v_exp_f32 v242, v242
    v_add_f32 v222, v227, v228
    v_mfma_f32_16x16x32_bf16 v[156:159], v[192:195], v[44:47], v[156:159]
    ds_read_b64_tr_b16 v[176:177], v219 offset:16384
    v_mfma_f32_16x16x32_bf16 v[160:163], v[192:195], v[48:51], v[160:163]
    ds_read_b64_tr_b16 v[178:179], v219 offset:18432
    s_waitcnt vmcnt(14) lgkmcnt(6)
    v_mfma_f32_16x16x32_bf16 v[132:135], v[164:167], v[52:55], v[132:135]
    ds_read_b64_tr_b16 v[180:181], v216 offset:24576
    s_waitcnt vmcnt(13)
    v_mfma_f32_16x16x32_bf16 v[136:139], v[164:167], v[56:59], v[136:139]
    ds_read_b64_tr_b16 v[182:183], v216 offset:26624
    s_waitcnt lgkmcnt(6)
    v_mfma_f32_16x16x32_bf16 v[140:143], v[168:171], v[52:55], v[140:143]
    ds_read_b64_tr_b16 v[184:185], v217 offset:24576
    s_mul_i32 s2, s75, 4294952960
    s_add_u32 s2, s2, 18432
    s_add_u32 s57, s2, s69
    s_add_u32 s2, s2, s68
    buffer_load_dwordx4 v[28:31], v7, s[8:11], s2 offen sc1
    buffer_load_dwordx4 v[32:35], v7, s[8:11], s57 offen sc1
    v_mfma_f32_16x16x32_bf16 v[144:147], v[168:171], v[56:59], v[144:147]
    ds_read_b64_tr_b16 v[186:187], v217 offset:26624
    s_waitcnt lgkmcnt(6)
    v_mfma_f32_16x16x32_bf16 v[148:151], v[172:175], v[52:55], v[148:151]
    ds_read_b64_tr_b16 v[188:189], v218 offset:24576
    v_mfma_f32_16x16x32_bf16 v[152:155], v[172:175], v[56:59], v[152:155]
    ds_read_b64_tr_b16 v[190:191], v218 offset:26624
    v_add_f32 v223, v235, v236
    v_add_f32 v224, v229, v230
    v_add_f32 v225, v237, v238
    v_add_f32 v222, v222, v231
    v_add_f32 v223, v223, v239
    v_add_f32 v224, v224, v232
    v_add_f32 v225, v225, v240
    v_add_f32 v222, v222, v233
    v_add_f32 v223, v223, v241
    v_add_f32 v224, v224, v234
    v_add_f32 v225, v225, v242
    v_add_f32 v222, v222, v224
    v_add_f32 v223, v223, v225
    s_nop 1
    v_permlane32_swap_b32 v222, v223
    v_add_f32 v222, v222, v223
    s_waitcnt lgkmcnt(6)
    v_mfma_f32_16x16x32_bf16 v[156:159], v[176:179], v[52:55], v[156:159]
    ds_read_b64_tr_b16 v[192:193], v219 offset:24576
    v_mfma_f32_16x16x32_bf16 v[160:163], v[176:179], v[56:59], v[160:163]
    ds_read_b64_tr_b16 v[194:195], v219 offset:26624
    s_waitcnt vmcnt(11) lgkmcnt(6)
    v_mfma_f32_16x16x32_bf16 v[132:135], v[180:183], v[60:63], v[132:135]
    ds_read_b64_tr_b16 v[164:165], v216 offset:32768
    s_waitcnt vmcnt(10)
    v_mfma_f32_16x16x32_bf16 v[136:139], v[180:183], v[64:67], v[136:139]
    ds_read_b64_tr_b16 v[166:167], v216 offset:34816
    s_waitcnt lgkmcnt(6)
    v_mfma_f32_16x16x32_bf16 v[140:143], v[184:187], v[60:63], v[140:143]
    ds_read_b64_tr_b16 v[168:169], v217 offset:32768
    s_mul_i32 s2, s75, 4294952960
    s_add_u32 s2, s2, 20480
    s_add_u32 s57, s2, s69
    s_add_u32 s2, s2, s68
    buffer_load_dwordx4 v[36:39], v7, s[8:11], s2 offen sc1
    buffer_load_dwordx4 v[40:43], v7, s[8:11], s57 offen sc1
    v_mfma_f32_16x16x32_bf16 v[144:147], v[184:187], v[64:67], v[144:147]
    ds_read_b64_tr_b16 v[170:171], v217 offset:34816
    s_waitcnt lgkmcnt(6)
    v_mfma_f32_16x16x32_bf16 v[148:151], v[188:191], v[60:63], v[148:151]
    ds_read_b64_tr_b16 v[172:173], v218 offset:32768
    v_mfma_f32_16x16x32_bf16 v[152:155], v[188:191], v[64:67], v[152:155]
    ds_read_b64_tr_b16 v[174:175], v218 offset:34816
    v_mov_b32 v224, v222
    s_nop 1
    v_permlane16_swap_b32 v222, v224
    v_add_f32 v222, v222, v224
    v_mov_b32 v223, v222
    s_nop 1
    v_permlane32_swap_b32 v222, v223
    v_rcp_f32 v222, v222
    v_rcp_f32 v223, v223
    v_mul_f32 v227, v222, v227
    v_mul_f32 v235, v223, v235
    v_mul_f32 v228, v222, v228
    v_mul_f32 v236, v223, v236
    v_mul_f32 v229, v222, v229
    v_mul_f32 v237, v223, v237
    v_mul_f32 v230, v222, v230
    v_mul_f32 v238, v223, v238
    s_waitcnt lgkmcnt(6)
    v_mfma_f32_16x16x32_bf16 v[156:159], v[192:195], v[60:63], v[156:159]
    ds_read_b64_tr_b16 v[176:177], v219 offset:32768
    v_mfma_f32_16x16x32_bf16 v[160:163], v[192:195], v[64:67], v[160:163]
    ds_read_b64_tr_b16 v[178:179], v219 offset:34816
    s_waitcnt lgkmcnt(0)
    s_barrier
    s_waitcnt vmcnt(9)
    v_mfma_f32_16x16x32_bf16 v[132:135], v[164:167], v[68:71], v[132:135]
    ds_read_b64_tr_b16 v[180:181], v216 offset:40960
    s_waitcnt vmcnt(8)
    v_mfma_f32_16x16x32_bf16 v[136:139], v[164:167], v[72:75], v[136:139]
    ds_read_b64_tr_b16 v[182:183], v216 offset:43008
    s_mov_b32 s2, 0
    s_add_u32 m0, s59, 131072
    s_nop 0
    buffer_load_dwordx4 v253, s[20:23], s2 offen lds
    v_mfma_f32_16x16x32_bf16 v[140:143], v[168:171], v[68:71], v[140:143]
    ds_read_b64_tr_b16 v[184:185], v217 offset:40960
    v_mfma_f32_16x16x32_bf16 v[144:147], v[168:171], v[72:75], v[144:147]
    ds_read_b64_tr_b16 v[186:187], v217 offset:43008
    s_mul_i32 s2, s75, 4294952960
    s_add_u32 s2, s2, 22528
    s_add_u32 s57, s2, s69
    s_add_u32 s2, s2, s68
    buffer_load_dwordx4 v[44:47], v7, s[8:11], s2 offen sc1
    buffer_load_dwordx4 v[48:51], v7, s[8:11], s57 offen sc1
    v_mfma_f32_16x16x32_bf16 v[148:151], v[172:175], v[68:71], v[148:151]
    ds_read_b64_tr_b16 v[188:189], v218 offset:40960
    v_mul_f32 v231, v222, v231
    v_mul_f32 v239, v223, v239
    v_mul_f32 v232, v222, v232
    v_mul_f32 v240, v223, v240
    v_mul_f32 v233, v222, v233
    v_mul_f32 v241, v223, v241
    v_mul_f32 v234, v222, v234
    v_mul_f32 v242, v223, v242
    v_cvt_pk_bf16_f32 v208, v227, v228
    v_cvt_pk_bf16_f32 v212, v235, v236
    v_cvt_pk_bf16_f32 v209, v229, v230
    v_cvt_pk_bf16_f32 v213, v237, v238
    v_cvt_pk_bf16_f32 v210, v231, v232
    v_cvt_pk_bf16_f32 v214, v239, v240
    v_cvt_pk_bf16_f32 v211, v233, v234
    v_cvt_pk_bf16_f32 v215, v241, v242
    v_mfma_f32_16x16x32_bf16 v[152:155], v[172:175], v[72:75], v[152:155]
    ds_read_b64_tr_b16 v[190:191], v218 offset:43008
    v_mfma_f32_16x16x32_bf16 v[156:159], v[176:179], v[68:71], v[156:159]
    ds_read_b64_tr_b16 v[192:193], v219 offset:40960
    s_mov_b32 s2, 200704
    s_add_u32 m0, s59, 0
    s_nop 0
    buffer_load_dwordx4 v253, s[20:23], s2 offen lds
    v_mfma_f32_16x16x32_bf16 v[160:163], v[176:179], v[72:75], v[160:163]
    ds_read_b64_tr_b16 v[194:195], v219 offset:43008
    s_waitcnt vmcnt(11) lgkmcnt(6)
    v_mfma_f32_16x16x32_bf16 v[132:135], v[180:183], v[76:79], v[132:135]
    ds_read_b64_tr_b16 v[164:165], v216 offset:49152
    s_waitcnt vmcnt(10)
    v_mfma_f32_16x16x32_bf16 v[136:139], v[180:183], v[80:83], v[136:139]
    ds_read_b64_tr_b16 v[166:167], v216 offset:51200
    s_waitcnt lgkmcnt(6)
    v_mfma_f32_16x16x32_bf16 v[140:143], v[184:187], v[76:79], v[140:143]
    ds_read_b64_tr_b16 v[168:169], v217 offset:49152
    s_mov_b32 s2, 50176
    s_add_u32 m0, s59, 139264
    s_nop 0
    buffer_load_dwordx4 v253, s[20:23], s2 offen lds
    v_mfma_f32_16x16x32_bf16 v[144:147], v[184:187], v[80:83], v[144:147]
    ds_read_b64_tr_b16 v[170:171], v217 offset:51200
    s_waitcnt lgkmcnt(6)
    v_mfma_f32_16x16x32_bf16 v[148:151], v[188:191], v[76:79], v[148:151]
    ds_read_b64_tr_b16 v[172:173], v218 offset:49152
    s_mul_i32 s2, s75, 4294952960
    s_add_u32 s2, s2, 24576
    s_add_u32 s57, s2, s69
    s_add_u32 s2, s2, s68
    buffer_load_dwordx4 v[52:55], v7, s[8:11], s2 offen sc1
    buffer_load_dwordx4 v[56:59], v7, s[8:11], s57 offen sc1
    v_mfma_f32_16x16x32_bf16 v[152:155], v[188:191], v[80:83], v[152:155]
    ds_read_b64_tr_b16 v[174:175], v218 offset:51200
    s_waitcnt lgkmcnt(6)
    v_mfma_f32_16x16x32_bf16 v[156:159], v[192:195], v[76:79], v[156:159]
    ds_read_b64_tr_b16 v[176:177], v219 offset:49152
    s_mov_b32 s2, 250880
    s_add_u32 m0, s59, 8192
    s_nop 0
    buffer_load_dwordx4 v253, s[20:23], s2 offen lds
    v_mfma_f32_16x16x32_bf16 v[160:163], v[192:195], v[80:83], v[160:163]
    ds_read_b64_tr_b16 v[178:179], v219 offset:51200
    s_waitcnt vmcnt(13) lgkmcnt(6)
    v_mfma_f32_16x16x32_bf16 v[132:135], v[164:167], v[20:23], v[132:135]
    ds_read_b64_tr_b16 v[180:181], v216 offset:57344
    s_waitcnt vmcnt(12)
    v_mfma_f32_16x16x32_bf16 v[136:139], v[164:167], v[24:27], v[136:139]
    ds_read_b64_tr_b16 v[182:183], v216 offset:59392
    s_mul_i32 s2, s75, 4294952960
    s_add_u32 s2, s2, 26624
    s_add_u32 s57, s2, s69
    s_add_u32 s2, s2, s68
    buffer_load_dwordx4 v[60:63], v7, s[8:11], s2 offen sc1
    buffer_load_dwordx4 v[64:67], v7, s[8:11], s57 offen sc1
    s_waitcnt lgkmcnt(6)
    v_mfma_f32_16x16x32_bf16 v[140:143], v[168:171], v[20:23], v[140:143]
    ds_read_b64_tr_b16 v[184:185], v217 offset:57344
    v_mfma_f32_16x16x32_bf16 v[144:147], v[168:171], v[24:27], v[144:147]
    ds_read_b64_tr_b16 v[186:187], v217 offset:59392
    s_mov_b32 s2, 301056
    s_add_u32 m0, s59, 32768
    s_nop 0
    buffer_load_dwordx4 v253, s[20:23], s2 offen lds
    s_waitcnt lgkmcnt(6)
    v_mfma_f32_16x16x32_bf16 v[148:151], v[172:175], v[20:23], v[148:151]
    ds_read_b64_tr_b16 v[188:189], v218 offset:57344
    s_add_u32 m0, s59, 147456
    s_nop 0
    buffer_load_dwordx4 v4, s[4:7], 0 offen lds
    v_mfma_f32_16x16x32_bf16 v[152:155], v[172:175], v[24:27], v[152:155]
    ds_read_b64_tr_b16 v[190:191], v218 offset:59392
    s_waitcnt lgkmcnt(6)
    v_mfma_f32_16x16x32_bf16 v[156:159], v[176:179], v[20:23], v[156:159]
    ds_read_b64_tr_b16 v[192:193], v219 offset:57344
    s_lshl_b32 s52, s51, 7
    buffer_load_dwordx2 v[196:197], v5, s[40:43], s52 offen offset:0
    buffer_load_dwordx2 v[198:199], v5, s[40:43], s52 offen offset:32
    v_mfma_f32_16x16x32_bf16 v[160:163], v[176:179], v[24:27], v[160:163]
    ds_read_b64_tr_b16 v[194:195], v219 offset:59392
    s_waitcnt vmcnt(17) lgkmcnt(6)
    v_mfma_f32_16x16x32_bf16 v[132:135], v[180:183], v[28:31], v[132:135]
    ds_read_b64_tr_b16 v[164:165], v8 offset:16384
    s_waitcnt vmcnt(16)
    v_mfma_f32_16x16x32_bf16 v[136:139], v[180:183], v[32:35], v[136:139]
    ds_read_b64_tr_b16 v[166:167], v8 offset:18432
    s_waitcnt lgkmcnt(6)
    v_mfma_f32_16x16x32_bf16 v[140:143], v[184:187], v[28:31], v[140:143]
    ds_read_b64_tr_b16 v[168:169], v9 offset:16384
    v_mfma_f32_16x16x32_bf16 v[144:147], v[184:187], v[32:35], v[144:147]
    ds_read_b64_tr_b16 v[170:171], v9 offset:18432
    s_waitcnt lgkmcnt(6)
    v_mfma_f32_16x16x32_bf16 v[148:151], v[188:191], v[28:31], v[148:151]
    ds_read_b64_tr_b16 v[172:173], v10 offset:16384
    s_mov_b32 s2, 351232
    s_add_u32 m0, s59, 40960
    s_nop 0
    buffer_load_dwordx4 v253, s[20:23], s2 offen lds
    v_mfma_f32_16x16x32_bf16 v[152:155], v[188:191], v[32:35], v[152:155]
    ds_read_b64_tr_b16 v[174:175], v10 offset:18432
    s_waitcnt lgkmcnt(6)
    v_mfma_f32_16x16x32_bf16 v[156:159], v[192:195], v[28:31], v[156:159]
    ds_read_b64_tr_b16 v[176:177], v11 offset:16384
    v_mfma_f32_16x16x32_bf16 v[160:163], v[192:195], v[32:35], v[160:163]
    ds_read_b64_tr_b16 v[178:179], v11 offset:18432
    s_waitcnt vmcnt(16) lgkmcnt(6)
    v_mfma_f32_16x16x32_bf16 v[132:135], v[164:167], v[36:39], v[132:135]
    ds_read_b64_tr_b16 v[180:181], v8 offset:24576
    s_waitcnt vmcnt(15)
    v_mfma_f32_16x16x32_bf16 v[136:139], v[164:167], v[40:43], v[136:139]
    ds_read_b64_tr_b16 v[182:183], v8 offset:26624
    s_waitcnt lgkmcnt(6)
    v_mfma_f32_16x16x32_bf16 v[140:143], v[168:171], v[36:39], v[140:143]
    ds_read_b64_tr_b16 v[184:185], v9 offset:24576
    v_mfma_f32_16x16x32_bf16 v[144:147], v[168:171], v[40:43], v[144:147]
    ds_read_b64_tr_b16 v[186:187], v9 offset:26624
    s_waitcnt lgkmcnt(6)
    v_mfma_f32_16x16x32_bf16 v[148:151], v[172:175], v[36:39], v[148:151]
    ds_read_b64_tr_b16 v[188:189], v10 offset:24576
    v_mfma_f32_16x16x32_bf16 v[152:155], v[172:175], v[40:43], v[152:155]
    ds_read_b64_tr_b16 v[190:191], v10 offset:26624
    s_waitcnt lgkmcnt(6)
    v_mfma_f32_16x16x32_bf16 v[156:159], v[176:179], v[36:39], v[156:159]
    ds_read_b64_tr_b16 v[192:193], v11 offset:24576
    v_mfma_f32_16x16x32_bf16 v[160:163], v[176:179], v[40:43], v[160:163]
    ds_read_b64_tr_b16 v[194:195], v11 offset:26624
    s_waitcnt vmcnt(13) lgkmcnt(6)
    v_mfma_f32_16x16x32_bf16 v[132:135], v[180:183], v[44:47], v[132:135]
    ds_read_b64_tr_b16 v[164:165], v8 offset:49152
    s_waitcnt vmcnt(12)
    v_mfma_f32_16x16x32_bf16 v[136:139], v[180:183], v[48:51], v[136:139]
    ds_read_b64_tr_b16 v[166:167], v8 offset:51200
    s_waitcnt lgkmcnt(6)
    v_mfma_f32_16x16x32_bf16 v[140:143], v[184:187], v[44:47], v[140:143]
    ds_read_b64_tr_b16 v[168:169], v9 offset:49152
    v_mfma_f32_16x16x32_bf16 v[144:147], v[184:187], v[48:51], v[144:147]
    ds_read_b64_tr_b16 v[170:171], v9 offset:51200
    s_waitcnt lgkmcnt(6)
    v_mfma_f32_16x16x32_bf16 v[148:151], v[188:191], v[44:47], v[148:151]
    ds_read_b64_tr_b16 v[172:173], v10 offset:49152
    v_mfma_f32_16x16x32_bf16 v[152:155], v[188:191], v[48:51], v[152:155]
    ds_read_b64_tr_b16 v[174:175], v10 offset:51200
    s_waitcnt lgkmcnt(6)
    v_mfma_f32_16x16x32_bf16 v[156:159], v[192:195], v[44:47], v[156:159]
    ds_read_b64_tr_b16 v[176:177], v11 offset:49152
    v_mfma_f32_16x16x32_bf16 v[160:163], v[192:195], v[48:51], v[160:163]
    ds_read_b64_tr_b16 v[178:179], v11 offset:51200
    s_lshl_b32 s52, s47, 13
    s_lshl_b32 s57, s44, 10
    s_add_u32 s52, s52, s57
    s_add_u32 s52, s52, 4194304
    buffer_load_dwordx4 v[124:127], v7, s[8:11], s52 offen sc1
    s_waitcnt vmcnt(10) lgkmcnt(6)
    v_mfma_f32_16x16x32_bf16 v[132:135], v[164:167], v[52:55], v[132:135]
    ds_read_b64_tr_b16 v[180:181], v8 offset:57344
    s_waitcnt vmcnt(9)
    v_mfma_f32_16x16x32_bf16 v[136:139], v[164:167], v[56:59], v[136:139]
    ds_read_b64_tr_b16 v[182:183], v8 offset:59392
    s_waitcnt lgkmcnt(6)
    v_mfma_f32_16x16x32_bf16 v[140:143], v[168:171], v[52:55], v[140:143]
    ds_read_b64_tr_b16 v[184:185], v9 offset:57344
    v_mfma_f32_16x16x32_bf16 v[144:147], v[168:171], v[56:59], v[144:147]
    ds_read_b64_tr_b16 v[186:187], v9 offset:59392
    s_waitcnt lgkmcnt(6)
    v_mfma_f32_16x16x32_bf16 v[148:151], v[172:175], v[52:55], v[148:151]
    ds_read_b64_tr_b16 v[188:189], v10 offset:57344
    v_mfma_f32_16x16x32_bf16 v[152:155], v[172:175], v[56:59], v[152:155]
    ds_read_b64_tr_b16 v[190:191], v10 offset:59392
    s_waitcnt lgkmcnt(6)
    v_mfma_f32_16x16x32_bf16 v[156:159], v[176:179], v[52:55], v[156:159]
    ds_read_b64_tr_b16 v[192:193], v11 offset:57344
    v_mfma_f32_16x16x32_bf16 v[160:163], v[176:179], v[56:59], v[160:163]
    ds_read_b64_tr_b16 v[194:195], v11 offset:59392
    s_waitcnt vmcnt(7) lgkmcnt(6)
    v_mfma_f32_16x16x32_bf16 v[132:135], v[180:183], v[60:63], v[132:135]
    s_waitcnt vmcnt(6)
    v_mfma_f32_16x16x32_bf16 v[136:139], v[180:183], v[64:67], v[136:139]
    s_waitcnt lgkmcnt(4)
    v_mfma_f32_16x16x32_bf16 v[140:143], v[184:187], v[60:63], v[140:143]
    v_mfma_f32_16x16x32_bf16 v[144:147], v[184:187], v[64:67], v[144:147]
    s_waitcnt lgkmcnt(2)
    v_mfma_f32_16x16x32_bf16 v[148:151], v[188:191], v[60:63], v[148:151]
    v_mfma_f32_16x16x32_bf16 v[152:155], v[188:191], v[64:67], v[152:155]
    s_waitcnt lgkmcnt(0)
    v_mfma_f32_16x16x32_bf16 v[156:159], v[192:195], v[60:63], v[156:159]
    v_mfma_f32_16x16x32_bf16 v[160:163], v[192:195], v[64:67], v[160:163]
    s_mul_i32 s52, s46, 458752
    s_lshl_b32 s57, s47, 15
    s_add_u32 s52, s52, s57
    s_lshl_b32 s57, s44, 12
    s_add_u32 s52, s52, s57
    s_add_u32 s52, s52, 14680064
    buffer_store_dwordx4 v[136:139], v7, s[8:11], s52 offen offset:0 sc1
    buffer_store_dwordx4 v[144:147], v7, s[8:11], s52 offen offset:1024 sc1
    buffer_store_dwordx4 v[152:155], v7, s[8:11], s52 offen offset:2048 sc1
    buffer_store_dwordx4 v[160:163], v7, s[8:11], s52 offen offset:3072 sc1
    v_lshrrev_b32 v226, 1, v3
    v_and_b32 v227, 7, v2
    v_lshlrev_b32 v228, 7, v2
    v_and_b32 v229, 1, v3
    v_lshl_add_u32 v228, v229, 3, v228
    s_lshl_b32 s52, s45, 11
    s_add_u32 s52, s52, 147456
    v_add_u32 v228, s52, v228
    v_add_u32 v229, 0, v226
    v_xor_b32 v229, v229, v227
    v_lshl_add_u32 v224, v229, 4, v228
    v_add_u32 v229, 2, v226
    v_xor_b32 v229, v229, v227
    v_lshl_add_u32 v225, v229, 4, v228
    s_add_u32 s54, s47, 7
    s_sub_u32 s55, s47, 7
    s_cmp_eq_u32 s50, 0
    s_cselect_b32 s55, s54, s55
    s_lshl_b32 s52, s46, 9
    s_lshl_b32 s57, s50, 4
    s_add_u32 s52, s52, s57
    s_lshl_b32 s57, s45, 2
    s_add_u32 s52, s52, s57
    s_add_u32 s52, s52, 163840
    s_lshl_b32 s53, s46, 9
    s_lshl_b32 s57, s55, 5
    s_add_u32 s53, s53, s57
    s_lshl_b32 s57, s45, 2
    s_add_u32 s53, s53, s57
    s_add_u32 s53, s53, 171904
    v_lshlrev_b32 v230, 5, v1
    v_add_u32 v230, s52, v230
    v_lshlrev_b32 v231, 4, v1
    v_add_u32 v231, s53, v231
    v_cmp_gt_u32 vcc, 8, v1
    s_nop 1
    v_cndmask_b32 v230, v231, v230, vcc
    s_lshl_b32 s52, s45, 12
    s_add_u32 s52, s52, 16384
    v_add_u32 v222, s52, v7
    s_lshl_b32 s52, s45, 12
    s_add_u32 s52, s52, 49152
    v_add_u32 v223, s52, v7
    s_lshl_b32 s68, s46, 17
    s_lshl_b32 s57, s45, 15
    s_add_u32 s68, s68, s57
    s_lshl_b32 s57, s50, 14
    s_add_u32 s68, s68, s57
    s_add_u32 s68, s68, 12582912
    s_mul_i32 s69, s46, 458752
    s_lshl_b32 s57, s55, 15
    s_add_u32 s69, s69, s57
    s_lshl_b32 s57, s45, 12
    s_add_u32 s69, s69, s57
    s_add_u32 s69, s69, 14680064
    s_waitcnt vmcnt(4)
    v_xor_b32 v244, v14, v124
    v_and_b32 v244, 0xfff, v244
    v_cmp_ne_u32 vcc, 0, v244
    s_nop 1
    s_cmp_eq_u64 vcc, 0
    s_cbranch_scc1 L_kok_16
    s_lshl_b32 s52, s47, 13
    s_lshl_b32 s57, s44, 10
    s_add_u32 s52, s52, s57
    s_add_u32 s52, s52, 4194304
    s_mov_b32 s70, 0
L_kl_15:
    buffer_load_dwordx4 v[124:127], v7, s[8:11], s52 offen sc1
    s_waitcnt vmcnt(0)
    v_xor_b32 v244, v14, v124
    v_and_b32 v244, 0xfff, v244
    v_cmp_ne_u32 vcc, 0, v244
    s_nop 4
    s_cmp_eq_u64 vcc, 0
    s_cbranch_scc1 L_kok_16
    s_add_u32 s70, s70, 1
    s_cmp_lt_u32 s70, 4000
    s_cbranch_scc1 L_kl_15
L_kok_16:
    s_lshr_b32 s52, s44, 2
    s_lshl_b32 s52, s52, 1
    s_and_b32 s53, s44, 1
    s_add_u32 s52, s52, s53
    s_lshl_b32 s52, s52, 10
    s_bfe_u32 s53, s44, 0x10001
    s_lshl_b32 s53, s53, 3
    s_add_u32 s52, s52, s53
    s_add_u32 s52, s52, 159744
    v_cvt_pk_bf16_f32 v124, v124, v125
    v_cvt_pk_bf16_f32 v125, v126, v127
    v_add_u32 v244, s52, v7
    ds_write_b64 v244, v[124:125]
    v_add_u32 v244, 159744, v7
    s_waitcnt lgkmcnt(0)
    s_barrier
    ds_read_b128 v[84:87], v244 offset:0
    ds_read_b128 v[88:91], v244 offset:1024
    ds_read_b128 v[92:95], v244 offset:2048
    ds_read_b128 v[96:99], v244 offset:3072
    s_waitcnt lgkmcnt(3)
    v_mfma_f32_16x16x32_bf16 v[108:111], v[84:87], v[208:211], 0
    s_waitcnt lgkmcnt(2)
    v_mfma_f32_16x16x32_bf16 v[112:115], v[88:91], v[208:211], 0
    v_mov_b32_dpp v100, v88 row_newbcast:12 row_mask:0xf bank_mask:0xf
    v_mov_b32_dpp v101, v89 row_newbcast:12 row_mask:0xf bank_mask:0xf
    v_mov_b32_dpp v102, v90 row_newbcast:12 row_mask:0xf bank_mask:0xf
    v_mov_b32_dpp v103, v91 row_newbcast:12 row_mask:0xf bank_mask:0xf
    s_waitcnt lgkmcnt(0)
    v_mov_b32_dpp v104, v96 row_newbcast:12 row_mask:0xf bank_mask:0xf
    v_mov_b32_dpp v105, v97 row_newbcast:12 row_mask:0xf bank_mask:0xf
    v_mov_b32_dpp v106, v98 row_newbcast:12 row_mask:0xf bank_mask:0xf
    v_mov_b32_dpp v107, v99 row_newbcast:12 row_mask:0xf bank_mask:0xf
    v_mfma_f32_16x16x32_bf16 v[108:111], v[92:95], v[212:215], v[108:111]
    v_mfma_f32_16x16x32_bf16 v[112:115], v[96:99], v[212:215], v[112:115]
    v_mfma_f32_16x16x32_bf16 v[116:119], v[100:103], v[208:211], 0
    v_mfma_f32_16x16x32_bf16 v[116:119], v[104:107], v[212:215], v[116:119]
    s_nop 7
    v_add_f32 v116, 0x358637bd, v116
    v_rcp_f32 v116, v116
    s_nop 0
    v_mul_f32 v108, v116, v108
    v_mul_f32 v109, v116, v109
    v_mul_f32 v110, v116, v110
    v_mul_f32 v111, v116, v111
    v_mul_f32 v112, v116, v112
    v_mul_f32 v113, v116, v113
    v_mul_f32 v114, v116, v114
    v_mul_f32 v115, v116, v115
    v_cvt_pk_bf16_f32 v120, v108, v109
    v_cvt_pk_bf16_f32 v121, v110, v111
    v_cvt_pk_bf16_f32 v122, v112, v113
    v_cvt_pk_bf16_f32 v123, v114, v115
    v_cndmask_b32 v122, v122, v15, s[62:63]
    v_cndmask_b32 v123, v123, v15, s[62:63]
    s_lshl_b32 s52, s46, 17
    s_lshl_b32 s57, s45, 15
    s_add_u32 s52, s52, s57
    s_lshl_b32 s57, s47, 10
    s_add_u32 s52, s52, s57
    s_add_u32 s52, s52, 12582912
    buffer_store_dwordx4 v[120:123], v7, s[8:11], s52 offen sc1
    s_waitcnt vmcnt(1)
    s_lshl_b32 s52, s46, 9
    s_lshl_b32 s57, s47, 5
    s_add_u32 s52, s52, s57
    s_lshl_b32 s57, s44, 2
    s_add_u32 s52, s52, s57
    s_add_u32 s52, s52, 172032
    s_mov_b64 exec, 1
    s_cmp_eq_u32 s49, 0
    s_cbranch_scc1 L_slow_17
    buffer_store_dword v14, v15, s[8:11], s52 offen
    s_branch L_mdone_18
L_slow_17:
    buffer_store_dword v14, v15, s[8:11], s52 offen sc1
L_mdone_18:
    s_mov_b64 exec, -1
    s_waitcnt vmcnt(1)
    s_lshl_b32 s52, s46, 9
    s_lshl_b32 s57, s47, 5
    s_add_u32 s52, s52, s57
    s_lshl_b32 s57, s44, 2
    s_add_u32 s52, s52, s57
    s_add_u32 s52, s52, 163840
    s_mov_b64 exec, 1
    s_cmp_eq_u32 s49, 0
    s_cbranch_scc1 L_slow_19
    buffer_store_dword v14, v15, s[8:11], s52 offen
    s_branch L_mdone_20
L_slow_19:
    buffer_store_dword v14, v15, s[8:11], s52 offen sc1
L_mdone_20:
    s_mov_b64 exec, -1
    s_barrier
    v_mov_b32 v52, 0
    v_mov_b32 v53, 0
    v_mov_b32 v54, 0
    v_mov_b32 v55, 0
    v_mov_b32 v56, 0
    v_mov_b32 v57, 0
    v_mov_b32 v58, 0
    v_mov_b32 v59, 0
    v_mov_b32 v60, 0
    v_mov_b32 v61, 0
    v_mov_b32 v62, 0
    v_mov_b32 v63, 0
    v_mov_b32 v64, 0
    v_mov_b32 v65, 0
    v_mov_b32 v66, 0
    v_mov_b32 v67, 0
    v_add_u32 v100, 0x20000, v8
    v_add_u32 v101, 0x20000, v9
    v_add_u32 v102, 0x20000, v10
    v_add_u32 v103, 0x20000, v11
    ds_write_b128 v222, v[148:151] offset:2048
    ds_write_b128 v222, v[156:159] offset:3072
    ds_read_b64_tr_b16 v[164:165], v100 offset:0
    ds_read_b64_tr_b16 v[166:167], v100 offset:2048
    ds_read_b64_tr_b16 v[168:169], v101 offset:0
    ds_read_b64_tr_b16 v[170:171], v101 offset:2048
    ds_read_b64_tr_b16 v[172:173], v102 offset:0
    ds_read_b64_tr_b16 v[174:175], v102 offset:2048
    ds_read_b64_tr_b16 v[176:177], v103 offset:0
    ds_read_b64_tr_b16 v[178:179], v103 offset:2048
    s_mov_b32 s52, 0
    s_mov_b32 exec_lo, 1023
    s_mov_b32 exec_hi, 0
    s_mov_b32 s70, 0
L_poll_21:
    buffer_load_dword v254, v230, s[8:11], s52 offen sc1
    s_waitcnt vmcnt(0)
    v_cmp_ne_u32 vcc, s48, v254
    s_nop 4
    s_cmp_eq_u64 vcc, 0
    s_cbranch_scc1 L_polld_22
    s_add_u32 s70, s70, 1
    s_cmp_lt_u32 s70, 4000
    s_cbranch_scc1 L_poll_21
L_polld_22:
    s_mov_b64 exec, -1
    buffer_load_dwordx4 v[20:23], v7, s[8:11], s68 offen offset:0 sc1
    buffer_load_dwordx4 v[24:27], v7, s[8:11], s68 offen offset:1024 sc1
    buffer_load_dwordx4 v[28:31], v7, s[8:11], s68 offen offset:2048 sc1
    buffer_load_dwordx4 v[32:35], v7, s[8:11], s68 offen offset:3072 sc1
    s_add_u32 s68, s68, 4096
    buffer_load_dwordx4 v[36:39], v7, s[8:11], s68 offen offset:0 sc1
    buffer_load_dwordx4 v[40:43], v7, s[8:11], s68 offen offset:1024 sc1
    buffer_load_dwordx4 v[44:47], v7, s[8:11], s68 offen offset:2048 sc1
    buffer_load_dwordx4 v[48:51], v7, s[8:11], s68 offen offset:3072 sc1
    buffer_load_dwordx4 v[68:71], v7, s[8:11], s69 offen offset:0 sc1
    buffer_load_dwordx4 v[72:75], v7, s[8:11], s69 offen offset:1024 sc1
    s_add_u32 s69, s69, 16384
    buffer_load_dwordx4 v[76:79], v7, s[8:11], s69 offen offset:0 sc1
    buffer_load_dwordx4 v[80:83], v7, s[8:11], s69 offen offset:1024 sc1
    s_waitcnt vmcnt(11) lgkmcnt(6)
    v_mfma_f32_16x16x32_bf16 v[52:55], v[164:167], v[20:23], v[52:55]
    ds_read_b64_tr_b16 v[180:181], v100 offset:4096
    s_waitcnt lgkmcnt(5)
    v_mfma_f32_16x16x32_bf16 v[56:59], v[168:171], v[20:23], v[56:59]
    ds_read_b64_tr_b16 v[182:183], v100 offset:6144
    s_waitcnt lgkmcnt(4)
    v_mfma_f32_16x16x32_bf16 v[60:63], v[172:175], v[20:23], v[60:63]
    ds_read_b64_tr_b16 v[184:185], v101 offset:4096
    s_waitcnt lgkmcnt(3)
    v_mfma_f32_16x16x32_bf16 v[64:67], v[176:179], v[20:23], v[64:67]
    ds_read_b64_tr_b16 v[186:187], v101 offset:6144
    ds_read_b64_tr_b16 v[188:189], v102 offset:4096
    ds_read_b64_tr_b16 v[190:191], v102 offset:6144
    ds_read_b64_tr_b16 v[192:193], v103 offset:4096
    ds_read_b64_tr_b16 v[194:195], v103 offset:6144
    s_waitcnt vmcnt(10) lgkmcnt(6)
    v_mfma_f32_16x16x32_bf16 v[52:55], v[180:183], v[24:27], v[52:55]
    ds_read_b64_tr_b16 v[164:165], v100 offset:8192
    s_waitcnt lgkmcnt(5)
    v_mfma_f32_16x16x32_bf16 v[56:59], v[184:187], v[24:27], v[56:59]
    ds_read_b64_tr_b16 v[166:167], v100 offset:10240
    s_waitcnt lgkmcnt(4)
    v_mfma_f32_16x16x32_bf16 v[60:63], v[188:191], v[24:27], v[60:63]
    ds_read_b64_tr_b16 v[168:169], v101 offset:8192
    s_waitcnt lgkmcnt(3)
    v_mfma_f32_16x16x32_bf16 v[64:67], v[192:195], v[24:27], v[64:67]
    ds_read_b64_tr_b16 v[170:171], v101 offset:10240
    ds_read_b64_tr_b16 v[172:173], v102 offset:8192
    ds_read_b64_tr_b16 v[174:175], v102 offset:10240
    ds_read_b64_tr_b16 v[176:177], v103 offset:8192
    ds_read_b64_tr_b16 v[178:179], v103 offset:10240
    s_waitcnt vmcnt(9) lgkmcnt(6)
    v_mfma_f32_16x16x32_bf16 v[52:55], v[164:167], v[28:31], v[52:55]
    ds_read_b64_tr_b16 v[180:181], v100 offset:12288
    s_waitcnt lgkmcnt(5)
    v_mfma_f32_16x16x32_bf16 v[56:59], v[168:171], v[28:31], v[56:59]
    ds_read_b64_tr_b16 v[182:183], v100 offset:14336
    s_waitcnt lgkmcnt(4)
    v_mfma_f32_16x16x32_bf16 v[60:63], v[172:175], v[28:31], v[60:63]
    ds_read_b64_tr_b16 v[184:185], v101 offset:12288
    s_waitcnt lgkmcnt(3)
    v_mfma_f32_16x16x32_bf16 v[64:67], v[176:179], v[28:31], v[64:67]
    ds_read_b64_tr_b16 v[186:187], v101 offset:14336
    ds_read_b64_tr_b16 v[188:189], v102 offset:12288
    ds_read_b64_tr_b16 v[190:191], v102 offset:14336
    ds_read_b64_tr_b16 v[192:193], v103 offset:12288
    ds_read_b64_tr_b16 v[194:195], v103 offset:14336
    s_waitcnt vmcnt(8) lgkmcnt(6)
    v_mfma_f32_16x16x32_bf16 v[52:55], v[180:183], v[32:35], v[52:55]
    ds_read_b64_tr_b16 v[164:165], v216 offset:0
    s_waitcnt lgkmcnt(5)
    v_mfma_f32_16x16x32_bf16 v[56:59], v[184:187], v[32:35], v[56:59]
    ds_read_b64_tr_b16 v[166:167], v216 offset:2048
    s_waitcnt lgkmcnt(4)
    v_mfma_f32_16x16x32_bf16 v[60:63], v[188:191], v[32:35], v[60:63]
    ds_read_b64_tr_b16 v[168:169], v217 offset:0
    s_waitcnt lgkmcnt(3)
    v_mfma_f32_16x16x32_bf16 v[64:67], v[192:195], v[32:35], v[64:67]
    ds_read_b64_tr_b16 v[170:171], v217 offset:2048
    ds_read_b64_tr_b16 v[172:173], v218 offset:0
    ds_read_b64_tr_b16 v[174:175], v218 offset:2048
    ds_read_b64_tr_b16 v[176:177], v219 offset:0
    ds_read_b64_tr_b16 v[178:179], v219 offset:2048
    s_waitcnt vmcnt(7) lgkmcnt(6)
    v_mfma_f32_16x16x32_bf16 v[52:55], v[164:167], v[36:39], v[52:55]
    ds_read_b64_tr_b16 v[180:181], v216 offset:4096
    s_waitcnt lgkmcnt(5)
    v_mfma_f32_16x16x32_bf16 v[56:59], v[168:171], v[36:39], v[56:59]
    ds_read_b64_tr_b16 v[182:183], v216 offset:6144
    s_waitcnt lgkmcnt(4)
    v_mfma_f32_16x16x32_bf16 v[60:63], v[172:175], v[36:39], v[60:63]
    ds_read_b64_tr_b16 v[184:185], v217 offset:4096
    s_waitcnt lgkmcnt(3)
    v_mfma_f32_16x16x32_bf16 v[64:67], v[176:179], v[36:39], v[64:67]
    ds_read_b64_tr_b16 v[186:187], v217 offset:6144
    ds_read_b64_tr_b16 v[188:189], v218 offset:4096
    ds_read_b64_tr_b16 v[190:191], v218 offset:6144
    ds_read_b64_tr_b16 v[192:193], v219 offset:4096
    ds_read_b64_tr_b16 v[194:195], v219 offset:6144
    s_waitcnt vmcnt(6) lgkmcnt(6)
    v_mfma_f32_16x16x32_bf16 v[52:55], v[180:183], v[40:43], v[52:55]
    ds_read_b64_tr_b16 v[164:165], v216 offset:8192
    s_waitcnt lgkmcnt(5)
    v_mfma_f32_16x16x32_bf16 v[56:59], v[184:187], v[40:43], v[56:59]
    ds_read_b64_tr_b16 v[166:167], v216 offset:10240
    s_waitcnt lgkmcnt(4)
    v_mfma_f32_16x16x32_bf16 v[60:63], v[188:191], v[40:43], v[60:63]
    ds_read_b64_tr_b16 v[168:169], v217 offset:8192
    s_waitcnt lgkmcnt(3)
    v_mfma_f32_16x16x32_bf16 v[64:67], v[192:195], v[40:43], v[64:67]
    ds_read_b64_tr_b16 v[170:171], v217 offset:10240
    ds_read_b64_tr_b16 v[172:173], v218 offset:8192
    ds_read_b64_tr_b16 v[174:175], v218 offset:10240
    ds_read_b64_tr_b16 v[176:177], v219 offset:8192
    ds_read_b64_tr_b16 v[178:179], v219 offset:10240
    s_waitcnt vmcnt(5) lgkmcnt(6)
    v_mfma_f32_16x16x32_bf16 v[52:55], v[164:167], v[44:47], v[52:55]
    ds_read_b64_tr_b16 v[180:181], v216 offset:12288
    s_waitcnt lgkmcnt(5)
    v_mfma_f32_16x16x32_bf16 v[56:59], v[168:171], v[44:47], v[56:59]
    ds_read_b64_tr_b16 v[182:183], v216 offset:14336
    s_waitcnt lgkmcnt(4)
    v_mfma_f32_16x16x32_bf16 v[60:63], v[172:175], v[44:47], v[60:63]
    ds_read_b64_tr_b16 v[184:185], v217 offset:12288
    s_waitcnt lgkmcnt(3)
    v_mfma_f32_16x16x32_bf16 v[64:67], v[176:179], v[44:47], v[64:67]
    ds_read_b64_tr_b16 v[186:187], v217 offset:14336
    ds_read_b64_tr_b16 v[188:189], v218 offset:12288
    ds_read_b64_tr_b16 v[190:191], v218 offset:14336
    ds_read_b64_tr_b16 v[192:193], v219 offset:12288
    ds_read_b64_tr_b16 v[194:195], v219 offset:14336
    s_waitcnt vmcnt(4) lgkmcnt(6)
    v_mfma_f32_16x16x32_bf16 v[52:55], v[180:183], v[48:51], v[52:55]
    s_waitcnt lgkmcnt(4)
    v_mfma_f32_16x16x32_bf16 v[56:59], v[184:187], v[48:51], v[56:59]
    s_waitcnt lgkmcnt(2)
    v_mfma_f32_16x16x32_bf16 v[60:63], v[188:191], v[48:51], v[60:63]
    s_waitcnt lgkmcnt(0)
    v_mfma_f32_16x16x32_bf16 v[64:67], v[192:195], v[48:51], v[64:67]
    s_waitcnt vmcnt(1)
    v_add_f32 v68, v68, v76
    v_add_f32 v69, v69, v77
    v_add_f32 v70, v70, v78
    v_add_f32 v71, v71, v79
    v_add_f32 v132, v132, v68
    v_add_f32 v133, v133, v69
    v_add_f32 v134, v134, v70
    v_add_f32 v135, v135, v71
    s_waitcnt vmcnt(0)
    v_add_f32 v72, v72, v80
    v_add_f32 v73, v73, v81
    v_add_f32 v74, v74, v82
    v_add_f32 v75, v75, v83
    v_add_f32 v140, v140, v72
    v_add_f32 v141, v141, v73
    v_add_f32 v142, v142, v74
    v_add_f32 v143, v143, v75
    ds_write_b128 v222, v[60:63] offset:0
    ds_write_b128 v222, v[64:67] offset:1024
    s_waitcnt lgkmcnt(0)
    s_barrier
    ds_read_b128 v[164:167], v223 offset:0
    ds_read_b128 v[168:171], v223 offset:1024
    ds_read_b128 v[172:175], v223 offset:2048
    ds_read_b128 v[176:179], v223 offset:3072
    ds_read_b64 v[232:233], v224
    ds_read_b64 v[234:235], v225
    v_lshlrev_b32 v236, 16, v196
    v_and_b32 v237, 0xffff0000, v196
    v_lshlrev_b32 v238, 16, v197
    v_and_b32 v239, 0xffff0000, v197
    v_add_f32 v132, v132, v236
    v_add_f32 v133, v133, v237
    v_add_f32 v134, v134, v238
    v_add_f32 v135, v135, v239
    s_waitcnt lgkmcnt(3)
    v_add_f32 v132, v132, v172
    v_add_f32 v133, v133, v173
    v_add_f32 v134, v134, v174
    v_add_f32 v135, v135, v175
    v_mul_f32 v68, 0xbfb8aa3b, v132
    v_mul_f32 v69, 0xbfb8aa3b, v133
    v_mul_f32 v70, 0xbfb8aa3b, v134
    v_mul_f32 v71, 0xbfb8aa3b, v135
    v_exp_f32 v68, v68
    v_exp_f32 v69, v69
    v_exp_f32 v70, v70
    v_exp_f32 v71, v71
    v_add_f32 v52, v52, v164
    v_add_f32 v53, v53, v165
    v_add_f32 v54, v54, v166
    v_add_f32 v55, v55, v167
    s_waitcnt lgkmcnt(1)
    v_lshlrev_b32 v240, 16, v232
    v_and_b32 v241, 0xffff0000, v232
    v_lshlrev_b32 v242, 16, v233
    v_and_b32 v243, 0xffff0000, v233
    v_add_f32 v68, 1.0, v68
    v_add_f32 v69, 1.0, v69
    v_add_f32 v70, 1.0, v70
    v_add_f32 v71, 1.0, v71
    v_rcp_f32 v68, v68
    v_rcp_f32 v69, v69
    v_rcp_f32 v70, v70
    v_rcp_f32 v71, v71
    v_mul_f32 v132, v132, v52
    v_mul_f32 v133, v133, v53
    v_mul_f32 v134, v134, v54
    v_mul_f32 v135, v135, v55
    v_fma_f32 v132, v68, v132, v240
    v_fma_f32 v133, v69, v133, v241
    v_fma_f32 v134, v70, v134, v242
    v_fma_f32 v135, v71, v135, v243
    v_cvt_pk_bf16_f32 v232, v132, v133
    v_cvt_pk_bf16_f32 v233, v134, v135
    ds_write_b64 v224, v[232:233]
    v_lshlrev_b32 v236, 16, v198
    v_and_b32 v237, 0xffff0000, v198
    v_lshlrev_b32 v238, 16, v199
    v_and_b32 v239, 0xffff0000, v199
    v_add_f32 v140, v140, v236
    v_add_f32 v141, v141, v237
    v_add_f32 v142, v142, v238
    v_add_f32 v143, v143, v239
    v_add_f32 v140, v140, v176
    v_add_f32 v141, v141, v177
    v_add_f32 v142, v142, v178
    v_add_f32 v143, v143, v179
    v_mul_f32 v72, 0xbfb8aa3b, v140
    v_mul_f32 v73, 0xbfb8aa3b, v141
    v_mul_f32 v74, 0xbfb8aa3b, v142
    v_mul_f32 v75, 0xbfb8aa3b, v143
    v_exp_f32 v72, v72
    v_exp_f32 v73, v73
    v_exp_f32 v74, v74
    v_exp_f32 v75, v75
    v_add_f32 v56, v56, v168
    v_add_f32 v57, v57, v169
    v_add_f32 v58, v58, v170
    v_add_f32 v59, v59, v171
    s_waitcnt lgkmcnt(1)
    v_lshlrev_b32 v240, 16, v234
    v_and_b32 v241, 0xffff0000, v234
    v_lshlrev_b32 v242, 16, v235
    v_and_b32 v243, 0xffff0000, v235
    v_add_f32 v72, 1.0, v72
    v_add_f32 v73, 1.0, v73
    v_add_f32 v74, 1.0, v74
    v_add_f32 v75, 1.0, v75
    v_rcp_f32 v72, v72
    v_rcp_f32 v73, v73
    v_rcp_f32 v74, v74
    v_rcp_f32 v75, v75
    v_mul_f32 v140, v140, v56
    v_mul_f32 v141, v141, v57
    v_mul_f32 v142, v142, v58
    v_mul_f32 v143, v143, v59
    v_fma_f32 v140, v72, v140, v240
    v_fma_f32 v141, v73, v141, v241
    v_fma_f32 v142, v74, v142, v242
    v_fma_f32 v143, v75, v143, v243
    v_cvt_pk_bf16_f32 v234, v140, v141
    v_cvt_pk_bf16_f32 v235, v142, v143
    ds_write_b64 v225, v[234:235]
    s_waitcnt lgkmcnt(0)
    s_barrier
    s_add_u32 s52, s59, 147456
    v_add_u32 v222, s52, v7
    ds_read_b128 v[236:239], v222
    s_waitcnt lgkmcnt(0)
    buffer_store_dwordx4 v[236:239], v4, s[28:31], 0 offen sc1
    s_or_b32 s52, s61, s44
    s_cmp_lg_u32 s52, 0
    s_cbranch_scc1 L_nobump_23
    s_add_u32 s52, s60, 64
    v_mov_b32 v222, s52
    s_mov_b64 exec, 1
    buffer_store_dword v222, v15, s[8:11], 0 offen sc1
    s_mov_b64 exec, -1
L_nobump_23:
    s_endpgm
L_ffnB:
    s_mul_i32 s2, s75, 688128
    s_add_u32 s2, s2, 0
    s_add_u32 m0, s58, 49152
    s_nop 0
    buffer_load_dwordx4 v6, s[12:15], s2 offen lds
    s_add_u32 s2, s2, 14336
    s_add_u32 m0, s58, 50176
    s_nop 0
    buffer_load_dwordx4 v6, s[12:15], s2 offen lds
    s_mul_i32 s2, s75, 384
    s_add_u32 s2, s2, 128
    s_add_u32 m0, s58, 16384
    s_nop 0
    buffer_load_dwordx4 v4, s[4:7], s2 offen lds
    s_add_u32 m0, s58, 17408
    s_nop 0
    buffer_load_dwordx4 v5, s[4:7], s2 offen lds
    s_mul_i32 s2, s75, 688128
    s_add_u32 s2, s2, 229376
    s_add_u32 m0, s58, 65536
    s_nop 0
    buffer_load_dwordx4 v6, s[12:15], s2 offen lds
    s_add_u32 s2, s2, 14336
    s_add_u32 m0, s58, 66560
    s_nop 0
    buffer_load_dwordx4 v6, s[12:15], s2 offen lds
    s_cmp_ge_u32 s47, 7
    s_cselect_b32 s50, 1, 0
    s_mul_i32 s52, s50, 7
    s_sub_u32 s51, s47, s52
    s_mul_i32 s3, s50, 802816
    s_mov_b32 s49, 0
    s_getreg_b32 s71, hwreg(HW_REG_XCC_ID)
    s_and_b32 s71, s71, 15
    v_mov_b32 v15, 0
    s_movk_i32 s74, 0xfff
    v_mov_b32 v16, 0x3f803f80
    v_mov_b32 v17, 0x3f803f80
    v_mov_b32 v18, 0x3f803f80
    v_mov_b32 v19, 0x3f803f80
    v_cmp_eq_u32 s[62:63], 3, v3
    v_cmp_le_u32 s[64:65], 12, v2
    s_mul_i32 s52, s47, 1568
    s_lshl_b32 s53, s44, 8
    s_add_u32 s52, s52, s53
    s_add_u32 m0, s53, 155648
    s_mov_b64 exec, 0xffff
    buffer_load_dwordx4 v7, s[32:35], s52 offen lds
    s_mov_b64 exec, -1
    v_lshrrev_b32 v222, 1, v2
    v_xor_b32 v222, v222, v3
    v_lshlrev_b32 v223, 7, v2
    s_lshl_b32 s52, s45, 12
    v_add_u32 v223, s52, v223
    v_lshl_add_u32 v12, v222, 4, v223
    v_xor_b32 v222, 4, v222
    v_lshl_add_u32 v13, v222, 4, v223
    v_add_u32 v220, 0x10000, v12
    v_add_u32 v221, 0x10000, v13
    v_lshrrev_b32 v222, 2, v2
    v_lshl_add_u32 v223, v3, 3, v222
    v_lshlrev_b32 v223, 8, v223
    v_and_b32 v224, 3, v1
    v_lshl_add_u32 v223, v224, 3, v223
    v_and_b32 v224, 1, v3
    v_lshl_or_b32 v222, v224, 2, v222
    s_xor_b32 s52, s45, 0
    s_add_u32 s52, s52, 4
    v_xor_b32 v224, s52, v222
    v_lshl_add_u32 v8, v224, 5, v223
    v_add_u32 v216, 0x10000, v8
    s_xor_b32 s52, s45, 1
    s_add_u32 s52, s52, 4
    v_xor_b32 v224, s52, v222
    v_lshl_add_u32 v9, v224, 5, v223
    v_add_u32 v217, 0x10000, v9
    s_xor_b32 s52, s45, 2
    s_add_u32 s52, s52, 4
    v_xor_b32 v224, s52, v222
    v_lshl_add_u32 v10, v224, 5, v223
    v_add_u32 v218, 0x10000, v10
    s_xor_b32 s52, s45, 3
    s_add_u32 s52, s52, 4
    v_xor_b32 v224, s52, v222
    v_lshl_add_u32 v11, v224, 5, v223
    v_add_u32 v219, 0x10000, v11
    v_and_b32 v222, 7, v1
    v_lshrrev_b32 v222, 1, v222
    v_xor_b32 v222, v222, v3
    v_and_b32 v223, 1, v1
    v_lshl_add_u32 v222, v222, 1, v223
    v_lshlrev_b32 v222, 4, v222
    s_lshl_b32 s52, s51, 7
    v_add_u32 v222, s52, v222
    v_lshrrev_b32 v223, 3, v1
    s_lshl_b32 s52, s44, 3
    v_add_u32 v223, s52, v223
    v_mul_u32_u24 v224, 896, v223
    v_add_u32 v252, v224, v222
    v_lshrrev_b32 v224, 5, v223
    v_lshlrev_b32 v224, 2, v224
    v_sub_u32 v224, v223, v224
    v_mul_u32_u24 v224, 896, v224
    v_add_u32 v253, v224, v222
    v_mov_b32 v132, 0
    v_mov_b32 v133, 0
    v_mov_b32 v134, 0
    v_mov_b32 v135, 0
    v_mov_b32 v136, 0
    v_mov_b32 v137, 0
    v_mov_b32 v138, 0
    v_mov_b32 v139, 0
    v_mov_b32 v140, 0
    v_mov_b32 v141, 0
    v_mov_b32 v142, 0
    v_mov_b32 v143, 0
    v_mov_b32 v144, 0
    v_mov_b32 v145, 0
    v_mov_b32 v146, 0
    v_mov_b32 v147, 0
    v_mov_b32 v148, 0
    v_mov_b32 v149, 0
    v_mov_b32 v150, 0
    v_mov_b32 v151, 0
    v_mov_b32 v152, 0
    v_mov_b32 v153, 0
    v_mov_b32 v154, 0
    v_mov_b32 v155, 0
    v_mov_b32 v156, 0
    v_mov_b32 v157, 0
    v_mov_b32 v158, 0
    v_mov_b32 v159, 0
    v_mov_b32 v160, 0
    v_mov_b32 v161, 0
    v_mov_b32 v162, 0
    v_mov_b32 v163, 0
    v_mov_b32 v196, 0
    v_mov_b32 v197, 0
    v_mov_b32 v198, 0
    v_mov_b32 v199, 0
    v_mov_b32 v200, 0
    v_mov_b32 v201, 0
    v_mov_b32 v202, 0
    v_mov_b32 v203, 0
    v_mov_b32 v204, 0
    v_mov_b32 v205, 0
    v_mov_b32 v206, 0
    v_mov_b32 v207, 0
    s_cmp_ge_u32 s44, 6
    s_cselect_b32 s52, 2, 0
    s_sub_u32 s52, s44, s52
    s_lshr_b32 s53, s52, 1
    s_and_b32 s54, s52, 1
    v_lshrrev_b32 v222, 2, v2
    v_lshl_add_u32 v222, v3, 3, v222
    v_mul_u32_u24 v222, 176, v222
    v_and_b32 v223, 3, v1
    v_lshl_add_u32 v222, v223, 3, v222
    s_mul_i32 s55, s53, 56
    s_lshl_b32 s56, s54, 5
    s_add_u32 s55, s55, s56
    s_add_u32 s55, s55, 131072
    v_add_u32 v222, s55, v222
    s_and_b32 s55, s61, 15
    s_mul_i32 s55, s55, 3
    s_add_u32 s55, s55, s53
    s_and_b32 s56, s55, 15
    s_lshr_b32 s55, s55, 4
    s_add_u32 s55, s55, 2
    s_cmp_ge_u32 s55, 3
    s_cselect_b32 s57, 3, 0
    s_sub_u32 s55, s55, s57
    s_mul_i32 s56, s56, 3
    s_add_u32 s56, s56, s55
    s_lshl_b32 s56, s56, 1
    s_add_u32 s56, s56, s54
    s_mul_i32 s56, s56, 14336
    s_lshr_b32 s55, s61, 4
    s_lshl_b32 s57, s55, 10
    s_add_u32 s56, s56, s57
    s_add_u32 s56, s56, 262144
    s_cmp_ge_u32 s55, 14
    s_cselect_b32 s57, 1073741824, 0
    s_add_u32 s56, s56, s57
    s_waitcnt vmcnt(9)
    s_waitcnt lgkmcnt(0)
    s_add_u32 s48, s60, 0x9e3779b9
    v_mov_b32 v14, s48
    s_barrier
    ds_read_b64_tr_b16 v[226:227], v222
    ds_read_b64_tr_b16 v[228:229], v222 offset:704
    s_waitcnt lgkmcnt(0)
    buffer_store_dwordx4 v[226:229], v7, s[8:11], s56 offen sc1
    s_mul_i32 s2, s75, 688128
    s_add_u32 s2, s2, 458752
    s_add_u32 m0, s58, 81920
    s_nop 0
    buffer_load_dwordx4 v6, s[12:15], s2 offen lds
    s_add_u32 s2, s2, 14336
    s_add_u32 m0, s58, 82944
    s_nop 0
    buffer_load_dwordx4 v6, s[12:15], s2 offen lds
    s_mul_i32 s2, s75, 384
    s_add_u32 s2, s2, 256
    s_add_u32 m0, s58, 32768
    s_nop 0
    buffer_load_dwordx4 v4, s[4:7], s2 offen lds
    s_add_u32 m0, s58, 33792
    s_nop 0
    buffer_load_dwordx4 v5, s[4:7], s2 offen lds
    s_cmp_lg_u32 s45, 3
    s_cbranch_scc1 L_nw_24
    v_lshlrev_b32 v238, 7, v1
    s_lshl_b32 s52, s61, 13
    buffer_load_dword v249, v238, s[16:19], s52 offen
    s_sub_u32 s52, s52, 1605632
    s_cselect_b32 s52, 1073741824, s52
    buffer_load_dword v249, v238, s[20:23], s52 offen
L_nw_24:
    s_cmp_lg_u32 s45, 2
    s_cbranch_scc1 L_nw_25
    v_lshlrev_b32 v238, 7, v1
    s_lshl_b32 s52, s61, 13
    buffer_load_dword v249, v238, s[12:15], s52 offen
    s_sub_u32 s52, s52, 1605632
    s_cselect_b32 s52, 1073741824, s52
    buffer_load_dword v249, v238, s[36:39], s52 offen
    buffer_load_dword v249, v238, s[40:43], s52 offen
    buffer_load_dword v249, v238, s[32:35], s52 offen
L_nw_25:
    s_waitcnt vmcnt(10)
    s_barrier
    ds_read_b128 v[20:23], v12 offset:0
    ds_read_b64_tr_b16 v[164:165], v8 offset:49152
    ds_read_b64_tr_b16 v[166:167], v8 offset:50176
    ds_read_b128 v[24:27], v12 offset:2048
    ds_read_b64_tr_b16 v[168:169], v9 offset:49152
    ds_read_b64_tr_b16 v[170:171], v9 offset:50176
    ds_read_b64_tr_b16 v[172:173], v10 offset:49152
    ds_read_b64_tr_b16 v[174:175], v10 offset:50176
    ds_read_b64_tr_b16 v[176:177], v11 offset:49152
    ds_read_b64_tr_b16 v[178:179], v11 offset:50176
    s_waitcnt lgkmcnt(7)
    v_mfma_f32_16x16x32_bf16 v[132:135], v[164:167], v[20:23], v[132:135]
    ds_read_b128 v[28:31], v13 offset:0
    s_waitcnt lgkmcnt(7)
    v_mfma_f32_16x16x32_bf16 v[136:139], v[164:167], v[24:27], v[136:139]
    ds_read_b64_tr_b16 v[180:181], v8 offset:57344
    s_waitcnt lgkmcnt(6)
    v_mfma_f32_16x16x32_bf16 v[140:143], v[168:171], v[20:23], v[140:143]
    ds_read_b64_tr_b16 v[182:183], v8 offset:58368
    v_mfma_f32_16x16x32_bf16 v[144:147], v[168:171], v[24:27], v[144:147]
    ds_read_b128 v[32:35], v13 offset:2048
    s_mul_i32 s2, s75, 688128
    s_add_u32 s2, s2, 688128
    s_add_u32 m0, s58, 98304
    s_nop 0
    buffer_load_dwordx4 v6, s[12:15], s2 offen lds
    s_waitcnt lgkmcnt(6)
    v_mfma_f32_16x16x32_bf16 v[148:151], v[172:175], v[20:23], v[148:151]
    ds_read_b64_tr_b16 v[184:185], v9 offset:57344
    v_mfma_f32_16x16x32_bf16 v[152:155], v[172:175], v[24:27], v[152:155]
    ds_read_b64_tr_b16 v[186:187], v9 offset:58368
    s_waitcnt lgkmcnt(6)
    v_mfma_f32_16x16x32_bf16 v[156:159], v[176:179], v[20:23], v[156:159]
    ds_read_b64_tr_b16 v[188:189], v10 offset:57344
    v_mfma_f32_16x16x32_bf16 v[160:163], v[176:179], v[24:27], v[160:163]
    ds_read_b64_tr_b16 v[190:191], v10 offset:58368
    s_add_u32 s2, s2, 14336
    s_add_u32 m0, s58, 99328
    s_nop 0
    buffer_load_dwordx4 v6, s[12:15], s2 offen lds
    v_mfma_f32_16x16x32_bf16 v[196:199], v[164:167], v[16:19], v[196:199]
    ds_read_b64_tr_b16 v[192:193], v11 offset:57344
    v_mfma_f32_16x16x32_bf16 v[200:203], v[16:19], v[24:27], v[200:203]
    ds_read_b64_tr_b16 v[194:195], v11 offset:58368
    v_mfma_f32_16x16x32_bf16 v[204:207], v[24:27], v[24:27], v[204:207]
    s_waitcnt vmcnt(8)
    s_barrier
    s_waitcnt lgkmcnt(7)
    v_mfma_f32_16x16x32_bf16 v[132:135], v[180:183], v[28:31], v[132:135]
    ds_read_b128 v[36:39], v12 offset:16384
    s_waitcnt lgkmcnt(7)
    v_mfma_f32_16x16x32_bf16 v[136:139], v[180:183], v[32:35], v[136:139]
    ds_read_b64_tr_b16 v[164:165], v216 offset:0
    s_waitcnt lgkmcnt(6)
    v_mfma_f32_16x16x32_bf16 v[140:143], v[184:187], v[28:31], v[140:143]
    ds_read_b64_tr_b16 v[166:167], v216 offset:1024
    v_mfma_f32_16x16x32_bf16 v[144:147], v[184:187], v[32:35], v[144:147]
    ds_read_b128 v[40:43], v12 offset:18432
    s_mul_i32 s2, s75, 4294049792
    s_add_u32 s2, s2, 917504
    s_add_u32 m0, s58, 114688
    s_nop 0
    buffer_load_dwordx4 v6, s[12:15], s2 offen lds
    s_waitcnt lgkmcnt(6)
    v_mfma_f32_16x16x32_bf16 v[148:151], v[188:191], v[28:31], v[148:151]
    ds_read_b64_tr_b16 v[168:169], v217 offset:0
    v_mfma_f32_16x16x32_bf16 v[152:155], v[188:191], v[32:35], v[152:155]
    ds_read_b64_tr_b16 v[170:171], v217 offset:1024
    s_waitcnt lgkmcnt(6)
    v_mfma_f32_16x16x32_bf16 v[156:159], v[192:195], v[28:31], v[156:159]
    ds_read_b64_tr_b16 v[172:173], v218 offset:0
    v_mfma_f32_16x16x32_bf16 v[160:163], v[192:195], v[32:35], v[160:163]
    ds_read_b64_tr_b16 v[174:175], v218 offset:1024
    s_add_u32 s2, s2, 14336
    s_add_u32 m0, s58, 115712
    s_nop 0
    buffer_load_dwordx4 v6, s[12:15], s2 offen lds
    v_mfma_f32_16x16x32_bf16 v[196:199], v[180:183], v[16:19], v[196:199]
    ds_read_b64_tr_b16 v[176:177], v219 offset:0
    v_mfma_f32_16x16x32_bf16 v[200:203], v[16:19], v[32:35], v[200:203]
    ds_read_b64_tr_b16 v[178:179], v219 offset:1024
    v_mfma_f32_16x16x32_bf16 v[204:207], v[32:35], v[32:35], v[204:207]
    s_waitcnt lgkmcnt(7)
    v_mfma_f32_16x16x32_bf16 v[132:135], v[164:167], v[36:39], v[132:135]
    ds_read_b128 v[44:47], v13 offset:16384
    s_waitcnt lgkmcnt(7)
    v_mfma_f32_16x16x32_bf16 v[136:139], v[164:167], v[40:43], v[136:139]
    ds_read_b64_tr_b16 v[180:181], v216 offset:8192
    s_waitcnt lgkmcnt(6)
    v_mfma_f32_16x16x32_bf16 v[140:143], v[168:171], v[36:39], v[140:143]
    ds_read_b64_tr_b16 v[182:183], v216 offset:9216
    v_mfma_f32_16x16x32_bf16 v[144:147], v[168:171], v[40:43], v[144:147]
    ds_read_b128 v[48:51], v13 offset:18432
    s_mul_i32 s2, s75, 384
    s_add_u32 s2, s2, 384
    s_add_u32 m0, s58, 0
    s_nop 0
    buffer_load_dwordx4 v4, s[4:7], s2 offen lds
    s_waitcnt lgkmcnt(6)
    v_mfma_f32_16x16x32_bf16 v[148:151], v[172:175], v[36:39], v[148:151]
    ds_read_b64_tr_b16 v[184:185], v217 offset:8192
    v_mfma_f32_16x16x32_bf16 v[152:155], v[172:175], v[40:43], v[152:155]
    ds_read_b64_tr_b16 v[186:187], v217 offset:9216
    s_waitcnt lgkmcnt(6)
    v_mfma_f32_16x16x32_bf16 v[156:159], v[176:179], v[36:39], v[156:159]
    ds_read_b64_tr_b16 v[188:189], v218 offset:8192
    v_mfma_f32_16x16x32_bf16 v[160:163], v[176:179], v[40:43], v[160:163]
    ds_read_b64_tr_b16 v[190:191], v218 offset:9216
    s_add_u32 m0, s58, 1024
    s_nop 0
    buffer_load_dwordx4 v5, s[4:7], s2 offen lds
    v_mfma_f32_16x16x32_bf16 v[196:199], v[164:167], v[16:19], v[196:199]
    ds_read_b64_tr_b16 v[192:193], v219 offset:8192
    v_mfma_f32_16x16x32_bf16 v[200:203], v[16:19], v[40:43], v[200:203]
    ds_read_b64_tr_b16 v[194:195], v219 offset:9216
    v_mfma_f32_16x16x32_bf16 v[204:207], v[40:43], v[40:43], v[204:207]
    s_waitcnt vmcnt(6)
    s_barrier
    s_waitcnt lgkmcnt(7)
    v_mfma_f32_16x16x32_bf16 v[132:135], v[180:183], v[44:47], v[132:135]
    ds_read_b128 v[52:55], v12 offset:32768
    s_waitcnt lgkmcnt(7)
    v_mfma_f32_16x16x32_bf16 v[136:139], v[180:183], v[48:51], v[136:139]
    ds_read_b64_tr_b16 v[164:165], v216 offset:16384
    s_waitcnt lgkmcnt(6)
    v_mfma_f32_16x16x32_bf16 v[140:143], v[184:187], v[44:47], v[140:143]
    ds_read_b64_tr_b16 v[166:167], v216 offset:17408
    v_mfma_f32_16x16x32_bf16 v[144:147], v[184:187], v[48:51], v[144:147]
    ds_read_b128 v[56:59], v12 offset:34816
    s_mul_i32 s2, s75, 4294049792
    s_add_u32 s2, s2, 1146880
    s_add_u32 m0, s58, 49152
    s_nop 0
    buffer_load_dwordx4 v6, s[12:15], s2 offen lds
    s_waitcnt lgkmcnt(6)
    v_mfma_f32_16x16x32_bf16 v[148:151], v[188:191], v[44:47], v[148:151]
    ds_read_b64_tr_b16 v[168:169], v217 offset:16384
    v_mfma_f32_16x16x32_bf16 v[152:155], v[188:191], v[48:51], v[152:155]
    ds_read_b64_tr_b16 v[170:171], v217 offset:17408
    s_waitcnt lgkmcnt(6)
    v_mfma_f32_16x16x32_bf16 v[156:159], v[192:195], v[44:47], v[156:159]
    ds_read_b64_tr_b16 v[172:173], v218 offset:16384
    v_mfma_f32_16x16x32_bf16 v[160:163], v[192:195], v[48:51], v[160:163]
    ds_read_b64_tr_b16 v[174:175], v218 offset:17408
    s_add_u32 s2, s2, 14336
    s_add_u32 m0, s58, 50176
    s_nop 0
    buffer_load_dwordx4 v6, s[12:15], s2 offen lds
    v_mfma_f32_16x16x32_bf16 v[196:199], v[180:183], v[16:19], v[196:199]
    ds_read_b64_tr_b16 v[176:177], v219 offset:16384
    v_mfma_f32_16x16x32_bf16 v[200:203], v[16:19], v[48:51], v[200:203]
    ds_read_b64_tr_b16 v[178:179], v219 offset:17408
    v_mfma_f32_16x16x32_bf16 v[204:207], v[48:51], v[48:51], v[204:207]
    s_waitcnt lgkmcnt(7)
    v_mfma_f32_16x16x32_bf16 v[132:135], v[164:167], v[52:55], v[132:135]
    ds_read_b128 v[60:63], v13 offset:32768
    s_waitcnt lgkmcnt(7)
    v_mfma_f32_16x16x32_bf16 v[136:139], v[164:167], v[56:59], v[136:139]
    ds_read_b64_tr_b16 v[180:181], v216 offset:24576
    s_waitcnt lgkmcnt(6)
    v_mfma_f32_16x16x32_bf16 v[140:143], v[168:171], v[52:55], v[140:143]
    ds_read_b64_tr_b16 v[182:183], v216 offset:25600
    s_mul_i32 s2, s75, 4294966784
    s_add_u32 s2, s2, 512
    s_add_u32 m0, s58, 16384
    s_nop 0
    buffer_load_dwordx4 v4, s[4:7], s2 offen lds
    v_mfma_f32_16x16x32_bf16 v[144:147], v[168:171], v[56:59], v[144:147]
    ds_read_b128 v[64:67], v13 offset:34816
    s_waitcnt lgkmcnt(6)
    v_mfma_f32_16x16x32_bf16 v[148:151], v[172:175], v[52:55], v[148:151]
    ds_read_b64_tr_b16 v[184:185], v217 offset:24576
    v_mfma_f32_16x16x32_bf16 v[152:155], v[172:175], v[56:59], v[152:155]
    ds_read_b64_tr_b16 v[186:187], v217 offset:25600
    s_add_u32 m0, s58, 17408
    s_nop 0
    buffer_load_dwordx4 v5, s[4:7], s2 offen lds
    s_waitcnt lgkmcnt(6)
    v_mfma_f32_16x16x32_bf16 v[156:159], v[176:179], v[52:55], v[156:159]
    ds_read_b64_tr_b16 v[188:189], v218 offset:24576
    v_mfma_f32_16x16x32_bf16 v[160:163], v[176:179], v[56:59], v[160:163]
    ds_read_b64_tr_b16 v[190:191], v218 offset:25600
    v_mfma_f32_16x16x32_bf16 v[196:199], v[164:167], v[16:19], v[196:199]
    ds_read_b64_tr_b16 v[192:193], v219 offset:24576
    s_and_b32 s52, s61, 7
    s_lshl_b32 s52, s52, 7
    s_add_u32 s52, s52, 4096
    v_lshlrev_b32 v248, 2, v1
    buffer_load_dword v248, v248, s[8:11], s52 offen sc1
    v_mfma_f32_16x16x32_bf16 v[200:203], v[16:19], v[56:59], v[200:203]
    ds_read_b64_tr_b16 v[194:195], v219 offset:25600
    v_mfma_f32_16x16x32_bf16 v[204:207], v[56:59], v[56:59], v[204:207]
    s_waitcnt vmcnt(5)
    s_barrier
    s_waitcnt lgkmcnt(7)
    v_mfma_f32_16x16x32_bf16 v[132:135], v[180:183], v[60:63], v[132:135]
    ds_read_b128 v[68:71], v12 offset:0
    s_waitcnt lgkmcnt(7)
    v_mfma_f32_16x16x32_bf16 v[136:139], v[180:183], v[64:67], v[136:139]
    ds_read_b64_tr_b16 v[164:165], v216 offset:32768
    s_waitcnt lgkmcnt(6)
    v_mfma_f32_16x16x32_bf16 v[140:143], v[184:187], v[60:63], v[140:143]
    ds_read_b64_tr_b16 v[166:167], v216 offset:33792
    v_mfma_f32_16x16x32_bf16 v[144:147], v[184:187], v[64:67], v[144:147]
    ds_read_b128 v[72:75], v12 offset:2048
    s_mul_i32 s2, s75, 4294049792
    s_add_u32 s2, s2, 1376256
    s_add_u32 m0, s58, 65536
    s_nop 0
    buffer_load_dwordx4 v6, s[12:15], s2 offen lds
    s_waitcnt lgkmcnt(6)
    v_mfma_f32_16x16x32_bf16 v[148:151], v[188:191], v[60:63], v[148:151]
    ds_read_b64_tr_b16 v[168:169], v217 offset:32768
    v_mfma_f32_16x16x32_bf16 v[152:155], v[188:191], v[64:67], v[152:155]
    ds_read_b64_tr_b16 v[170:171], v217 offset:33792
    s_waitcnt lgkmcnt(6)
    v_mfma_f32_16x16x32_bf16 v[156:159], v[192:195], v[60:63], v[156:159]
    ds_read_b64_tr_b16 v[172:173], v218 offset:32768
    v_mfma_f32_16x16x32_bf16 v[160:163], v[192:195], v[64:67], v[160:163]
    ds_read_b64_tr_b16 v[174:175], v218 offset:33792
    s_add_u32 s2, s2, 14336
    s_add_u32 m0, s58, 66560
    s_nop 0
    buffer_load_dwordx4 v6, s[12:15], s2 offen lds
    v_mfma_f32_16x16x32_bf16 v[196:199], v[180:183], v[16:19], v[196:199]
    ds_read_b64_tr_b16 v[176:177], v219 offset:32768
    v_mfma_f32_16x16x32_bf16 v[200:203], v[16:19], v[64:67], v[200:203]
    ds_read_b64_tr_b16 v[178:179], v219 offset:33792
    v_mfma_f32_16x16x32_bf16 v[204:207], v[64:67], v[64:67], v[204:207]
    s_waitcnt lgkmcnt(7)
    v_mfma_f32_16x16x32_bf16 v[132:135], v[164:167], v[68:71], v[132:135]
    ds_read_b128 v[76:79], v13 offset:0
    s_waitcnt lgkmcnt(7)
    v_mfma_f32_16x16x32_bf16 v[136:139], v[164:167], v[72:75], v[136:139]
    ds_read_b64_tr_b16 v[180:181], v216 offset:40960
    s_waitcnt lgkmcnt(6)
    v_mfma_f32_16x16x32_bf16 v[140:143], v[168:171], v[68:71], v[140:143]
    ds_read_b64_tr_b16 v[182:183], v216 offset:41984
    v_mfma_f32_16x16x32_bf16 v[144:147], v[168:171], v[72:75], v[144:147]
    ds_read_b128 v[80:83], v13 offset:2048
    s_mul_i32 s2, s75, 4294966784
    s_add_u32 s2, s2, 640
    s_add_u32 m0, s58, 32768
    s_nop 0
    buffer_load_dwordx4 v4, s[4:7], s2 offen lds
    s_waitcnt lgkmcnt(6)
    v_mfma_f32_16x16x32_bf16 v[148:151], v[172:175], v[68:71], v[148:151]
    ds_read_b64_tr_b16 v[184:185], v217 offset:40960
    v_mfma_f32_16x16x32_bf16 v[152:155], v[172:175], v[72:75], v[152:155]
    ds_read_b64_tr_b16 v[186:187], v217 offset:41984
    s_waitcnt lgkmcnt(6)
    v_mfma_f32_16x16x32_bf16 v[156:159], v[176:179], v[68:71], v[156:159]
    ds_read_b64_tr_b16 v[188:189], v218 offset:40960
    v_mfma_f32_16x16x32_bf16 v[160:163], v[176:179], v[72:75], v[160:163]
    ds_read_b64_tr_b16 v[190:191], v218 offset:41984
    s_add_u32 m0, s58, 33792
    s_nop 0
    buffer_load_dwordx4 v5, s[4:7], s2 offen lds
    v_mfma_f32_16x16x32_bf16 v[196:199], v[164:167], v[16:19], v[196:199]
    ds_read_b64_tr_b16 v[192:193], v219 offset:40960
    v_mfma_f32_16x16x32_bf16 v[200:203], v[16:19], v[72:75], v[200:203]
    ds_read_b64_tr_b16 v[194:195], v219 offset:41984
    v_mfma_f32_16x16x32_bf16 v[204:207], v[72:75], v[72:75], v[204:207]
    s_waitcnt vmcnt(5)
    s_barrier
    s_waitcnt lgkmcnt(7)
    v_mfma_f32_16x16x32_bf16 v[132:135], v[180:183], v[76:79], v[132:135]
    ds_read_b128 v[84:87], v12 offset:16384
    s_waitcnt lgkmcnt(7)
    v_mfma_f32_16x16x32_bf16 v[136:139], v[180:183], v[80:83], v[136:139]
    ds_read_b64_tr_b16 v[164:165], v216 offset:49152
    s_waitcnt lgkmcnt(6)
    v_mfma_f32_16x16x32_bf16 v[140:143], v[184:187], v[76:79], v[140:143]
    ds_read_b64_tr_b16 v[166:167], v216 offset:50176
    v_mfma_f32_16x16x32_bf16 v[144:147], v[184:187], v[80:83], v[144:147]
    ds_read_b128 v[88:91], v12 offset:18432
    s_waitcnt lgkmcnt(6)
    v_mfma_f32_16x16x32_bf16 v[148:151], v[188:191], v[76:79], v[148:151]
    ds_read_b64_tr_b16 v[168:169], v217 offset:49152
    v_mfma_f32_16x16x32_bf16 v[152:155], v[188:191], v[80:83], v[152:155]
    ds_read_b64_tr_b16 v[170:171], v217 offset:50176
    s_waitcnt lgkmcnt(6)
    v_mfma_f32_16x16x32_bf16 v[156:159], v[192:195], v[76:79], v[156:159]
    ds_read_b64_tr_b16 v[172:173], v218 offset:49152
    v_mfma_f32_16x16x32_bf16 v[160:163], v[192:195], v[80:83], v[160:163]
    ds_read_b64_tr_b16 v[174:175], v218 offset:50176
    v_mfma_f32_16x16x32_bf16 v[196:199], v[180:183], v[16:19], v[196:199]
    ds_read_b64_tr_b16 v[176:177], v219 offset:49152
    v_mfma_f32_16x16x32_bf16 v[200:203], v[16:19], v[80:83], v[200:203]
    ds_read_b64_tr_b16 v[178:179], v219 offset:50176
    v_mfma_f32_16x16x32_bf16 v[204:207], v[80:83], v[80:83], v[204:207]
    s_waitcnt lgkmcnt(7)
    v_mfma_f32_16x16x32_bf16 v[132:135], v[164:167], v[84:87], v[132:135]
    ds_read_b128 v[92:95], v13 offset:16384
    s_waitcnt lgkmcnt(7)
    v_mfma_f32_16x16x32_bf16 v[136:139], v[164:167], v[88:91], v[136:139]
    ds_read_b64_tr_b16 v[180:181], v216 offset:57344
    s_waitcnt lgkmcnt(6)
    v_mfma_f32_16x16x32_bf16 v[140:143], v[168:171], v[84:87], v[140:143]
    ds_read_b64_tr_b16 v[182:183], v216 offset:58368
    v_mfma_f32_16x16x32_bf16 v[144:147], v[168:171], v[88:91], v[144:147]
    ds_read_b128 v[96:99], v13 offset:18432
    s_mul_i32 s2, s75, 4294966784
    s_add_u32 s2, s2, 768
    s_add_u32 m0, s58, 0
    s_nop 0
    buffer_load_dwordx4 v4, s[4:7], s2 offen lds
    s_waitcnt lgkmcnt(6)
    v_mfma_f32_16x16x32_bf16 v[148:151], v[172:175], v[84:87], v[148:151]
    ds_read_b64_tr_b16 v[184:185], v217 offset:57344
    v_mfma_f32_16x16x32_bf16 v[152:155], v[172:175], v[88:91], v[152:155]
    ds_read_b64_tr_b16 v[186:187], v217 offset:58368
    s_waitcnt lgkmcnt(6)
    v_mfma_f32_16x16x32_bf16 v[156:159], v[176:179], v[84:87], v[156:159]
    ds_read_b64_tr_b16 v[188:189], v218 offset:57344
    v_mfma_f32_16x16x32_bf16 v[160:163], v[176:179], v[88:91], v[160:163]
    ds_read_b64_tr_b16 v[190:191], v218 offset:58368
    s_add_u32 m0, s58, 1024
    s_nop 0
    buffer_load_dwordx4 v5, s[4:7], s2 offen lds
    v_mfma_f32_16x16x32_bf16 v[196:199], v[164:167], v[16:19], v[196:199]
    ds_read_b64_tr_b16 v[192:193], v219 offset:57344
    v_mfma_f32_16x16x32_bf16 v[200:203], v[16:19], v[88:91], v[200:203]
    ds_read_b64_tr_b16 v[194:195], v219 offset:58368
    v_mfma_f32_16x16x32_bf16 v[204:207], v[88:91], v[88:91], v[204:207]
    s_waitcnt vmcnt(6)
    v_subrev_u32 v239, s48, v248
    s_mov_b32 s70, 0
L_modep_26:
    s_mov_b32 exec_hi, 0
    v_cmp_le_u32 vcc, 16, v239
    s_nop 4
    s_cmp_eq_u64 vcc, 0
    s_cbranch_scc1 L_modeok_27
    s_add_u32 s70, s70, 1
    s_cmp_ge_u32 s70, 4000
    s_cbranch_scc1 L_modeok_27
    s_and_b32 s52, s61, 7
    s_lshl_b32 s52, s52, 7
    s_add_u32 s52, s52, 4096
    v_lshlrev_b32 v239, 2, v1
    buffer_load_dword v239, v239, s[8:11], s52 offen sc1
    s_waitcnt vmcnt(0)
    v_subrev_u32 v239, s48, v239
    s_branch L_modep_26
L_modeok_27:
    v_cmp_ne_u32 vcc, s71, v239
    s_nop 4
    s_cmp_eq_u64 vcc, 0
    s_cselect_b32 s49, 1, 0
    s_mov_b64 exec, -1
    s_waitcnt vmcnt(2)
    s_barrier
    s_waitcnt lgkmcnt(7)
    v_mfma_f32_16x16x32_bf16 v[132:135], v[180:183], v[92:95], v[132:135]
    ds_read_b128 v[100:103], v12 offset:32768
    s_waitcnt lgkmcnt(7)
    v_mfma_f32_16x16x32_bf16 v[136:139], v[180:183], v[96:99], v[136:139]
    ds_read_b64_tr_b16 v[164:165], v8 offset:49152
    s_waitcnt lgkmcnt(6)
    v_mfma_f32_16x16x32_bf16 v[140:143], v[184:187], v[92:95], v[140:143]
    ds_read_b64_tr_b16 v[166:167], v8 offset:50176
    v_mfma_f32_16x16x32_bf16 v[144:147], v[184:187], v[96:99], v[144:147]
    ds_read_b128 v[104:107], v12 offset:34816
    s_waitcnt lgkmcnt(6)
    v_mfma_f32_16x16x32_bf16 v[148:151], v[188:191], v[92:95], v[148:151]
    ds_read_b64_tr_b16 v[168:169], v9 offset:49152
    v_mfma_f32_16x16x32_bf16 v[152:155], v[188:191], v[96:99], v[152:155]
    ds_read_b64_tr_b16 v[170:171], v9 offset:50176
    s_waitcnt lgkmcnt(6)
    v_mfma_f32_16x16x32_bf16 v[156:159], v[192:195], v[92:95], v[156:159]
    ds_read_b64_tr_b16 v[172:173], v10 offset:49152
    v_mfma_f32_16x16x32_bf16 v[160:163], v[192:195], v[96:99], v[160:163]
    ds_read_b64_tr_b16 v[174:175], v10 offset:50176
    v_mfma_f32_16x16x32_bf16 v[196:199], v[180:183], v[16:19], v[196:199]
    ds_read_b64_tr_b16 v[176:177], v11 offset:49152
    v_mfma_f32_16x16x32_bf16 v[200:203], v[16:19], v[96:99], v[200:203]
    ds_read_b64_tr_b16 v[178:179], v11 offset:50176
    v_mfma_f32_16x16x32_bf16 v[204:207], v[96:99], v[96:99], v[204:207]
    s_waitcnt lgkmcnt(7)
    v_mfma_f32_16x16x32_bf16 v[132:135], v[164:167], v[100:103], v[132:135]
    ds_read_b128 v[108:111], v13 offset:32768
    s_waitcnt lgkmcnt(7)
    v_mfma_f32_16x16x32_bf16 v[136:139], v[164:167], v[104:107], v[136:139]
    ds_read_b64_tr_b16 v[180:181], v8 offset:57344
    s_waitcnt lgkmcnt(6)
    v_mfma_f32_16x16x32_bf16 v[140:143], v[168:171], v[100:103], v[140:143]
    ds_read_b64_tr_b16 v[182:183], v8 offset:58368
    v_mfma_f32_16x16x32_bf16 v[144:147], v[168:171], v[104:107], v[144:147]
    ds_read_b128 v[112:115], v13 offset:34816
    s_waitcnt lgkmcnt(6)
    v_mfma_f32_16x16x32_bf16 v[148:151], v[172:175], v[100:103], v[148:151]
    ds_read_b64_tr_b16 v[184:185], v9 offset:57344
    v_mfma_f32_16x16x32_bf16 v[152:155], v[172:175], v[104:107], v[152:155]
    ds_read_b64_tr_b16 v[186:187], v9 offset:58368
    s_waitcnt lgkmcnt(6)
    v_mfma_f32_16x16x32_bf16 v[156:159], v[176:179], v[100:103], v[156:159]
    ds_read_b64_tr_b16 v[188:189], v10 offset:57344
    v_mfma_f32_16x16x32_bf16 v[160:163], v[176:179], v[104:107], v[160:163]
    ds_read_b64_tr_b16 v[190:191], v10 offset:58368
    v_mfma_f32_16x16x32_bf16 v[196:199], v[164:167], v[16:19], v[196:199]
    ds_read_b64_tr_b16 v[192:193], v11 offset:57344
    v_mfma_f32_16x16x32_bf16 v[200:203], v[16:19], v[104:107], v[200:203]
    ds_read_b64_tr_b16 v[194:195], v11 offset:58368
    v_mfma_f32_16x16x32_bf16 v[204:207], v[104:107], v[104:107], v[204:207]
    s_waitcnt vmcnt(0)
    s_barrier
    s_lshr_b32 s53, s44, 1
    s_mul_i32 s52, s53, 14336
    s_mul_i32 s56, s47, 86016
    s_add_u32 s56, s56, s52
    s_add_u32 s56, s56, 262144
    s_add_u32 s52, s52, 81920
    s_cmp_eq_u32 s53, 3
    s_cselect_b32 s52, 16384, s52
    s_and_b32 s53, s44, 1
    s_mul_i32 s53, s53, 7
    s_lshl_b32 s55, s53, 10
    s_add_u32 s55, s55, s52
    s_mul_i32 s54, s75, 6
    s_add_u32 s54, s54, s53
    s_waitcnt lgkmcnt(7)
    v_mfma_f32_16x16x32_bf16 v[132:135], v[180:183], v[108:111], v[132:135]
    ds_read_b128 v[116:119], v12 offset:0
    s_waitcnt lgkmcnt(7)
    v_mfma_f32_16x16x32_bf16 v[136:139], v[180:183], v[112:115], v[136:139]
    ds_read_b64_tr_b16 v[164:165], v216 offset:0
    s_waitcnt lgkmcnt(6)
    v_mfma_f32_16x16x32_bf16 v[140:143], v[184:187], v[108:111], v[140:143]
    ds_read_b64_tr_b16 v[166:167], v216 offset:1024
    s_add_u32 s2, s54, 0
    s_cmp_ge_u32 s2, 14
    s_cselect_b32 s57, 14, 0
    s_sub_u32 s2, s2, s57
    s_lshl_b32 s2, s2, 10
    s_add_u32 s2, s2, s56
    s_add_u32 m0, s55, 0
    s_nop 0
    buffer_load_dwordx4 v7, s[8:11], s2 offen sc1 lds
    v_mfma_f32_16x16x32_bf16 v[144:147], v[184:187], v[112:115], v[144:147]
    ds_read_b128 v[120:123], v12 offset:2048
    s_waitcnt lgkmcnt(6)
    v_mfma_f32_16x16x32_bf16 v[148:151], v[188:191], v[108:111], v[148:151]
    ds_read_b64_tr_b16 v[168:169], v217 offset:0
    v_mfma_f32_16x16x32_bf16 v[152:155], v[188:191], v[112:115], v[152:155]
    ds_read_b64_tr_b16 v[170:171], v217 offset:1024
    s_add_u32 s2, s54, 1
    s_cmp_ge_u32 s2, 14
    s_cselect_b32 s57, 14, 0
    s_sub_u32 s2, s2, s57
    s_lshl_b32 s2, s2, 10
    s_add_u32 s2, s2, s56
    s_add_u32 m0, s55, 1024
    s_nop 0
    buffer_load_dwordx4 v7, s[8:11], s2 offen sc1 lds
    s_waitcnt lgkmcnt(6)
    v_mfma_f32_16x16x32_bf16 v[156:159], v[192:195], v[108:111], v[156:159]
    ds_read_b64_tr_b16 v[172:173], v218 offset:0
    v_mfma_f32_16x16x32_bf16 v[160:163], v[192:195], v[112:115], v[160:163]
    ds_read_b64_tr_b16 v[174:175], v218 offset:1024
    v_mfma_f32_16x16x32_bf16 v[196:199], v[180:183], v[16:19], v[196:199]
    ds_read_b64_tr_b16 v[176:177], v219 offset:0
    s_add_u32 s2, s54, 2
    s_cmp_ge_u32 s2, 14
    s_cselect_b32 s57, 14, 0
    s_sub_u32 s2, s2, s57
    s_lshl_b32 s2, s2, 10
    s_add_u32 s2, s2, s56
    s_add_u32 m0, s55, 2048
    s_nop 0
    buffer_load_dwordx4 v7, s[8:11], s2 offen sc1 lds
    v_mfma_f32_16x16x32_bf16 v[200:203], v[16:19], v[112:115], v[200:203]
    ds_read_b64_tr_b16 v[178:179], v219 offset:1024
    v_mfma_f32_16x16x32_bf16 v[204:207], v[112:115], v[112:115], v[204:207]
    s_waitcnt lgkmcnt(7)
    v_mfma_f32_16x16x32_bf16 v[132:135], v[164:167], v[116:119], v[132:135]
    ds_read_b128 v[124:127], v13 offset:0
    s_waitcnt lgkmcnt(7)
    v_mfma_f32_16x16x32_bf16 v[136:139], v[164:167], v[120:123], v[136:139]
    ds_read_b64_tr_b16 v[180:181], v216 offset:8192
    s_waitcnt lgkmcnt(6)
    v_mfma_f32_16x16x32_bf16 v[140:143], v[168:171], v[116:119], v[140:143]
    ds_read_b64_tr_b16 v[182:183], v216 offset:9216
    v_mfma_f32_16x16x32_bf16 v[144:147], v[168:171], v[120:123], v[144:147]
    ds_read_b128 v[128:131], v13 offset:2048
    s_add_u32 s2, s54, 3
    s_cmp_ge_u32 s2, 14
    s_cselect_b32 s57, 14, 0
    s_sub_u32 s2, s2, s57
    s_lshl_b32 s2, s2, 10
    s_add_u32 s2, s2, s56
    s_add_u32 m0, s55, 3072
    s_nop 0
    buffer_load_dwordx4 v7, s[8:11], s2 offen sc1 lds
    s_waitcnt lgkmcnt(6)
    v_mfma_f32_16x16x32_bf16 v[148:151], v[172:175], v[116:119], v[148:151]
    ds_read_b64_tr_b16 v[184:185], v217 offset:8192
    v_mfma_f32_16x16x32_bf16 v[152:155], v[172:175], v[120:123], v[152:155]
    ds_read_b64_tr_b16 v[186:187], v217 offset:9216
    s_waitcnt lgkmcnt(6)
    v_mfma_f32_16x16x32_bf16 v[156:159], v[176:179], v[116:119], v[156:159]
    ds_read_b64_tr_b16 v[188:189], v218 offset:8192
    v_mfma_f32_16x16x32_bf16 v[160:163], v[176:179], v[120:123], v[160:163]
    ds_read_b64_tr_b16 v[190:191], v218 offset:9216
    s_add_u32 s2, s54, 4
    s_cmp_ge_u32 s2, 14
    s_cselect_b32 s57, 14, 0
    s_sub_u32 s2, s2, s57
    s_lshl_b32 s2, s2, 10
    s_add_u32 s2, s2, s56
    s_add_u32 m0, s55, 4096
    s_nop 0
    buffer_load_dwordx4 v7, s[8:11], s2 offen sc1 lds
    v_mfma_f32_16x16x32_bf16 v[196:199], v[164:167], v[16:19], v[196:199]
    ds_read_b64_tr_b16 v[192:193], v219 offset:8192
    v_mfma_f32_16x16x32_bf16 v[200:203], v[16:19], v[120:123], v[200:203]
    ds_read_b64_tr_b16 v[194:195], v219 offset:9216
    v_mfma_f32_16x16x32_bf16 v[204:207], v[120:123], v[120:123], v[204:207]
    s_waitcnt lgkmcnt(7)
    v_mfma_f32_16x16x32_bf16 v[132:135], v[180:183], v[124:127], v[132:135]
    s_waitcnt lgkmcnt(6)
    v_mfma_f32_16x16x32_bf16 v[136:139], v[180:183], v[128:131], v[136:139]
    s_waitcnt lgkmcnt(4)
    v_mfma_f32_16x16x32_bf16 v[140:143], v[184:187], v[124:127], v[140:143]
    s_add_u32 s2, s54, 5
    s_cmp_ge_u32 s2, 14
    s_cselect_b32 s57, 14, 0
    s_sub_u32 s2, s2, s57
    s_lshl_b32 s2, s2, 10
    s_add_u32 s2, s2, s56
    s_add_u32 m0, s55, 5120
    s_nop 0
    buffer_load_dwordx4 v7, s[8:11], s2 offen sc1 lds
    v_mfma_f32_16x16x32_bf16 v[144:147], v[184:187], v[128:131], v[144:147]
    s_waitcnt lgkmcnt(2)
    v_mfma_f32_16x16x32_bf16 v[148:151], v[188:191], v[124:127], v[148:151]
    v_mfma_f32_16x16x32_bf16 v[152:155], v[188:191], v[128:131], v[152:155]
    s_add_u32 s2, s54, 6
    s_cmp_ge_u32 s2, 14
    s_cselect_b32 s57, 14, 0
    s_sub_u32 s2, s2, s57
    s_lshl_b32 s2, s2, 10
    s_add_u32 s2, s2, s56
    s_add_u32 m0, s55, 6144
    s_nop 0
    buffer_load_dwordx4 v7, s[8:11], s2 offen sc1 lds
    s_waitcnt lgkmcnt(0)
    v_mfma_f32_16x16x32_bf16 v[156:159], v[192:195], v[124:127], v[156:159]
    v_mfma_f32_16x16x32_bf16 v[160:163], v[192:195], v[128:131], v[160:163]
    v_mfma_f32_16x16x32_bf16 v[196:199], v[180:183], v[16:19], v[196:199]
    v_lshlrev_b32 v238, 3, v3
    s_xor_b32 s52, s45, 0
    s_lshl_b32 s52, s52, 5
    s_lshl_b32 s53, s47, 8
    s_add_u32 s52, s52, s53
    buffer_load_dwordx2 v[8:9], v238, s[36:39], s52 offen offset:128
    s_xor_b32 s52, s45, 1
    s_lshl_b32 s52, s52, 5
    s_lshl_b32 s53, s47, 8
    s_add_u32 s52, s52, s53
    buffer_load_dwordx2 v[10:11], v238, s[36:39], s52 offen offset:128
    s_xor_b32 s52, s45, 2
    s_lshl_b32 s52, s52, 5
    s_lshl_b32 s53, s47, 8
    s_add_u32 s52, s52, s53
    buffer_load_dwordx2 v[12:13], v238, s[36:39], s52 offen offset:128
    s_xor_b32 s52, s45, 3
    s_lshl_b32 s52, s52, 5
    s_lshl_b32 s53, s47, 8
    s_add_u32 s52, s52, s53
    buffer_load_dwordx2 v[4:5], v238, s[36:39], s52 offen offset:128
    v_mfma_f32_16x16x32_bf16 v[200:203], v[16:19], v[128:131], v[200:203]
    v_mfma_f32_16x16x32_bf16 v[204:207], v[128:131], v[128:131], v[204:207]
    v_and_b32 v222, 3, v2
    v_cmp_eq_u32 s[78:79], 1, v222
    v_cmp_eq_u32 s[80:81], 2, v222
    v_cmp_eq_u32 s[82:83], 3, v222
    v_lshrrev_b32 v223, 2, v2
    v_cmp_eq_u32 s[72:73], v223, v3
    s_lshl_b32 s52, s45, 7
    s_add_u32 s52, s52, 147520
    v_lshl_add_u32 v226, v2, 2, s52
    v_mul_f32 v225, 0x3b124925, v200
    v_cndmask_b32 v224, v204, v205, s[78:79]
    v_cndmask_b32 v224, v224, v206, s[80:81]
    v_cndmask_b32 v224, v224, v207, s[82:83]
    v_mul_f32 v224, 0x3b124925, v224
    v_fma_f32 v224, -v225, v225, v224
    v_max_f32 v224, 0, v224
    v_add_f32 v224, 0x3727c5ac, v224
    v_rsq_f32 v224, v224
    s_nop 0
    v_mul_f32 v225, v225, v224
    v_sub_f32 v225, 0, v225
    s_mov_b64 exec, s[72:73]
    ds_write_b32 v226, v224
    ds_write_b32 v226, v225 offset:512
    s_mov_b64 exec, -1
    s_lshl_b32 s52, s45, 6
    s_add_u32 s52, s52, 157952
    v_lshlrev_b32 v226, 4, v3
    v_add_u32 v226, s52, v226
    v_cmp_eq_u32 vcc, 0, v2
    s_nop 1
    s_mov_b64 exec, vcc
    ds_write_b128 v226, v[196:199]
    s_mov_b64 exec, -1
    s_waitcnt vmcnt(4)
    s_waitcnt lgkmcnt(0)
    s_barrier
    s_lshl_b32 s52, s45, 7
    s_add_u32 s52, s52, 147456
    v_lshl_add_u32 v220, v2, 2, s52
    ds_read_b32 v200, v220 offset:0
    ds_read_b32 v202, v220 offset:512
    ds_read_b32 v201, v220 offset:64
    ds_read_b32 v203, v220 offset:576
    s_mul_i32 s52, s45, 14336
    s_add_u32 s52, s52, 89088
    s_cmp_eq_u32 s45, 3
    s_cselect_b32 s52, 23552, s52
    v_add_u32 v221, s52, v7
    s_lshr_b32 s52, s44, 2
    s_mul_i32 s52, s52, 14336
    s_mul_i32 s56, s47, 86016
    s_add_u32 s56, s56, s52
    s_add_u32 s56, s56, 319488
    s_lshl_b32 s53, s45, 2
    s_lshl_b32 s55, s53, 10
    s_add_u32 s55, s55, s52
    s_mul_i32 s54, s75, 6
    s_add_u32 s54, s54, s53
    v_add_u32 v220, 110592, v7
    v_add_u32 v251, 16384, v7
    v_mov_b32 v204, 0
    v_mov_b32 v205, 0
    v_mov_b32 v206, 0
    v_mov_b32 v207, 0
    v_mov_b32 v208, 0
    v_mov_b32 v209, 0
    v_mov_b32 v210, 0
    v_mov_b32 v211, 0
    v_mov_b32 v212, 0
    v_mov_b32 v213, 0
    v_mov_b32 v214, 0
    v_mov_b32 v215, 0
    v_mov_b32 v216, 0
    v_mov_b32 v217, 0
    v_mov_b32 v218, 0
    v_mov_b32 v219, 0
    v_mov_b32 v196, 0
    v_mov_b32 v197, 0
    v_mov_b32 v198, 0
    v_mov_b32 v199, 0
    ds_read_b128 v[164:167], v220 offset:0
    ds_read_b128 v[168:171], v251 offset:0
    ds_read_b128 v[188:191], v221 offset:0
    ds_read_b128 v[172:175], v220 offset:1024
    ds_read_b128 v[176:179], v251 offset:1024
    s_waitcnt lgkmcnt(4)
    v_mfma_f32_16x16x32_bf16 v[204:207], v[20:23], v[164:167], v[204:207]
    ds_read_b128 v[180:183], v220 offset:2048
    v_mfma_f32_16x16x32_bf16 v[208:211], v[24:27], v[164:167], v[208:211]
    ds_read_b128 v[184:187], v251 offset:2048
    s_add_u32 s2, s54, 0
    s_cmp_ge_u32 s2, 14
    s_cselect_b32 s57, 14, 0
    s_sub_u32 s2, s2, s57
    s_lshl_b32 s2, s2, 10
    s_add_u32 s2, s2, s56
    s_add_u32 m0, s55, 49152
    s_nop 0
    buffer_load_dwordx4 v7, s[8:11], s2 offen sc1 lds
    s_waitcnt lgkmcnt(5)
    v_mfma_f32_16x16x32_bf16 v[212:215], v[20:23], v[168:171], v[212:215]
    ds_read_b128 v[192:195], v221 offset:1024
    v_mfma_f32_16x16x32_bf16 v[216:219], v[24:27], v[168:171], v[216:219]
    s_add_u32 s2, s54, 1
    s_cmp_ge_u32 s2, 14
    s_cselect_b32 s57, 14, 0
    s_sub_u32 s2, s2, s57
    s_lshl_b32 s2, s2, 10
    s_add_u32 s2, s2, s56
    s_add_u32 m0, s55, 50176
    s_nop 0
    buffer_load_dwordx4 v7, s[8:11], s2 offen sc1 lds
    s_waitcnt lgkmcnt(5)
    v_mfma_f32_16x16x32_bf16 v[196:199], v[188:191], v[16:19], v[196:199]
    s_waitcnt lgkmcnt(4)
    v_mfma_f32_16x16x32_bf16 v[204:207], v[28:31], v[172:175], v[204:207]
    ds_read_b128 v[164:167], v220 offset:3072
    v_mfma_f32_16x16x32_bf16 v[208:211], v[32:35], v[172:175], v[208:211]
    ds_read_b128 v[168:171], v251 offset:3072
    s_add_u32 s2, s54, 2
    s_cmp_ge_u32 s2, 14
    s_cselect_b32 s57, 14, 0
    s_sub_u32 s2, s2, s57
    s_lshl_b32 s2, s2, 10
    s_add_u32 s2, s2, s56
    s_add_u32 s57, s55, 51200
    s_cmp_eq_u32 s45, 3
    s_cselect_b32 m0, 80896, s57
    s_nop 0
    buffer_load_dwordx4 v7, s[8:11], s2 offen sc1 lds
    s_waitcnt lgkmcnt(5)
    v_mfma_f32_16x16x32_bf16 v[212:215], v[28:31], v[176:179], v[212:215]
    s_add_u32 s2, s54, 3
    s_cmp_ge_u32 s2, 14
    s_cselect_b32 s57, 14, 0
    s_sub_u32 s2, s2, s57
    s_lshl_b32 s2, s2, 10
    s_add_u32 s2, s2, s56
    s_add_u32 s57, s55, 52224
    s_cmp_eq_u32 s45, 3
    s_cselect_b32 m0, 80896, s57
    s_nop 0
    buffer_load_dwordx4 v7, s[8:11], s2 offen sc1 lds
    v_mfma_f32_16x16x32_bf16 v[216:219], v[32:35], v[176:179], v[216:219]
    s_xor_b32 s52, s45, 0
    s_lshl_b32 s52, s52, 6
    s_add_u32 s52, s52, 157952
    v_lshl_add_u32 v230, v3, 4, s52
    ds_read_b128 v[222:225], v230
    s_waitcnt lgkmcnt(5)
    v_mfma_f32_16x16x32_bf16 v[204:207], v[36:39], v[180:183], v[204:207]
    ds_read_b128 v[172:175], v220 offset:4096
    v_mfma_f32_16x16x32_bf16 v[208:211], v[40:43], v[180:183], v[208:211]
    ds_read_b128 v[176:179], v251 offset:4096
    s_xor_b32 s52, s45, 1
    s_lshl_b32 s52, s52, 6
    s_add_u32 s52, s52, 157952
    v_lshl_add_u32 v230, v3, 4, s52
    ds_read_b128 v[226:229], v230
    s_waitcnt lgkmcnt(7)
    v_mfma_f32_16x16x32_bf16 v[212:215], v[36:39], v[184:187], v[212:215]
    ds_read_b128 v[188:191], v221 offset:2048
    v_mfma_f32_16x16x32_bf16 v[216:219], v[40:43], v[184:187], v[216:219]
    s_waitcnt vmcnt(7)
    v_lshlrev_b32 v240, 16, v8
    v_and_b32 v241, 0xffff0000, v8
    v_lshlrev_b32 v242, 16, v9
    v_and_b32 v243, 0xffff0000, v9
    s_waitcnt lgkmcnt(7)
    v_mfma_f32_16x16x32_bf16 v[196:199], v[192:195], v[16:19], v[196:199]
    s_waitcnt lgkmcnt(6)
    v_mfma_f32_16x16x32_bf16 v[204:207], v[44:47], v[164:167], v[204:207]
    ds_read_b128 v[180:183], v220 offset:5120
    v_mfma_f32_16x16x32_bf16 v[208:211], v[48:51], v[164:167], v[208:211]
    ds_read_b128 v[184:187], v251 offset:5120
    s_waitcnt lgkmcnt(6)
    v_fma_f32 v230, v202, v222, v240
    v_fma_f32 v231, v202, v223, v241
    v_fma_f32 v132, v200, v132, v230
    v_fma_f32 v133, v200, v133, v231
    v_max_f32 v132, 0, v132
    v_max_f32 v133, 0, v133
    v_mul_f32 v132, v132, v132
    v_mul_f32 v133, v133, v133
    v_cvt_pk_bf16_f32 v232, v132, v133
    v_mfma_f32_16x16x32_bf16 v[212:215], v[44:47], v[168:171], v[212:215]
    v_fma_f32 v230, v202, v224, v242
    v_fma_f32 v231, v202, v225, v243
    v_fma_f32 v134, v200, v134, v230
    v_fma_f32 v135, v200, v135, v231
    v_max_f32 v134, 0, v134
    v_max_f32 v135, 0, v135
    v_mul_f32 v134, v134, v134
    v_mul_f32 v135, v135, v135
    v_cvt_pk_bf16_f32 v233, v134, v135
    v_mfma_f32_16x16x32_bf16 v[216:219], v[48:51], v[168:171], v[216:219]
    s_mul_i32 s2, s75, 401408
    s_add_u32 s2, s2, 0
    s_add_u32 s2, s2, s3
    s_add_u32 m0, s59, 0
    s_nop 0
    buffer_load_dwordx4 v252, s[16:19], s2 offen lds
    s_waitcnt lgkmcnt(5)
    v_mfma_f32_16x16x32_bf16 v[204:207], v[52:55], v[172:175], v[204:207]
    ds_read_b128 v[164:167], v220 offset:6144
    v_mfma_f32_16x16x32_bf16 v[208:211], v[56:59], v[172:175], v[208:211]
    ds_read_b128 v[168:171], v251 offset:6144
    v_fma_f32 v230, v203, v222, v240
    v_fma_f32 v231, v203, v223, v241
    v_fma_f32 v136, v201, v136, v230
    v_fma_f32 v137, v201, v137, v231
    v_max_f32 v136, 0, v136
    v_max_f32 v137, 0, v137
    v_mul_f32 v136, v136, v136
    v_mul_f32 v137, v137, v137
    v_cvt_pk_bf16_f32 v236, v136, v137
    s_waitcnt lgkmcnt(6)
    v_mfma_f32_16x16x32_bf16 v[212:215], v[52:55], v[176:179], v[212:215]
    ds_read_b128 v[192:195], v221 offset:3072
    v_mfma_f32_16x16x32_bf16 v[216:219], v[56:59], v[176:179], v[216:219]
    v_fma_f32 v230, v203, v224, v242
    v_fma_f32 v231, v203, v225, v243
    v_fma_f32 v138, v201, v138, v230
    v_fma_f32 v139, v201, v139, v231
    v_max_f32 v138, 0, v138
    v_max_f32 v139, 0, v139
    v_mul_f32 v138, v138, v138
    v_mul_f32 v139, v139, v139
    v_cvt_pk_bf16_f32 v237, v138, v139
    s_waitcnt lgkmcnt(5)
    v_mfma_f32_16x16x32_bf16 v[196:199], v[188:191], v[16:19], v[196:199]
    s_waitcnt lgkmcnt(4)
    v_mfma_f32_16x16x32_bf16 v[204:207], v[60:63], v[180:183], v[204:207]
    ds_read_b128 v[172:175], v220 offset:7168
    v_mfma_f32_16x16x32_bf16 v[208:211], v[64:67], v[180:183], v[208:211]
    ds_read_b128 v[176:179], v251 offset:7168
    s_xor_b32 s52, s45, 2
    s_lshl_b32 s52, s52, 6
    s_add_u32 s52, s52, 157952
    v_lshl_add_u32 v230, v3, 4, s52
    ds_read_b128 v[222:225], v230
    s_waitcnt lgkmcnt(6)
    v_mfma_f32_16x16x32_bf16 v[212:215], v[60:63], v[184:187], v[212:215]
    s_waitcnt vmcnt(7)
    v_lshlrev_b32 v240, 16, v10
    v_and_b32 v241, 0xffff0000, v10
    v_lshlrev_b32 v242, 16, v11
    v_and_b32 v243, 0xffff0000, v11
    v_mfma_f32_16x16x32_bf16 v[216:219], v[64:67], v[184:187], v[216:219]
    v_fma_f32 v230, v202, v226, v240
    v_fma_f32 v231, v202, v227, v241
    v_fma_f32 v140, v200, v140, v230
    v_fma_f32 v141, v200, v141, v231
    v_max_f32 v140, 0, v140
    v_max_f32 v141, 0, v141
    v_mul_f32 v140, v140, v140
    v_mul_f32 v141, v141, v141
    v_cvt_pk_bf16_f32 v234, v140, v141
    s_waitcnt lgkmcnt(5)
    v_mfma_f32_16x16x32_bf16 v[204:207], v[68:71], v[164:167], v[204:207]
    ds_read_b128 v[180:183], v220 offset:8192
    v_mfma_f32_16x16x32_bf16 v[208:211], v[72:75], v[164:167], v[208:211]
    ds_read_b128 v[184:187], v251 offset:8192
    s_mul_i32 s2, s75, 401408
    s_add_u32 s2, s2, 57344
    s_add_u32 s2, s2, s3
    s_add_u32 m0, s59, 8192
    s_nop 0
    buffer_load_dwordx4 v252, s[16:19], s2 offen lds
    s_waitcnt lgkmcnt(6)
    v_mfma_f32_16x16x32_bf16 v[212:215], v[68:71], v[168:171], v[212:215]
    ds_read_b128 v[188:191], v221 offset:4096
    v_mfma_f32_16x16x32_bf16 v[216:219], v[72:75], v[168:171], v[216:219]
    v_fma_f32 v230, v202, v228, v242
    v_fma_f32 v231, v202, v229, v243
    v_fma_f32 v142, v200, v142, v230
    v_fma_f32 v143, v200, v143, v231
    v_max_f32 v142, 0, v142
    v_max_f32 v143, 0, v143
    v_mul_f32 v142, v142, v142
    v_mul_f32 v143, v143, v143
    v_cvt_pk_bf16_f32 v235, v142, v143
    s_waitcnt lgkmcnt(6)
    v_mfma_f32_16x16x32_bf16 v[196:199], v[192:195], v[16:19], v[196:199]
    s_waitcnt lgkmcnt(5)
    v_mfma_f32_16x16x32_bf16 v[204:207], v[76:79], v[172:175], v[204:207]
    ds_read_b128 v[164:167], v220 offset:9216
    v_mfma_f32_16x16x32_bf16 v[208:211], v[80:83], v[172:175], v[208:211]
    ds_read_b128 v[168:171], v251 offset:9216
    v_fma_f32 v230, v203, v226, v240
    v_fma_f32 v231, v203, v227, v241
    v_fma_f32 v144, v201, v144, v230
    v_fma_f32 v145, v201, v145, v231
    v_max_f32 v144, 0, v144
    v_max_f32 v145, 0, v145
    v_mul_f32 v144, v144, v144
    v_mul_f32 v145, v145, v145
    v_cvt_pk_bf16_f32 v238, v144, v145
    s_waitcnt lgkmcnt(6)
    v_mfma_f32_16x16x32_bf16 v[212:215], v[76:79], v[176:179], v[212:215]
    v_fma_f32 v230, v203, v228, v242
    v_fma_f32 v231, v203, v229, v243
    v_fma_f32 v146, v201, v146, v230
    v_fma_f32 v147, v201, v147, v231
    v_max_f32 v146, 0, v146
    v_max_f32 v147, 0, v147
    v_mul_f32 v146, v146, v146
    v_mul_f32 v147, v147, v147
    v_cvt_pk_bf16_f32 v239, v146, v147
    v_mfma_f32_16x16x32_bf16 v[216:219], v[80:83], v[176:179], v[216:219]
    s_xor_b32 s52, s45, 3
    s_lshl_b32 s52, s52, 6
    s_add_u32 s52, s52, 157952
    v_lshl_add_u32 v230, v3, 4, s52
    ds_read_b128 v[226:229], v230
    s_waitcnt lgkmcnt(5)
    v_mfma_f32_16x16x32_bf16 v[204:207], v[84:87], v[180:183], v[204:207]
    ds_read_b128 v[172:175], v220 offset:10240
    v_mfma_f32_16x16x32_bf16 v[208:211], v[88:91], v[180:183], v[208:211]
    ds_read_b128 v[176:179], v251 offset:10240
    s_bitcmp1_b32 s45, 0
    s_cbranch_scc0 L_noswap_28
    v_swap_b32 v232, v234
    v_swap_b32 v233, v235
    v_swap_b32 v236, v238
    v_swap_b32 v237, v239
L_noswap_28:
    s_mul_i32 s52, s46, 458752
    s_mul_i32 s57, s45, 114688
    s_add_u32 s52, s52, s57
    s_lshl_b32 s57, s47, 12
    s_add_u32 s52, s52, s57
    s_add_u32 s52, s52, 5244928
    s_lshr_b32 s53, s45, 1
    s_xor_b32 s53, s53, 0
    s_lshl_b32 s53, s53, 10
    s_add_u32 s52, s52, s53
    s_add_u32 s53, s52, 57344
    buffer_store_dwordx4 v[232:235], v7, s[8:11], s52 offen sc1
    buffer_store_dwordx4 v[236:239], v7, s[8:11], s53 offen sc1
    s_waitcnt lgkmcnt(6)
    v_mfma_f32_16x16x32_bf16 v[212:215], v[84:87], v[184:187], v[212:215]
    ds_read_b128 v[192:195], v221 offset:5120
    v_mfma_f32_16x16x32_bf16 v[216:219], v[88:91], v[184:187], v[216:219]
    s_mul_i32 s2, s75, 401408
    s_add_u32 s2, s2, 114688
    s_add_u32 s2, s2, s3
    s_add_u32 m0, s59, 32768
    s_nop 0
    buffer_load_dwordx4 v252, s[16:19], s2 offen lds
    s_waitcnt lgkmcnt(6)
    v_mfma_f32_16x16x32_bf16 v[196:199], v[188:191], v[16:19], v[196:199]
    s_waitcnt lgkmcnt(5)
    v_mfma_f32_16x16x32_bf16 v[204:207], v[92:95], v[164:167], v[204:207]
    ds_read_b128 v[180:183], v220 offset:11264
    v_mfma_f32_16x16x32_bf16 v[208:211], v[96:99], v[164:167], v[208:211]
    ds_read_b128 v[184:187], v251 offset:11264
    s_lshl_b32 s52, s45, 7
    s_add_u32 s52, s52, 147456
    v_lshl_add_u32 v230, v3, 4, s52
    ds_read_b128 v[132:135], v230 offset:0
    ds_read_b128 v[140:143], v230 offset:512
    ds_read_b128 v[136:139], v230 offset:64
    ds_read_b128 v[144:147], v230 offset:576
    s_waitcnt lgkmcnt(10)
    v_mfma_f32_16x16x32_bf16 v[212:215], v[92:95], v[168:171], v[212:215]
    s_waitcnt vmcnt(10)
    v_lshlrev_b32 v240, 16, v12
    v_and_b32 v241, 0xffff0000, v12
    v_lshlrev_b32 v242, 16, v13
    v_and_b32 v243, 0xffff0000, v13
    v_mfma_f32_16x16x32_bf16 v[216:219], v[96:99], v[168:171], v[216:219]
    v_fma_f32 v230, v202, v222, v240
    v_fma_f32 v231, v202, v223, v241
    v_fma_f32 v148, v200, v148, v230
    v_fma_f32 v149, v200, v149, v231
    v_max_f32 v148, 0, v148
    v_max_f32 v149, 0, v149
    v_mul_f32 v148, v148, v148
    v_mul_f32 v149, v149, v149
    v_cvt_pk_bf16_f32 v232, v148, v149
    s_waitcnt lgkmcnt(8)
    v_mfma_f32_16x16x32_bf16 v[204:207], v[100:103], v[172:175], v[204:207]
    ds_read_b128 v[164:167], v220 offset:12288
    v_mfma_f32_16x16x32_bf16 v[208:211], v[104:107], v[172:175], v[208:211]
    ds_read_b128 v[168:171], v251 offset:12288
    v_fma_f32 v230, v202, v224, v242
    v_fma_f32 v231, v202, v225, v243
    v_fma_f32 v150, v200, v150, v230
    v_fma_f32 v151, v200, v151, v231
    v_max_f32 v150, 0, v150
    v_max_f32 v151, 0, v151
    v_mul_f32 v150, v150, v150
    v_mul_f32 v151, v151, v151
    v_cvt_pk_bf16_f32 v233, v150, v151
    s_waitcnt lgkmcnt(9)
    v_mfma_f32_16x16x32_bf16 v[212:215], v[100:103], v[176:179], v[212:215]
    ds_read_b128 v[188:191], v221 offset:6144
    v_mfma_f32_16x16x32_bf16 v[216:219], v[104:107], v[176:179], v[216:219]
    v_fma_f32 v230, v203, v222, v240
    v_fma_f32 v231, v203, v223, v241
    v_fma_f32 v152, v201, v152, v230
    v_fma_f32 v153, v201, v153, v231
    v_max_f32 v152, 0, v152
    v_max_f32 v153, 0, v153
    v_mul_f32 v152, v152, v152
    v_mul_f32 v153, v153, v153
    v_cvt_pk_bf16_f32 v236, v152, v153
    s_waitcnt lgkmcnt(9)
    v_mfma_f32_16x16x32_bf16 v[196:199], v[192:195], v[16:19], v[196:199]
    s_waitcnt lgkmcnt(8)
    v_mfma_f32_16x16x32_bf16 v[204:207], v[108:111], v[180:183], v[204:207]
    ds_read_b128 v[172:175], v220 offset:13312
    v_mfma_f32_16x16x32_bf16 v[208:211], v[112:115], v[180:183], v[208:211]
    ds_read_b128 v[176:179], v251 offset:13312
    s_mul_i32 s2, s75, 401408
    s_add_u32 s2, s2, 172032
    s_add_u32 s2, s2, s3
    s_add_u32 m0, s59, 40960
    s_nop 0
    buffer_load_dwordx4 v252, s[16:19], s2 offen lds
    s_waitcnt lgkmcnt(9)
    v_mfma_f32_16x16x32_bf16 v[212:215], v[108:111], v[184:187], v[212:215]
    v_fma_f32 v230, v203, v224, v242
    v_fma_f32 v231, v203, v225, v243
    v_fma_f32 v154, v201, v154, v230
    v_fma_f32 v155, v201, v155, v231
    v_max_f32 v154, 0, v154
    v_max_f32 v155, 0, v155
    v_mul_f32 v154, v154, v154
    v_mul_f32 v155, v155, v155
    v_cvt_pk_bf16_f32 v237, v154, v155
    v_mfma_f32_16x16x32_bf16 v[216:219], v[112:115], v[184:187], v[216:219]
    s_waitcnt vmcnt(10)
    v_lshlrev_b32 v240, 16, v4
    v_and_b32 v241, 0xffff0000, v4
    v_lshlrev_b32 v242, 16, v5
    v_and_b32 v243, 0xffff0000, v5
    s_waitcnt lgkmcnt(4)
    v_mfma_f32_16x16x32_bf16 v[204:207], v[116:119], v[164:167], v[204:207]
    v_mfma_f32_16x16x32_bf16 v[208:211], v[120:123], v[164:167], v[208:211]
    v_fma_f32 v230, v202, v226, v240
    v_fma_f32 v231, v202, v227, v241
    v_fma_f32 v156, v200, v156, v230
    v_fma_f32 v157, v200, v157, v231
    v_max_f32 v156, 0, v156
    v_max_f32 v157, 0, v157
    v_mul_f32 v156, v156, v156
    v_mul_f32 v157, v157, v157
    v_cvt_pk_bf16_f32 v234, v156, v157
    s_waitcnt lgkmcnt(3)
    v_mfma_f32_16x16x32_bf16 v[212:215], v[116:119], v[168:171], v[212:215]
    v_mfma_f32_16x16x32_bf16 v[216:219], v[120:123], v[168:171], v[216:219]
    v_fma_f32 v230, v202, v228, v242
    v_fma_f32 v231, v202, v229, v243
    v_fma_f32 v158, v200, v158, v230
    v_fma_f32 v159, v200, v159, v231
    v_max_f32 v158, 0, v158
    v_max_f32 v159, 0, v159
    v_mul_f32 v158, v158, v158
    v_mul_f32 v159, v159, v159
    v_cvt_pk_bf16_f32 v235, v158, v159
    s_waitcnt lgkmcnt(2)
    v_mfma_f32_16x16x32_bf16 v[196:199], v[188:191], v[16:19], v[196:199]
    s_waitcnt lgkmcnt(1)
    v_mfma_f32_16x16x32_bf16 v[204:207], v[124:127], v[172:175], v[204:207]
    v_mfma_f32_16x16x32_bf16 v[208:211], v[128:131], v[172:175], v[208:211]
    v_fma_f32 v230, v203, v226, v240
    v_fma_f32 v231, v203, v227, v241
    v_fma_f32 v160, v201, v160, v230
    v_fma_f32 v161, v201, v161, v231
    v_max_f32 v160, 0, v160
    v_max_f32 v161, 0, v161
    v_mul_f32 v160, v160, v160
    v_mul_f32 v161, v161, v161
    v_cvt_pk_bf16_f32 v238, v160, v161
    s_waitcnt lgkmcnt(0)
    v_mfma_f32_16x16x32_bf16 v[212:215], v[124:127], v[176:179], v[212:215]
    v_fma_f32 v230, v203, v228, v242
    v_fma_f32 v231, v203, v229, v243
    v_fma_f32 v162, v201, v162, v230
    v_fma_f32 v163, v201, v163, v231
    v_max_f32 v162, 0, v162
    v_max_f32 v163, 0, v163
    v_mul_f32 v162, v162, v162
    v_mul_f32 v163, v163, v163
    v_cvt_pk_bf16_f32 v239, v162, v163
    v_mfma_f32_16x16x32_bf16 v[216:219], v[128:131], v[176:179], v[216:219]
    s_bitcmp1_b32 s45, 0
    s_cbranch_scc0 L_noswap_29
    v_swap_b32 v232, v234
    v_swap_b32 v233, v235
    v_swap_b32 v236, v238
    v_swap_b32 v237, v239
L_noswap_29:
    s_mul_i32 s52, s46, 458752
    s_mul_i32 s57, s45, 114688
    s_add_u32 s52, s52, s57
    s_lshl_b32 s57, s47, 12
    s_add_u32 s52, s52, s57
    s_add_u32 s52, s52, 5244928
    s_lshr_b32 s53, s45, 1
    s_xor_b32 s53, s53, 1
    s_lshl_b32 s53, s53, 10
    s_add_u32 s52, s52, s53
    s_add_u32 s53, s52, 57344
    buffer_store_dwordx4 v[232:235], v7, s[8:11], s52 offen sc1
    buffer_store_dwordx4 v[236:239], v7, s[8:11], s53 offen sc1
    s_lshl_b32 s52, s45, 6
    s_add_u32 s52, s52, 158464
    v_lshl_add_u32 v220, v3, 4, s52
    v_cmp_eq_u32 vcc, 0, v2
    s_nop 1
    s_mov_b64 exec, vcc
    ds_write_b128 v220, v[196:199]
    s_mov_b64 exec, -1
    s_waitcnt vmcnt(8)
    s_waitcnt lgkmcnt(0)
    s_barrier
    v_add_u32 v220, 49152, v7
    v_mov_b32 v230, 0
    v_mov_b32 v231, 0
    v_mov_b32 v232, 0
    v_mov_b32 v233, 0
    v_mov_b32 v234, 0
    v_mov_b32 v235, 0
    v_mov_b32 v236, 0
    v_mov_b32 v237, 0
    ds_read_b128 v[164:167], v220 offset:0
    ds_read_b128 v[168:171], v220 offset:14336
    s_waitcnt lgkmcnt(1)
    v_mfma_f32_16x16x32_bf16 v[230:233], v[164:167], v[24:27], v[230:233]
    s_waitcnt lgkmcnt(0)
    v_mfma_f32_16x16x32_bf16 v[234:237], v[168:171], v[24:27], v[234:237]
    ds_read_b128 v[172:175], v220 offset:1024
    ds_read_b128 v[176:179], v220 offset:15360
    v_lshlrev_b32 v239, 2, v2
    v_add_u32 v239, 158336, v239
    ds_read_b32 v240, v239 offset:0
    ds_read_b32 v242, v239 offset:256
    ds_read_b32 v241, v239 offset:64
    s_waitcnt lgkmcnt(4)
    v_mfma_f32_16x16x32_bf16 v[230:233], v[172:175], v[32:35], v[230:233]
    s_waitcnt lgkmcnt(3)
    v_mfma_f32_16x16x32_bf16 v[234:237], v[176:179], v[32:35], v[234:237]
    ds_read_b128 v[164:167], v220 offset:2048
    ds_read_b128 v[168:171], v220 offset:16384
    ds_read_b32 v243, v239 offset:320
    s_waitcnt lgkmcnt(4)
    v_add_f32 v240, v240, v242
    s_waitcnt lgkmcnt(0)
    v_add_f32 v241, v241, v243
    v_cmp_eq_u32 vcc, 12, v2
    v_mov_b32 v238, 0x3f803f80
    v_mfma_f32_16x16x32_bf16 v[230:233], v[164:167], v[40:43], v[230:233]
    v_mfma_f32_16x16x32_bf16 v[234:237], v[168:171], v[40:43], v[234:237]
    ds_read_b128 v[172:175], v220 offset:3072
    ds_read_b128 v[176:179], v220 offset:17408
    v_cndmask_b32 v238, v15, v238, vcc
    s_lshl_b32 s55, s45, 11
    s_add_u32 s55, s55, 147456
    v_add_u32 v239, s55, v7
    v_mul_f32 v204, v132, v204
    s_mul_i32 s2, s75, 401408
    s_add_u32 s2, s2, 229376
    s_add_u32 s2, s2, s3
    s_add_u32 m0, s59, 81920
    s_nop 0
    buffer_load_dwordx4 v252, s[16:19], s2 offen lds
    s_waitcnt lgkmcnt(1)
    v_mfma_f32_16x16x32_bf16 v[230:233], v[172:175], v[48:51], v[230:233]
    s_waitcnt lgkmcnt(0)
    v_mfma_f32_16x16x32_bf16 v[234:237], v[176:179], v[48:51], v[234:237]
    ds_read_b128 v[164:167], v220 offset:4096
    ds_read_b128 v[168:171], v220 offset:18432
    v_fma_f32 v204, v140, v240, v204
    v_mul_f32 v205, v133, v205
    v_fma_f32 v205, v141, v240, v205
    v_mul_f32 v206, v134, v206
    v_fma_f32 v206, v142, v240, v206
    s_mul_i32 s2, s75, 401408
    s_add_u32 s2, s2, 286720
    s_add_u32 s2, s2, s3
    s_add_u32 m0, s59, 90112
    s_nop 0
    buffer_load_dwordx4 v252, s[16:19], s2 offen lds
    s_waitcnt lgkmcnt(1)
    v_mfma_f32_16x16x32_bf16 v[230:233], v[164:167], v[56:59], v[230:233]
    s_waitcnt lgkmcnt(0)
    v_mfma_f32_16x16x32_bf16 v[234:237], v[168:171], v[56:59], v[234:237]
    ds_read_b128 v[172:175], v220 offset:5120
    ds_read_b128 v[176:179], v220 offset:19456
    v_mul_f32 v207, v135, v207
    v_fma_f32 v207, v143, v240, v207
    v_cvt_pk_bf16_f32 v148, v204, v205
    v_cvt_pk_bf16_f32 v149, v206, v207
    v_mul_f32 v208, v136, v208
    s_mul_i32 s2, s75, 401408
    s_add_u32 s2, s2, 344064
    s_add_u32 s2, s2, s3
    s_add_u32 m0, s59, 98304
    s_nop 0
    buffer_load_dwordx4 v252, s[16:19], s2 offen lds
    s_waitcnt lgkmcnt(1)
    v_mfma_f32_16x16x32_bf16 v[230:233], v[172:175], v[64:67], v[230:233]
    s_waitcnt lgkmcnt(0)
    v_mfma_f32_16x16x32_bf16 v[234:237], v[176:179], v[64:67], v[234:237]
    ds_read_b128 v[164:167], v220 offset:6144
    ds_read_b128 v[168:171], v220 offset:20480
    v_fma_f32 v208, v144, v240, v208
    v_mul_f32 v209, v137, v209
    v_fma_f32 v209, v145, v240, v209
    v_mul_f32 v210, v138, v210
    v_fma_f32 v210, v146, v240, v210
    s_mul_i32 s2, s75, 4294565888
    s_add_u32 s2, s2, 401408
    s_add_u32 s2, s2, s3
    s_add_u32 m0, s59, 106496
    s_nop 0
    buffer_load_dwordx4 v252, s[16:19], s2 offen lds
    s_waitcnt lgkmcnt(1)
    v_mfma_f32_16x16x32_bf16 v[230:233], v[164:167], v[72:75], v[230:233]
    s_waitcnt lgkmcnt(0)
    v_mfma_f32_16x16x32_bf16 v[234:237], v[168:171], v[72:75], v[234:237]
    ds_read_b128 v[172:175], v220 offset:7168
    ds_read_b128 v[176:179], v220 offset:21504
    v_mul_f32 v211, v139, v211
    v_fma_f32 v211, v147, v240, v211
    v_cvt_pk_bf16_f32 v150, v208, v209
    v_cvt_pk_bf16_f32 v151, v210, v211
    ds_write_b128 v239, v[148:151] offset:0
    s_waitcnt vmcnt(4)
    s_lshl_b32 s52, s46, 9
    s_lshl_b32 s57, s47, 5
    s_add_u32 s52, s52, s57
    s_lshl_b32 s57, s44, 2
    s_add_u32 s52, s52, s57
    s_add_u32 s52, s52, 12288
    s_mov_b64 exec, 1
    s_cmp_eq_u32 s49, 0
    s_cbranch_scc1 L_slow_30
    buffer_store_dword v14, v15, s[8:11], s52 offen
    s_branch L_mdone_31
L_slow_30:
    buffer_store_dword v14, v15, s[8:11], s52 offen sc1
L_mdone_31:
    s_mov_b64 exec, -1
    s_mul_i32 s2, s75, 4294565888
    s_add_u32 s2, s2, 458752
    s_add_u32 s2, s2, s3
    s_add_u32 m0, s59, 114688
    s_nop 0
    buffer_load_dwordx4 v252, s[16:19], s2 offen lds
    s_waitcnt lgkmcnt(2)
    v_mfma_f32_16x16x32_bf16 v[230:233], v[172:175], v[80:83], v[230:233]
    s_waitcnt lgkmcnt(1)
    v_mfma_f32_16x16x32_bf16 v[234:237], v[176:179], v[80:83], v[234:237]
    ds_read_b128 v[164:167], v220 offset:8192
    ds_read_b128 v[168:171], v220 offset:22528
    v_mul_f32 v212, v132, v212
    v_fma_f32 v212, v140, v241, v212
    v_mul_f32 v213, v133, v213
    v_fma_f32 v213, v141, v241, v213
    v_mul_f32 v214, v134, v214
    s_mul_i32 s2, s75, 4294565888
    s_add_u32 s2, s2, 516096
    s_add_u32 s2, s2, s3
    s_add_u32 m0, s59, 122880
    s_nop 0
    buffer_load_dwordx4 v252, s[16:19], s2 offen lds
    s_waitcnt lgkmcnt(1)
    v_mfma_f32_16x16x32_bf16 v[230:233], v[164:167], v[88:91], v[230:233]
    s_waitcnt lgkmcnt(0)
    v_mfma_f32_16x16x32_bf16 v[234:237], v[168:171], v[88:91], v[234:237]
    ds_read_b128 v[172:175], v220 offset:9216
    ds_read_b128 v[176:179], v220 offset:23552
    v_fma_f32 v214, v142, v241, v214
    v_mul_f32 v215, v135, v215
    v_fma_f32 v215, v143, v241, v215
    v_cvt_pk_bf16_f32 v152, v212, v213
    v_cvt_pk_bf16_f32 v153, v214, v215
    s_mul_i32 s2, s75, 4294565888
    s_add_u32 s2, s2, 573440
    s_add_u32 s2, s2, s3
    s_add_u32 m0, s59, 16384
    s_nop 0
    buffer_load_dwordx4 v252, s[16:19], s2 offen lds
    s_waitcnt lgkmcnt(1)
    v_mfma_f32_16x16x32_bf16 v[230:233], v[172:175], v[96:99], v[230:233]
    s_waitcnt lgkmcnt(0)
    v_mfma_f32_16x16x32_bf16 v[234:237], v[176:179], v[96:99], v[234:237]
    ds_read_b128 v[164:167], v220 offset:10240
    ds_read_b128 v[168:171], v220 offset:24576
    v_mul_f32 v216, v136, v216
    v_fma_f32 v216, v144, v241, v216
    v_mul_f32 v217, v137, v217
    v_fma_f32 v217, v145, v241, v217
    v_mul_f32 v218, v138, v218
    s_mul_i32 s2, s75, 4294565888
    s_add_u32 s2, s2, 630784
    s_add_u32 s2, s2, s3
    s_add_u32 m0, s59, 24576
    s_nop 0
    buffer_load_dwordx4 v252, s[16:19], s2 offen lds
    s_waitcnt lgkmcnt(1)
    v_mfma_f32_16x16x32_bf16 v[230:233], v[164:167], v[104:107], v[230:233]
    s_waitcnt lgkmcnt(0)
    v_mfma_f32_16x16x32_bf16 v[234:237], v[168:171], v[104:107], v[234:237]
    ds_read_b128 v[172:175], v220 offset:11264
    ds_read_b128 v[176:179], v220 offset:25600
    v_fma_f32 v218, v146, v241, v218
    v_mul_f32 v219, v139, v219
    v_fma_f32 v219, v147, v241, v219
    v_cvt_pk_bf16_f32 v154, v216, v217
    v_cvt_pk_bf16_f32 v155, v218, v219
    s_waitcnt lgkmcnt(1)
    v_mfma_f32_16x16x32_bf16 v[230:233], v[172:175], v[112:115], v[230:233]
    s_waitcnt lgkmcnt(0)
    v_mfma_f32_16x16x32_bf16 v[234:237], v[176:179], v[112:115], v[234:237]
    ds_read_b128 v[164:167], v220 offset:12288
    ds_read_b128 v[168:171], v220 offset:26624
    v_cndmask_b32 v152, v152, v238, s[64:65]
    v_cndmask_b32 v153, v153, v238, s[64:65]
    v_cndmask_b32 v154, v154, v238, s[64:65]
    v_cndmask_b32 v155, v155, v238, s[64:65]
    ds_write_b128 v239, v[152:155] offset:1024
    s_waitcnt lgkmcnt(2)
    v_mfma_f32_16x16x32_bf16 v[230:233], v[164:167], v[120:123], v[230:233]
    s_waitcnt lgkmcnt(1)
    v_mfma_f32_16x16x32_bf16 v[234:237], v[168:171], v[120:123], v[234:237]
    ds_read_b128 v[172:175], v220 offset:13312
    ds_read_b128 v[176:179], v220 offset:27648
    s_waitcnt lgkmcnt(1)
    v_mfma_f32_16x16x32_bf16 v[230:233], v[172:175], v[128:131], v[230:233]
    s_waitcnt lgkmcnt(0)
    v_mfma_f32_16x16x32_bf16 v[234:237], v[176:179], v[128:131], v[234:237]
    v_lshrrev_b32 v208, 1, v1
    v_lshlrev_b32 v208, 5, v208
    v_and_b32 v209, 1, v1
    v_lshl_add_u32 v208, v209, 4, v208
    s_lshl_b32 s52, s46, 9
    s_mul_i32 s57, s50, 224
    s_add_u32 s52, s52, s57
    s_lshl_b32 s57, s45, 2
    s_add_u32 s52, s52, s57
    s_add_u32 s52, s52, 12288
    v_add_u32 v208, s52, v208
    buffer_load_dword v248, v208, s[8:11], 0 offen sc1
    s_xor_b32 s53, s50, 0
    s_mul_i32 s52, s46, 458752
    s_mul_i32 s57, s45, 114688
    s_add_u32 s52, s52, s57
    s_mul_i32 s57, s53, 57344
    s_add_u32 s52, s52, s57
    s_mul_i32 s57, s50, 28672
    s_add_u32 s52, s52, s57
    s_add_u32 s52, s52, 5243904
    s_mov_b32 s68, s52
    s_xor_b32 s53, s50, 1
    s_mul_i32 s52, s46, 458752
    s_mul_i32 s57, s45, 114688
    s_add_u32 s52, s52, s57
    s_mul_i32 s57, s53, 57344
    s_add_u32 s52, s52, s57
    s_mul_i32 s57, s50, 28672
    s_add_u32 s52, s52, s57
    s_add_u32 s52, s52, 5243904
    s_mov_b32 s69, s52
    s_barrier
    s_waitcnt vmcnt(0)
    v_mov_b32 v254, v248
    s_mov_b32 exec_lo, 16383
    s_mov_b32 exec_hi, 0
    v_cmp_ne_u32 vcc, s48, v254
    s_mov_b64 exec, -1
    s_nop 0
    s_cmp_eq_u64 vcc, 0
    s_cbranch_scc1 L_eok_32
    s_mov_b32 s52, 0
    s_mov_b32 exec_lo, 16383
    s_mov_b32 exec_hi, 0
    s_mov_b32 s70, 0
L_poll_33:
    buffer_load_dword v254, v208, s[8:11], s52 offen sc1
    s_waitcnt vmcnt(0)
    v_cmp_ne_u32 vcc, s48, v254
    s_nop 4
    s_cmp_eq_u64 vcc, 0
    s_cbranch_scc1 L_polld_34
    s_add_u32 s70, s70, 1
    s_cmp_lt_u32 s70, 4000
    s_cbranch_scc1 L_poll_33
L_polld_34:
    s_mov_b64 exec, -1
L_eok_32:
    s_lshl_b32 s52, s45, 10
    s_add_u32 s52, s52, 159744
    v_add_u32 v238, s52, v7
    ds_read_b128 v[116:119], v238
    v_lshrrev_b32 v243, 2, v2
    v_lshl_add_u32 v243, v3, 2, v243
    v_mul_u32_u24 v243, 56, v243
    v_and_b32 v244, 3, v1
    v_lshl_add_u32 v243, v244, 3, v243
    v_add_u32 v243, 155648, v243
    ds_read_b64_tr_b16 v[104:105], v243 offset:0
    ds_read_b64_tr_b16 v[106:107], v243 offset:896
    ds_read_b64_tr_b16 v[108:109], v243 offset:32
    ds_read_b64_tr_b16 v[110:111], v243 offset:928
    v_lshlrev_b32 v220, 4, v3
    v_add_u32 v220, 158720, v220
    ds_read_b128 v[84:87], v220 offset:0
    ds_read_b128 v[92:95], v220 offset:128
    ds_read_b128 v[88:91], v220 offset:64
    ds_read_b128 v[96:99], v220 offset:192
    s_waitcnt lgkmcnt(2)
    v_add_f32 v84, v84, v92
    v_add_f32 v85, v85, v93
    v_add_f32 v86, v86, v94
    v_add_f32 v87, v87, v95
    s_waitcnt lgkmcnt(0)
    v_add_f32 v88, v88, v96
    v_add_f32 v89, v89, v97
    v_add_f32 v90, v90, v98
    v_add_f32 v91, v91, v99
    v_mul_f32 v230, v201, v230
    v_fma_f32 v230, v203, v84, v230
    v_mul_f32 v231, v201, v231
    v_fma_f32 v231, v203, v85, v231
    v_mul_f32 v232, v201, v232
    v_fma_f32 v232, v203, v86, v232
    v_mul_f32 v233, v201, v233
    v_fma_f32 v233, v203, v87, v233
    v_cvt_pk_bf16_f32 v120, v230, v231
    v_cvt_pk_bf16_f32 v121, v232, v233
    v_mul_f32 v234, v201, v234
    v_fma_f32 v234, v203, v88, v234
    v_mul_f32 v235, v201, v235
    v_fma_f32 v235, v203, v89, v235
    v_mul_f32 v236, v201, v236
    v_fma_f32 v236, v203, v90, v236
    v_mul_f32 v237, v201, v237
    v_fma_f32 v237, v203, v91, v237
    v_cvt_pk_bf16_f32 v122, v234, v235
    v_cvt_pk_bf16_f32 v123, v236, v237
    v_cndmask_b32 v106, v106, v15, s[62:63]
    v_cndmask_b32 v107, v107, v15, s[62:63]
    v_cndmask_b32 v110, v110, v15, s[62:63]
    v_cndmask_b32 v111, v111, v15, s[62:63]
    v_lshrrev_b32 v220, 1, v2
    v_and_b32 v220, 3, v220
    v_lshlrev_b32 v221, 7, v2
    v_lshl_add_u32 v221, v3, 3, v221
    s_lshl_b32 s52, s45, 12
    s_add_u32 s52, s52, 131072
    v_add_u32 v221, s52, v221
    v_xor_b32 v196, 0, v220
    v_lshl_add_u32 v204, v196, 5, v221
    v_xor_b32 v196, 1, v220
    v_lshl_add_u32 v205, v196, 5, v221
    v_xor_b32 v196, 2, v220
    v_lshl_add_u32 v206, v196, 5, v221
    v_xor_b32 v196, 3, v220
    v_lshl_add_u32 v207, v196, 5, v221
    v_mfma_f32_16x16x32_bf16 v[84:87], v[104:107], v[116:119], 0
    v_mfma_f32_16x16x32_bf16 v[88:91], v[108:111], v[116:119], 0
    s_nop 6
    v_max3_f32 v222, v84, v85, v86
    v_max3_f32 v224, v88, v89, v90
    v_min3_f32 v223, v84, v85, v86
    v_min3_f32 v225, v88, v89, v90
    v_max_f32 v222, v222, v87
    v_max_f32 v224, v224, v91
    v_min_f32 v223, v223, v87
    v_min_f32 v225, v225, v91
    v_mov_b32 v226, 0x7149f2ca
    v_cndmask_b32 v224, v224, v222, s[62:63]
    v_cndmask_b32 v225, v225, v223, s[62:63]
    s_mov_b32 s56, 0x3fb8aa3b
    v_max_f32 v222, v222, v224
    v_min_f32 v223, v223, v225
    v_mul_f32 v222, 0x3fb8aa3b, v222
    v_mul_f32 v223, 0xbfb8aa3b, v223
    s_nop 1
    v_permlane32_swap_b32 v222, v223
    s_mul_i32 s2, s75, 14336
    s_add_u32 s2, s2, 0
    s_add_u32 s57, s2, s69
    s_add_u32 s2, s2, s68
    buffer_load_dwordx4 v[20:23], v7, s[8:11], s2 offen sc1
    buffer_load_dwordx4 v[24:27], v7, s[8:11], s57 offen sc1
    v_max_f32 v222, v222, v223
    v_mov_b32 v224, v222
    s_nop 1
    v_permlane16_swap_b32 v222, v224
    v_max_f32 v222, v222, v224
    v_mov_b32 v223, v222
    s_nop 1
    v_permlane32_swap_b32 v222, v223
    v_cndmask_b32 v224, v222, v226, s[62:63]
    v_cndmask_b32 v225, v223, v226, s[62:63]
    v_fma_f32 v227, v84, s56, -v222
    v_fma_f32 v235, -v84, s56, -v223
    v_fma_f32 v228, v85, s56, -v222
    v_fma_f32 v236, -v85, s56, -v223
    v_fma_f32 v229, v86, s56, -v222
    v_fma_f32 v237, -v86, s56, -v223
    v_fma_f32 v230, v87, s56, -v222
    v_fma_f32 v238, -v87, s56, -v223
    v_fma_f32 v231, v88, s56, -v224
    v_fma_f32 v239, -v88, s56, -v225
    s_mul_i32 s2, s75, 14336
    s_add_u32 s2, s2, 2048
    s_add_u32 s57, s2, s69
    s_add_u32 s2, s2, s68
    buffer_load_dwordx4 v[28:31], v7, s[8:11], s2 offen sc1
    buffer_load_dwordx4 v[32:35], v7, s[8:11], s57 offen sc1
    v_fma_f32 v232, v89, s56, -v224
    v_fma_f32 v240, -v89, s56, -v225
    v_fma_f32 v233, v90, s56, -v224
    v_fma_f32 v241, -v90, s56, -v225
    v_fma_f32 v234, v91, s56, -v224
    v_fma_f32 v242, -v91, s56, -v225
    v_exp_f32 v227, v227
    v_exp_f32 v235, v235
    v_exp_f32 v228, v228
    v_exp_f32 v236, v236
    v_exp_f32 v229, v229
    v_exp_f32 v237, v237
    v_exp_f32 v230, v230
    v_exp_f32 v238, v238
    v_exp_f32 v231, v231
    v_exp_f32 v239, v239
    v_exp_f32 v232, v232
    v_exp_f32 v240, v240
    v_exp_f32 v233, v233
    s_mul_i32 s2, s75, 14336
    s_add_u32 s2, s2, 4096
    s_add_u32 s57, s2, s69
    s_add_u32 s2, s2, s68
    buffer_load_dwordx4 v[36:39], v7, s[8:11], s2 offen sc1
    buffer_load_dwordx4 v[40:43], v7, s[8:11], s57 offen sc1
    v_exp_f32 v241, v241
    v_exp_f32 v234, v234
    v_exp_f32 v242, v242
    v_add_f32 v222, v227, v228
    v_add_f32 v223, v235, v236
    v_add_f32 v224, v229, v230
    v_add_f32 v225, v237, v238
    v_add_f32 v222, v222, v231
    v_add_f32 v223, v223, v239
    v_add_f32 v224, v224, v232
    v_add_f32 v225, v225, v240
    v_add_f32 v222, v222, v233
    v_add_f32 v223, v223, v241
    v_add_f32 v224, v224, v234
    v_add_f32 v225, v225, v242
    v_add_f32 v222, v222, v224
    v_add_f32 v223, v223, v225
    s_nop 1
    v_permlane32_swap_b32 v222, v223
    s_mul_i32 s2, s75, 14336
    s_add_u32 s2, s2, 6144
    s_add_u32 s57, s2, s69
    s_add_u32 s2, s2, s68
    buffer_load_dwordx4 v[44:47], v7, s[8:11], s2 offen sc1
    buffer_load_dwordx4 v[48:51], v7, s[8:11], s57 offen sc1
    v_add_f32 v222, v222, v223
    v_mov_b32 v224, v222
    s_nop 1
    v_permlane16_swap_b32 v222, v224
    v_add_f32 v222, v222, v224
    v_mov_b32 v223, v222
    s_nop 1
    v_permlane32_swap_b32 v222, v223
    v_rcp_f32 v222, v222
    v_rcp_f32 v223, v223
    v_mul_f32 v227, v222, v227
    v_mul_f32 v235, v223, v235
    v_mul_f32 v228, v222, v228
    v_mul_f32 v236, v223, v236
    v_mul_f32 v229, v222, v229
    v_mul_f32 v237, v223, v237
    v_mul_f32 v230, v222, v230
    v_mul_f32 v238, v223, v238
    v_mul_f32 v231, v222, v231
    v_mul_f32 v239, v223, v239
    s_mul_i32 s2, s75, 14336
    s_add_u32 s2, s2, 8192
    s_add_u32 s57, s2, s69
    s_add_u32 s2, s2, s68
    buffer_load_dwordx4 v[52:55], v7, s[8:11], s2 offen sc1
    buffer_load_dwordx4 v[56:59], v7, s[8:11], s57 offen sc1
    v_mul_f32 v232, v222, v232
    v_mul_f32 v240, v223, v240
    v_mul_f32 v233, v222, v233
    v_mul_f32 v241, v223, v241
    v_mul_f32 v234, v222, v234
    v_mul_f32 v242, v223, v242
    v_cvt_pk_bf16_f32 v92, v227, v228
    v_cvt_pk_bf16_f32 v96, v235, v236
    v_cvt_pk_bf16_f32 v93, v229, v230
    v_cvt_pk_bf16_f32 v97, v237, v238
    v_cvt_pk_bf16_f32 v94, v231, v232
    v_cvt_pk_bf16_f32 v98, v239, v240
    v_cvt_pk_bf16_f32 v95, v233, v234
    v_cvt_pk_bf16_f32 v99, v241, v242
    ds_write_b64 v204, v[92:93] offset:2048
    ds_write_b64 v205, v[94:95] offset:2048
    ds_write_b64 v206, v[96:97] offset:2048
    ds_write_b64 v207, v[98:99] offset:2048
    s_waitcnt lgkmcnt(0)
    s_barrier
    v_lshrrev_b32 v222, 2, v2
    v_lshl_add_u32 v223, v3, 2, v222
    v_lshrrev_b32 v224, 1, v223
    v_and_b32 v224, 3, v224
    s_lshr_b32 s52, s44, 1
    v_xor_b32 v224, s52, v224
    v_lshlrev_b32 v223, 7, v223
    v_lshl_add_u32 v223, v224, 5, v223
    v_and_b32 v224, 3, v1
    v_lshl_add_u32 v223, v224, 3, v223
    v_add_u32 v223, 131072, v223
    s_and_b32 s52, s44, 1
    s_lshl_b32 s52, s52, 10
    s_add_u32 s52, s52, 147456
    v_add_u32 v224, s52, v7
    ds_read_b64_tr_b16 v[84:85], v223 offset:0
    ds_read_b64_tr_b16 v[86:87], v223 offset:2048
    ds_read_b128 v[112:115], v224 offset:0
    ds_read_b64_tr_b16 v[88:89], v223 offset:4096
    ds_read_b64_tr_b16 v[90:91], v223 offset:6144
    ds_read_b128 v[116:119], v224 offset:2048
    ds_read_b64_tr_b16 v[92:93], v223 offset:8192
    ds_read_b64_tr_b16 v[94:95], v223 offset:10240
    ds_read_b128 v[124:127], v224 offset:4096
    ds_read_b64_tr_b16 v[96:97], v223 offset:12288
    ds_read_b64_tr_b16 v[98:99], v223 offset:14336
    ds_read_b128 v[128:131], v224 offset:6144
    s_waitcnt lgkmcnt(9)
    v_mfma_f32_16x16x32_bf16 v[226:229], v[84:87], v[112:115], 0
    s_waitcnt lgkmcnt(6)
    v_mfma_f32_16x16x32_bf16 v[226:229], v[88:91], v[116:119], v[226:229]
    s_waitcnt lgkmcnt(3)
    v_mfma_f32_16x16x32_bf16 v[226:229], v[92:95], v[124:127], v[226:229]
    s_waitcnt lgkmcnt(0)
    v_mfma_f32_16x16x32_bf16 v[226:229], v[96:99], v[128:131], v[226:229]
    s_lshl_b32 s52, s47, 17
    s_lshl_b32 s57, s46, 13
    s_add_u32 s52, s52, s57
    s_lshl_b32 s57, s44, 10
    s_add_u32 s52, s52, s57
    s_add_u32 s52, s52, 2097152
    s_nop 1
    v_bfi_b32 v226, s74, v14, v226
    buffer_store_dwordx4 v[226:229], v7, s[8:11], s52 offen sc1
    v_lshrrev_b32 v232, 2, v2
    v_lshl_add_u32 v233, v3, 2, v232
    v_lshrrev_b32 v234, 1, v233
    v_and_b32 v234, 3, v234
    v_lshlrev_b32 v233, 7, v233
    v_and_b32 v235, 3, v1
    v_lshl_add_u32 v233, v235, 3, v233
    v_xor_b32 v235, 0, v234
    v_lshl_add_u32 v8, v235, 5, v233
    v_add_u32 v216, 0x10000, v8
    v_xor_b32 v235, 1, v234
    v_lshl_add_u32 v9, v235, 5, v233
    v_add_u32 v217, 0x10000, v9
    v_xor_b32 v235, 2, v234
    v_lshl_add_u32 v10, v235, 5, v233
    v_add_u32 v218, 0x10000, v10
    v_xor_b32 v235, 3, v234
    v_lshl_add_u32 v11, v235, 5, v233
    v_add_u32 v219, 0x10000, v11
    v_mov_b32 v132, 0
    v_mov_b32 v133, 0
    v_mov_b32 v134, 0
    v_mov_b32 v135, 0
    v_mov_b32 v136, 0
    v_mov_b32 v137, 0
    v_mov_b32 v138, 0
    v_mov_b32 v139, 0
    v_mov_b32 v140, 0
    v_mov_b32 v141, 0
    v_mov_b32 v142, 0
    v_mov_b32 v143, 0
    v_mov_b32 v144, 0
    v_mov_b32 v145, 0
    v_mov_b32 v146, 0
    v_mov_b32 v147, 0
    v_mov_b32 v148, 0
    v_mov_b32 v149, 0
    v_mov_b32 v150, 0
    v_mov_b32 v151, 0
    v_mov_b32 v152, 0
    v_mov_b32 v153, 0
    v_mov_b32 v154, 0
    v_mov_b32 v155, 0
    v_mov_b32 v156, 0
    v_mov_b32 v157, 0
    v_mov_b32 v158, 0
    v_mov_b32 v159, 0
    v_mov_b32 v160, 0
    v_mov_b32 v161, 0
    v_mov_b32 v162, 0
    v_mov_b32 v163, 0
    s_lshr_b32 s52, s44, 1
    s_lshl_b32 s52, s52, 1
    s_add_u32 s52, s52, s50
    s_lshl_b32 s52, s52, 4
    s_and_b32 s53, s44, 1
    s_lshl_b32 s53, s53, 3
    s_add_u32 s52, s52, s53
    s_lshl_b32 s53, s46, 7
    s_add_u32 s52, s52, s53
    v_lshrrev_b32 v236, 3, v1
    v_and_b32 v237, 7, v1
    v_xor_b32 v237, v237, v236
    v_add_u32 v236, s52, v236
    v_mul_u32_u24 v236, 896, v236
    v_lshl_add_u32 v4, v237, 4, v236
    s_lshl_b32 s52, s51, 7
    v_add_u32 v4, s52, v4
    v_lshlrev_b32 v5, 3, v3
    ds_read_b64_tr_b16 v[164:165], v8 offset:4096
    ds_read_b64_tr_b16 v[166:167], v8 offset:6144
    ds_read_b64_tr_b16 v[168:169], v9 offset:4096
    ds_read_b64_tr_b16 v[170:171], v9 offset:6144
    ds_read_b64_tr_b16 v[172:173], v10 offset:4096
    ds_read_b64_tr_b16 v[174:175], v10 offset:6144
    ds_read_b64_tr_b16 v[176:177], v11 offset:4096
    ds_read_b64_tr_b16 v[178:179], v11 offset:6144
    s_waitcnt vmcnt(10) lgkmcnt(6)
    v_mfma_f32_16x16x32_bf16 v[132:135], v[164:167], v[20:23], v[132:135]
    ds_read_b64_tr_b16 v[180:181], v8 offset:12288
    s_waitcnt vmcnt(9)
    v_mfma_f32_16x16x32_bf16 v[136:139], v[164:167], v[24:27], v[136:139]
    ds_read_b64_tr_b16 v[182:183], v8 offset:14336
    s_mul_i32 s2, s75, 4294565888
    s_add_u32 s2, s2, 688128
    s_add_u32 s2, s2, s3
    s_add_u32 m0, s59, 49152
    s_nop 0
    buffer_load_dwordx4 v252, s[16:19], s2 offen lds
    s_waitcnt lgkmcnt(6)
    v_mfma_f32_16x16x32_bf16 v[140:143], v[168:171], v[20:23], v[140:143]
    ds_read_b64_tr_b16 v[184:185], v9 offset:12288
    v_mfma_f32_16x16x32_bf16 v[144:147], v[168:171], v[24:27], v[144:147]
    ds_read_b64_tr_b16 v[186:187], v9 offset:14336
    s_mul_i32 s2, s75, 4294565888
    s_add_u32 s2, s2, 745472
    s_add_u32 s2, s2, s3
    s_add_u32 m0, s59, 57344
    s_nop 0
    buffer_load_dwordx4 v252, s[16:19], s2 offen lds
    s_waitcnt lgkmcnt(6)
    v_mfma_f32_16x16x32_bf16 v[148:151], v[172:175], v[20:23], v[148:151]
    ds_read_b64_tr_b16 v[188:189], v10 offset:12288
    s_mul_i32 s2, s75, 14336
    s_add_u32 s2, s2, 10240
    s_add_u32 s57, s2, s69
    s_add_u32 s2, s2, s68
    buffer_load_dwordx4 v[60:63], v7, s[8:11], s2 offen sc1
    buffer_load_dwordx4 v[64:67], v7, s[8:11], s57 offen sc1
    v_mfma_f32_16x16x32_bf16 v[152:155], v[172:175], v[24:27], v[152:155]
    ds_read_b64_tr_b16 v[190:191], v10 offset:14336
    s_waitcnt lgkmcnt(6)
    v_mfma_f32_16x16x32_bf16 v[156:159], v[176:179], v[20:23], v[156:159]
    ds_read_b64_tr_b16 v[192:193], v11 offset:12288
    v_mfma_f32_16x16x32_bf16 v[84:87], v[104:107], v[120:123], 0
    v_mfma_f32_16x16x32_bf16 v[88:91], v[108:111], v[120:123], 0
    s_nop 6
    v_max3_f32 v222, v84, v85, v86
    v_max3_f32 v224, v88, v89, v90
    v_min3_f32 v223, v84, v85, v86
    v_min3_f32 v225, v88, v89, v90
    v_max_f32 v222, v222, v87
    v_max_f32 v224, v224, v91
    v_min_f32 v223, v223, v87
    v_min_f32 v225, v225, v91
    v_mov_b32 v226, 0x7149f2ca
    v_cndmask_b32 v224, v224, v222, s[62:63]
    v_cndmask_b32 v225, v225, v223, s[62:63]
    s_mov_b32 s56, 0x3fb8aa3b
    v_max_f32 v222, v222, v224
    v_mfma_f32_16x16x32_bf16 v[160:163], v[176:179], v[24:27], v[160:163]
    ds_read_b64_tr_b16 v[194:195], v11 offset:14336
    s_waitcnt vmcnt(12) lgkmcnt(6)
    v_mfma_f32_16x16x32_bf16 v[132:135], v[180:183], v[28:31], v[132:135]
    ds_read_b64_tr_b16 v[164:165], v8 offset:36864
    s_waitcnt vmcnt(11)
    v_mfma_f32_16x16x32_bf16 v[136:139], v[180:183], v[32:35], v[136:139]
    ds_read_b64_tr_b16 v[166:167], v8 offset:38912
    s_mov_b32 s2, 100352
    s_add_u32 m0, s59, 65536
    s_nop 0
    buffer_load_dwordx4 v253, s[20:23], s2 offen lds
    s_waitcnt lgkmcnt(6)
    v_mfma_f32_16x16x32_bf16 v[140:143], v[184:187], v[28:31], v[140:143]
    ds_read_b64_tr_b16 v[168:169], v9 offset:36864
    v_mfma_f32_16x16x32_bf16 v[144:147], v[184:187], v[32:35], v[144:147]
    ds_read_b64_tr_b16 v[170:171], v9 offset:38912
    s_mov_b32 s2, 150528
    s_add_u32 m0, s59, 73728
    s_nop 0
    buffer_load_dwordx4 v253, s[20:23], s2 offen lds
    s_waitcnt lgkmcnt(6)
    v_mfma_f32_16x16x32_bf16 v[148:151], v[188:191], v[28:31], v[148:151]
    ds_read_b64_tr_b16 v[172:173], v10 offset:36864
    s_mul_i32 s2, s75, 14336
    s_add_u32 s2, s2, 12288
    s_add_u32 s57, s2, s69
    s_add_u32 s2, s2, s68
    buffer_load_dwordx4 v[68:71], v7, s[8:11], s2 offen sc1
    buffer_load_dwordx4 v[72:75], v7, s[8:11], s57 offen sc1
    v_mfma_f32_16x16x32_bf16 v[152:155], v[188:191], v[32:35], v[152:155]
    ds_read_b64_tr_b16 v[174:175], v10 offset:38912
    s_waitcnt lgkmcnt(6)
    v_mfma_f32_16x16x32_bf16 v[156:159], v[192:195], v[28:31], v[156:159]
    ds_read_b64_tr_b16 v[176:177], v11 offset:36864
    v_min_f32 v223, v223, v225
    v_mul_f32 v222, 0x3fb8aa3b, v222
    v_mul_f32 v223, 0xbfb8aa3b, v223
    s_nop 1
    v_permlane32_swap_b32 v222, v223
    v_max_f32 v222, v222, v223
    v_mov_b32 v224, v222
    s_nop 1
    v_permlane16_swap_b32 v222, v224
    v_max_f32 v222, v222, v224
    v_mov_b32 v223, v222
    s_nop 1
    v_permlane32_swap_b32 v222, v223
    v_cndmask_b32 v224, v222, v226, s[62:63]
    v_cndmask_b32 v225, v223, v226, s[62:63]
    v_fma_f32 v227, v84, s56, -v222
    v_fma_f32 v235, -v84, s56, -v223
    v_fma_f32 v228, v85, s56, -v222
    v_mfma_f32_16x16x32_bf16 v[160:163], v[192:195], v[32:35], v[160:163]
    ds_read_b64_tr_b16 v[178:179], v11 offset:38912
    s_waitcnt vmcnt(14) lgkmcnt(6)
    v_mfma_f32_16x16x32_bf16 v[132:135], v[164:167], v[36:39], v[132:135]
    ds_read_b64_tr_b16 v[180:181], v8 offset:45056
    s_waitcnt vmcnt(13)
    v_mfma_f32_16x16x32_bf16 v[136:139], v[164:167], v[40:43], v[136:139]
    ds_read_b64_tr_b16 v[182:183], v8 offset:47104
    s_waitcnt lgkmcnt(6)
    v_mfma_f32_16x16x32_bf16 v[140:143], v[168:171], v[36:39], v[140:143]
    ds_read_b64_tr_b16 v[184:185], v9 offset:45056
    s_mul_i32 s2, s75, 4294952960
    s_add_u32 s2, s2, 14336
    s_add_u32 s57, s2, s69
    s_add_u32 s2, s2, s68
    buffer_load_dwordx4 v[76:79], v7, s[8:11], s2 offen sc1
    buffer_load_dwordx4 v[80:83], v7, s[8:11], s57 offen sc1
    v_mfma_f32_16x16x32_bf16 v[144:147], v[168:171], v[40:43], v[144:147]
    ds_read_b64_tr_b16 v[186:187], v9 offset:47104
    s_waitcnt lgkmcnt(6)
    v_mfma_f32_16x16x32_bf16 v[148:151], v[172:175], v[36:39], v[148:151]
    ds_read_b64_tr_b16 v[188:189], v10 offset:45056
    v_mfma_f32_16x16x32_bf16 v[152:155], v[172:175], v[40:43], v[152:155]
    ds_read_b64_tr_b16 v[190:191], v10 offset:47104
    v_fma_f32 v236, -v85, s56, -v223
    v_fma_f32 v229, v86, s56, -v222
    v_fma_f32 v237, -v86, s56, -v223
    v_fma_f32 v230, v87, s56, -v222
    v_fma_f32 v238, -v87, s56, -v223
    v_fma_f32 v231, v88, s56, -v224
    v_fma_f32 v239, -v88, s56, -v225
    v_fma_f32 v232, v89, s56, -v224
    v_fma_f32 v240, -v89, s56, -v225
    v_fma_f32 v233, v90, s56, -v224
    v_fma_f32 v241, -v90, s56, -v225
    v_fma_f32 v234, v91, s56, -v224
    v_fma_f32 v242, -v91, s56, -v225
    v_exp_f32 v227, v227
    v_exp_f32 v235, v235
    s_waitcnt lgkmcnt(6)
    v_mfma_f32_16x16x32_bf16 v[156:159], v[176:179], v[36:39], v[156:159]
    ds_read_b64_tr_b16 v[192:193], v11 offset:45056
    v_mfma_f32_16x16x32_bf16 v[160:163], v[176:179], v[40:43], v[160:163]
    ds_read_b64_tr_b16 v[194:195], v11 offset:47104
    s_waitcnt lgkmcnt(0)
    s_barrier
    s_waitcnt vmcnt(14)
    v_mfma_f32_16x16x32_bf16 v[132:135], v[180:183], v[44:47], v[132:135]
    ds_read_b64_tr_b16 v[164:165], v216 offset:20480
    s_waitcnt vmcnt(13)
    v_mfma_f32_16x16x32_bf16 v[136:139], v[180:183], v[48:51], v[136:139]
    ds_read_b64_tr_b16 v[166:167], v216 offset:22528
    v_mfma_f32_16x16x32_bf16 v[140:143], v[184:187], v[44:47], v[140:143]
    ds_read_b64_tr_b16 v[168:169], v217 offset:20480
    s_mul_i32 s2, s75, 4294952960
    s_add_u32 s2, s2, 16384
    s_add_u32 s57, s2, s69
    s_add_u32 s2, s2, s68
    buffer_load_dwordx4 v[20:23], v7, s[8:11], s2 offen sc1
    buffer_load_dwordx4 v[24:27], v7, s[8:11], s57 offen sc1
    v_mfma_f32_16x16x32_bf16 v[144:147], v[184:187], v[48:51], v[144:147]
    ds_read_b64_tr_b16 v[170:171], v217 offset:22528
    v_mfma_f32_16x16x32_bf16 v[148:151], v[188:191], v[44:47], v[148:151]
    ds_read_b64_tr_b16 v[172:173], v218 offset:20480
    v_mfma_f32_16x16x32_bf16 v[152:155], v[188:191], v[48:51], v[152:155]
    ds_read_b64_tr_b16 v[174:175], v218 offset:22528
    v_exp_f32 v228, v228
    v_exp_f32 v236, v236
    v_exp_f32 v229, v229
    v_exp_f32 v237, v237
    v_exp_f32 v230, v230
    v_exp_f32 v238, v238
    v_exp_f32 v231, v231
    v_exp_f32 v239, v239
    v_exp_f32 v232, v232
    v_exp_f32 v240, v240
    v_exp_f32 v233, v233
    v_exp_f32 v241, v241
    v_exp_f32 v234, v234
    v_exp_f32 v242, v242
    v_add_f32 v222, v227, v228
    v_mfma_f32_16x16x32_bf16 v[156:159], v[192:195], v[44:47], v[156:159]
    ds_read_b64_tr_b16 v[176:177], v219 offset:20480
    v_mfma_f32_16x16x32_bf16 v[160:163], v[192:195], v[48:51], v[160:163]
    ds_read_b64_tr_b16 v[178:179], v219 offset:22528
    s_waitcnt vmcnt(14) lgkmcnt(6)
    v_mfma_f32_16x16x32_bf16 v[132:135], v[164:167], v[52:55], v[132:135]
    ds_read_b64_tr_b16 v[180:181], v216 offset:28672
    s_waitcnt vmcnt(13)
    v_mfma_f32_16x16x32_bf16 v[136:139], v[164:167], v[56:59], v[136:139]
    ds_read_b64_tr_b16 v[182:183], v216 offset:30720
    s_waitcnt lgkmcnt(6)
    v_mfma_f32_16x16x32_bf16 v[140:143], v[168:171], v[52:55], v[140:143]
    ds_read_b64_tr_b16 v[184:185], v217 offset:28672
    s_mul_i32 s2, s75, 4294952960
    s_add_u32 s2, s2, 18432
    s_add_u32 s57, s2, s69
    s_add_u32 s2, s2, s68
    buffer_load_dwordx4 v[28:31], v7, s[8:11], s2 offen sc1
    buffer_load_dwordx4 v[32:35], v7, s[8:11], s57 offen sc1
    v_mfma_f32_16x16x32_bf16 v[144:147], v[168:171], v[56:59], v[144:147]
    ds_read_b64_tr_b16 v[186:187], v217 offset:30720
    s_waitcnt lgkmcnt(6)
    v_mfma_f32_16x16x32_bf16 v[148:151], v[172:175], v[52:55], v[148:151]
    ds_read_b64_tr_b16 v[188:189], v218 offset:28672
    v_mfma_f32_16x16x32_bf16 v[152:155], v[172:175], v[56:59], v[152:155]
    ds_read_b64_tr_b16 v[190:191], v218 offset:30720
    v_add_f32 v223, v235, v236
    v_add_f32 v224, v229, v230
    v_add_f32 v225, v237, v238
    v_add_f32 v222, v222, v231
    v_add_f32 v223, v223, v239
    v_add_f32 v224, v224, v232
    v_add_f32 v225, v225, v240
    v_add_f32 v222, v222, v233
    v_add_f32 v223, v223, v241
    v_add_f32 v224, v224, v234
    v_add_f32 v225, v225, v242
    v_add_f32 v222, v222, v224
    v_add_f32 v223, v223, v225
    s_nop 1
    v_permlane32_swap_b32 v222, v223
    v_add_f32 v222, v222, v223
    s_waitcnt lgkmcnt(6)
    v_mfma_f32_16x16x32_bf16 v[156:159], v[176:179], v[52:55], v[156:159]
    ds_read_b64_tr_b16 v[192:193], v219 offset:28672
    v_mfma_f32_16x16x32_bf16 v[160:163], v[176:179], v[56:59], v[160:163]
    ds_read_b64_tr_b16 v[194:195], v219 offset:30720
    s_waitcnt vmcnt(11) lgkmcnt(6)
    v_mfma_f32_16x16x32_bf16 v[132:135], v[180:183], v[60:63], v[132:135]
    ds_read_b64_tr_b16 v[164:165], v216 offset:36864
    s_waitcnt vmcnt(10)
    v_mfma_f32_16x16x32_bf16 v[136:139], v[180:183], v[64:67], v[136:139]
    ds_read_b64_tr_b16 v[166:167], v216 offset:38912
    s_waitcnt lgkmcnt(6)
    v_mfma_f32_16x16x32_bf16 v[140:143], v[184:187], v[60:63], v[140:143]
    ds_read_b64_tr_b16 v[168:169], v217 offset:36864
    s_mul_i32 s2, s75, 4294952960
    s_add_u32 s2, s2, 20480
    s_add_u32 s57, s2, s69
    s_add_u32 s2, s2, s68
    buffer_load_dwordx4 v[36:39], v7, s[8:11], s2 offen sc1
    buffer_load_dwordx4 v[40:43], v7, s[8:11], s57 offen sc1
    v_mfma_f32_16x16x32_bf16 v[144:147], v[184:187], v[64:67], v[144:147]
    ds_read_b64_tr_b16 v[170:171], v217 offset:38912
    s_waitcnt lgkmcnt(6)
    v_mfma_f32_16x16x32_bf16 v[148:151], v[188:191], v[60:63], v[148:151]
    ds_read_b64_tr_b16 v[172:173], v218 offset:36864
    v_mfma_f32_16x16x32_bf16 v[152:155], v[188:191], v[64:67], v[152:155]
    ds_read_b64_tr_b16 v[174:175], v218 offset:38912
    v_mov_b32 v224, v222
    s_nop 1
    v_permlane16_swap_b32 v222, v224
    v_add_f32 v222, v222, v224
    v_mov_b32 v223, v222
    s_nop 1
    v_permlane32_swap_b32 v222, v223
    v_rcp_f32 v222, v222
    v_rcp_f32 v223, v223
    v_mul_f32 v227, v222, v227
    v_mul_f32 v235, v223, v235
    v_mul_f32 v228, v222, v228
    v_mul_f32 v236, v223, v236
    v_mul_f32 v229, v222, v229
    v_mul_f32 v237, v223, v237
    v_mul_f32 v230, v222, v230
    v_mul_f32 v238, v223, v238
    s_waitcnt lgkmcnt(6)
    v_mfma_f32_16x16x32_bf16 v[156:159], v[192:195], v[60:63], v[156:159]
    ds_read_b64_tr_b16 v[176:177], v219 offset:36864
    v_mfma_f32_16x16x32_bf16 v[160:163], v[192:195], v[64:67], v[160:163]
    ds_read_b64_tr_b16 v[178:179], v219 offset:38912
    s_waitcnt lgkmcnt(0)
    s_barrier
    s_waitcnt vmcnt(9)
    v_mfma_f32_16x16x32_bf16 v[132:135], v[164:167], v[68:71], v[132:135]
    ds_read_b64_tr_b16 v[180:181], v216 offset:45056
    s_waitcnt vmcnt(8)
    v_mfma_f32_16x16x32_bf16 v[136:139], v[164:167], v[72:75], v[136:139]
    ds_read_b64_tr_b16 v[182:183], v216 offset:47104
    s_mov_b32 s2, 0
    s_add_u32 m0, s59, 131072
    s_nop 0
    buffer_load_dwordx4 v253, s[20:23], s2 offen lds
    v_mfma_f32_16x16x32_bf16 v[140:143], v[168:171], v[68:71], v[140:143]
    ds_read_b64_tr_b16 v[184:185], v217 offset:45056
    v_mfma_f32_16x16x32_bf16 v[144:147], v[168:171], v[72:75], v[144:147]
    ds_read_b64_tr_b16 v[186:187], v217 offset:47104
    s_mul_i32 s2, s75, 4294952960
    s_add_u32 s2, s2, 22528
    s_add_u32 s57, s2, s69
    s_add_u32 s2, s2, s68
    buffer_load_dwordx4 v[44:47], v7, s[8:11], s2 offen sc1
    buffer_load_dwordx4 v[48:51], v7, s[8:11], s57 offen sc1
    v_mfma_f32_16x16x32_bf16 v[148:151], v[172:175], v[68:71], v[148:151]
    ds_read_b64_tr_b16 v[188:189], v218 offset:45056
    v_mul_f32 v231, v222, v231
    v_mul_f32 v239, v223, v239
    v_mul_f32 v232, v222, v232
    v_mul_f32 v240, v223, v240
    v_mul_f32 v233, v222, v233
    v_mul_f32 v241, v223, v241
    v_mul_f32 v234, v222, v234
    v_mul_f32 v242, v223, v242
    v_cvt_pk_bf16_f32 v208, v227, v228
    v_cvt_pk_bf16_f32 v212, v235, v236
    v_cvt_pk_bf16_f32 v209, v229, v230
    v_cvt_pk_bf16_f32 v213, v237, v238
    v_cvt_pk_bf16_f32 v210, v231, v232
    v_cvt_pk_bf16_f32 v214, v239, v240
    v_cvt_pk_bf16_f32 v211, v233, v234
    v_cvt_pk_bf16_f32 v215, v241, v242
    v_mfma_f32_16x16x32_bf16 v[152:155], v[172:175], v[72:75], v[152:155]
    ds_read_b64_tr_b16 v[190:191], v218 offset:47104
    v_mfma_f32_16x16x32_bf16 v[156:159], v[176:179], v[68:71], v[156:159]
    ds_read_b64_tr_b16 v[192:193], v219 offset:45056
    s_mov_b32 s2, 200704
    s_add_u32 m0, s59, 0
    s_nop 0
    buffer_load_dwordx4 v253, s[20:23], s2 offen lds
    v_mfma_f32_16x16x32_bf16 v[160:163], v[176:179], v[72:75], v[160:163]
    ds_read_b64_tr_b16 v[194:195], v219 offset:47104
    s_waitcnt vmcnt(11) lgkmcnt(6)
    v_mfma_f32_16x16x32_bf16 v[132:135], v[180:183], v[76:79], v[132:135]
    ds_read_b64_tr_b16 v[164:165], v216 offset:53248
    s_waitcnt vmcnt(10)
    v_mfma_f32_16x16x32_bf16 v[136:139], v[180:183], v[80:83], v[136:139]
    ds_read_b64_tr_b16 v[166:167], v216 offset:55296
    s_waitcnt lgkmcnt(6)
    v_mfma_f32_16x16x32_bf16 v[140:143], v[184:187], v[76:79], v[140:143]
    ds_read_b64_tr_b16 v[168:169], v217 offset:53248
    s_mov_b32 s2, 50176
    s_add_u32 m0, s59, 139264
    s_nop 0
    buffer_load_dwordx4 v253, s[20:23], s2 offen lds
    v_mfma_f32_16x16x32_bf16 v[144:147], v[184:187], v[80:83], v[144:147]
    ds_read_b64_tr_b16 v[170:171], v217 offset:55296
    s_waitcnt lgkmcnt(6)
    v_mfma_f32_16x16x32_bf16 v[148:151], v[188:191], v[76:79], v[148:151]
    ds_read_b64_tr_b16 v[172:173], v218 offset:53248
    s_mul_i32 s2, s75, 4294952960
    s_add_u32 s2, s2, 24576
    s_add_u32 s57, s2, s69
    s_add_u32 s2, s2, s68
    buffer_load_dwordx4 v[52:55], v7, s[8:11], s2 offen sc1
    buffer_load_dwordx4 v[56:59], v7, s[8:11], s57 offen sc1
    v_mfma_f32_16x16x32_bf16 v[152:155], v[188:191], v[80:83], v[152:155]
    ds_read_b64_tr_b16 v[174:175], v218 offset:55296
    s_waitcnt lgkmcnt(6)
    v_mfma_f32_16x16x32_bf16 v[156:159], v[192:195], v[76:79], v[156:159]
    ds_read_b64_tr_b16 v[176:177], v219 offset:53248
    s_mov_b32 s2, 250880
    s_add_u32 m0, s59, 8192
    s_nop 0
    buffer_load_dwordx4 v253, s[20:23], s2 offen lds
    v_mfma_f32_16x16x32_bf16 v[160:163], v[192:195], v[80:83], v[160:163]
    ds_read_b64_tr_b16 v[178:179], v219 offset:55296
    s_waitcnt vmcnt(13) lgkmcnt(6)
    v_mfma_f32_16x16x32_bf16 v[132:135], v[164:167], v[20:23], v[132:135]
    ds_read_b64_tr_b16 v[180:181], v216 offset:61440
    s_waitcnt vmcnt(12)
    v_mfma_f32_16x16x32_bf16 v[136:139], v[164:167], v[24:27], v[136:139]
    ds_read_b64_tr_b16 v[182:183], v216 offset:63488
    s_mul_i32 s2, s75, 4294952960
    s_add_u32 s2, s2, 26624
    s_add_u32 s57, s2, s69
    s_add_u32 s2, s2, s68
    buffer_load_dwordx4 v[60:63], v7, s[8:11], s2 offen sc1
    buffer_load_dwordx4 v[64:67], v7, s[8:11], s57 offen sc1
    s_waitcnt lgkmcnt(6)
    v_mfma_f32_16x16x32_bf16 v[140:143], v[168:171], v[20:23], v[140:143]
    ds_read_b64_tr_b16 v[184:185], v217 offset:61440
    v_mfma_f32_16x16x32_bf16 v[144:147], v[168:171], v[24:27], v[144:147]
    ds_read_b64_tr_b16 v[186:187], v217 offset:63488
    s_mov_b32 s2, 301056
    s_add_u32 m0, s59, 32768
    s_nop 0
    buffer_load_dwordx4 v253, s[20:23], s2 offen lds
    s_waitcnt lgkmcnt(6)
    v_mfma_f32_16x16x32_bf16 v[148:151], v[172:175], v[20:23], v[148:151]
    ds_read_b64_tr_b16 v[188:189], v218 offset:61440
    s_add_u32 m0, s59, 147456
    s_nop 0
    buffer_load_dwordx4 v4, s[4:7], 0 offen lds
    v_mfma_f32_16x16x32_bf16 v[152:155], v[172:175], v[24:27], v[152:155]
    ds_read_b64_tr_b16 v[190:191], v218 offset:63488
    s_waitcnt lgkmcnt(6)
    v_mfma_f32_16x16x32_bf16 v[156:159], v[176:179], v[20:23], v[156:159]
    ds_read_b64_tr_b16 v[192:193], v219 offset:61440
    s_lshl_b32 s52, s51, 7
    buffer_load_dwordx2 v[196:197], v5, s[40:43], s52 offen offset:64
    buffer_load_dwordx2 v[198:199], v5, s[40:43], s52 offen offset:96
    v_mfma_f32_16x16x32_bf16 v[160:163], v[176:179], v[24:27], v[160:163]
    ds_read_b64_tr_b16 v[194:195], v219 offset:63488
    s_waitcnt vmcnt(17) lgkmcnt(6)
    v_mfma_f32_16x16x32_bf16 v[132:135], v[180:183], v[28:31], v[132:135]
    ds_read_b64_tr_b16 v[164:165], v8 offset:20480
    s_waitcnt vmcnt(16)
    v_mfma_f32_16x16x32_bf16 v[136:139], v[180:183], v[32:35], v[136:139]
    ds_read_b64_tr_b16 v[166:167], v8 offset:22528
    s_waitcnt lgkmcnt(6)
    v_mfma_f32_16x16x32_bf16 v[140:143], v[184:187], v[28:31], v[140:143]
    ds_read_b64_tr_b16 v[168:169], v9 offset:20480
    v_mfma_f32_16x16x32_bf16 v[144:147], v[184:187], v[32:35], v[144:147]
    ds_read_b64_tr_b16 v[170:171], v9 offset:22528
    s_waitcnt lgkmcnt(6)
    v_mfma_f32_16x16x32_bf16 v[148:151], v[188:191], v[28:31], v[148:151]
    ds_read_b64_tr_b16 v[172:173], v10 offset:20480
    s_mov_b32 s2, 351232
    s_add_u32 m0, s59, 40960
    s_nop 0
    buffer_load_dwordx4 v253, s[20:23], s2 offen lds
    v_mfma_f32_16x16x32_bf16 v[152:155], v[188:191], v[32:35], v[152:155]
    ds_read_b64_tr_b16 v[174:175], v10 offset:22528
    s_waitcnt lgkmcnt(6)
    v_mfma_f32_16x16x32_bf16 v[156:159], v[192:195], v[28:31], v[156:159]
    ds_read_b64_tr_b16 v[176:177], v11 offset:20480
    v_mfma_f32_16x16x32_bf16 v[160:163], v[192:195], v[32:35], v[160:163]
    ds_read_b64_tr_b16 v[178:179], v11 offset:22528
    s_waitcnt vmcnt(16) lgkmcnt(6)
    v_mfma_f32_16x16x32_bf16 v[132:135], v[164:167], v[36:39], v[132:135]
    ds_read_b64_tr_b16 v[180:181], v8 offset:28672
    s_waitcnt vmcnt(15)
    v_mfma_f32_16x16x32_bf16 v[136:139], v[164:167], v[40:43], v[136:139]
    ds_read_b64_tr_b16 v[182:183], v8 offset:30720
    s_waitcnt lgkmcnt(6)
    v_mfma_f32_16x16x32_bf16 v[140:143], v[168:171], v[36:39], v[140:143]
    ds_read_b64_tr_b16 v[184:185], v9 offset:28672
    v_mfma_f32_16x16x32_bf16 v[144:147], v[168:171], v[40:43], v[144:147]
    ds_read_b64_tr_b16 v[186:187], v9 offset:30720
    s_waitcnt lgkmcnt(6)
    v_mfma_f32_16x16x32_bf16 v[148:151], v[172:175], v[36:39], v[148:151]
    ds_read_b64_tr_b16 v[188:189], v10 offset:28672
    v_mfma_f32_16x16x32_bf16 v[152:155], v[172:175], v[40:43], v[152:155]
    ds_read_b64_tr_b16 v[190:191], v10 offset:30720
    s_waitcnt lgkmcnt(6)
    v_mfma_f32_16x16x32_bf16 v[156:159], v[176:179], v[36:39], v[156:159]
    ds_read_b64_tr_b16 v[192:193], v11 offset:28672
    v_mfma_f32_16x16x32_bf16 v[160:163], v[176:179], v[40:43], v[160:163]
    ds_read_b64_tr_b16 v[194:195], v11 offset:30720
    s_waitcnt vmcnt(13) lgkmcnt(6)
    v_mfma_f32_16x16x32_bf16 v[132:135], v[180:183], v[44:47], v[132:135]
    ds_read_b64_tr_b16 v[164:165], v8 offset:53248
    s_waitcnt vmcnt(12)
    v_mfma_f32_16x16x32_bf16 v[136:139], v[180:183], v[48:51], v[136:139]
    ds_read_b64_tr_b16 v[166:167], v8 offset:55296
    s_waitcnt lgkmcnt(6)
    v_mfma_f32_16x16x32_bf16 v[140:143], v[184:187], v[44:47], v[140:143]
    ds_read_b64_tr_b16 v[168:169], v9 offset:53248
    v_mfma_f32_16x16x32_bf16 v[144:147], v[184:187], v[48:51], v[144:147]
    ds_read_b64_tr_b16 v[170:171], v9 offset:55296
    s_waitcnt lgkmcnt(6)
    v_mfma_f32_16x16x32_bf16 v[148:151], v[188:191], v[44:47], v[148:151]
    ds_read_b64_tr_b16 v[172:173], v10 offset:53248
    v_mfma_f32_16x16x32_bf16 v[152:155], v[188:191], v[48:51], v[152:155]
    ds_read_b64_tr_b16 v[174:175], v10 offset:55296
    s_waitcnt lgkmcnt(6)
    v_mfma_f32_16x16x32_bf16 v[156:159], v[192:195], v[44:47], v[156:159]
    ds_read_b64_tr_b16 v[176:177], v11 offset:53248
    v_mfma_f32_16x16x32_bf16 v[160:163], v[192:195], v[48:51], v[160:163]
    ds_read_b64_tr_b16 v[178:179], v11 offset:55296
    s_lshl_b32 s52, s47, 13
    s_lshl_b32 s57, s44, 10
    s_add_u32 s52, s52, s57
    s_add_u32 s52, s52, 4194304
    buffer_load_dwordx4 v[124:127], v7, s[8:11], s52 offen sc1
    s_waitcnt vmcnt(10) lgkmcnt(6)
    v_mfma_f32_16x16x32_bf16 v[132:135], v[164:167], v[52:55], v[132:135]
    ds_read_b64_tr_b16 v[180:181], v8 offset:61440
    s_waitcnt vmcnt(9)
    v_mfma_f32_16x16x32_bf16 v[136:139], v[164:167], v[56:59], v[136:139]
    ds_read_b64_tr_b16 v[182:183], v8 offset:63488
    s_waitcnt lgkmcnt(6)
    v_mfma_f32_16x16x32_bf16 v[140:143], v[168:171], v[52:55], v[140:143]
    ds_read_b64_tr_b16 v[184:185], v9 offset:61440
    v_mfma_f32_16x16x32_bf16 v[144:147], v[168:171], v[56:59], v[144:147]
    ds_read_b64_tr_b16 v[186:187], v9 offset:63488
    s_waitcnt lgkmcnt(6)
    v_mfma_f32_16x16x32_bf16 v[148:151], v[172:175], v[52:55], v[148:151]
    ds_read_b64_tr_b16 v[188:189], v10 offset:61440
    v_mfma_f32_16x16x32_bf16 v[152:155], v[172:175], v[56:59], v[152:155]
    ds_read_b64_tr_b16 v[190:191], v10 offset:63488
    s_waitcnt lgkmcnt(6)
    v_mfma_f32_16x16x32_bf16 v[156:159], v[176:179], v[52:55], v[156:159]
    ds_read_b64_tr_b16 v[192:193], v11 offset:61440
    v_mfma_f32_16x16x32_bf16 v[160:163], v[176:179], v[56:59], v[160:163]
    ds_read_b64_tr_b16 v[194:195], v11 offset:63488
    s_waitcnt vmcnt(7) lgkmcnt(6)
    v_mfma_f32_16x16x32_bf16 v[132:135], v[180:183], v[60:63], v[132:135]
    s_waitcnt vmcnt(6)
    v_mfma_f32_16x16x32_bf16 v[136:139], v[180:183], v[64:67], v[136:139]
    s_waitcnt lgkmcnt(4)
    v_mfma_f32_16x16x32_bf16 v[140:143], v[184:187], v[60:63], v[140:143]
    v_mfma_f32_16x16x32_bf16 v[144:147], v[184:187], v[64:67], v[144:147]
    s_waitcnt lgkmcnt(2)
    v_mfma_f32_16x16x32_bf16 v[148:151], v[188:191], v[60:63], v[148:151]
    v_mfma_f32_16x16x32_bf16 v[152:155], v[188:191], v[64:67], v[152:155]
    s_waitcnt lgkmcnt(0)
    v_mfma_f32_16x16x32_bf16 v[156:159], v[192:195], v[60:63], v[156:159]
    v_mfma_f32_16x16x32_bf16 v[160:163], v[192:195], v[64:67], v[160:163]
    s_mul_i32 s52, s46, 458752
    s_lshl_b32 s57, s47, 15
    s_add_u32 s52, s52, s57
    s_lshl_b32 s57, s44, 12
    s_add_u32 s52, s52, s57
    s_add_u32 s52, s52, 14680064
    buffer_store_dwordx4 v[136:139], v7, s[8:11], s52 offen offset:0 sc1
    buffer_store_dwordx4 v[144:147], v7, s[8:11], s52 offen offset:1024 sc1
    buffer_store_dwordx4 v[152:155], v7, s[8:11], s52 offen offset:2048 sc1
    buffer_store_dwordx4 v[160:163], v7, s[8:11], s52 offen offset:3072 sc1
    v_lshrrev_b32 v226, 1, v3
    v_and_b32 v227, 7, v2
    v_lshlrev_b32 v228, 7, v2
    v_and_b32 v229, 1, v3
    v_lshl_add_u32 v228, v229, 3, v228
    s_lshl_b32 s52, s45, 11
    s_add_u32 s52, s52, 147456
    v_add_u32 v228, s52, v228
    v_add_u32 v229, 4, v226
    v_xor_b32 v229, v229, v227
    v_lshl_add_u32 v224, v229, 4, v228
    v_add_u32 v229, 6, v226
    v_xor_b32 v229, v229, v227
    v_lshl_add_u32 v225, v229, 4, v228
    s_add_u32 s54, s47, 7
    s_sub_u32 s55, s47, 7
    s_cmp_eq_u32 s50, 0
    s_cselect_b32 s55, s54, s55
    s_lshl_b32 s52, s46, 9
    s_lshl_b32 s57, s50, 4
    s_add_u32 s52, s52, s57
    s_lshl_b32 s57, s45, 2
    s_add_u32 s52, s52, s57
    s_add_u32 s52, s52, 164096
    s_lshl_b32 s53, s46, 9
    s_lshl_b32 s57, s55, 5
    s_add_u32 s53, s53, s57
    s_lshl_b32 s57, s45, 2
    s_add_u32 s53, s53, s57
    s_add_u32 s53, s53, 171904
    v_lshlrev_b32 v230, 5, v1
    v_add_u32 v230, s52, v230
    v_lshlrev_b32 v231, 4, v1
    v_add_u32 v231, s53, v231
    v_cmp_gt_u32 vcc, 8, v1
    s_nop 1
    v_cndmask_b32 v230, v231, v230, vcc
    s_lshl_b32 s52, s45, 12
    s_add_u32 s52, s52, 49152
    v_add_u32 v222, s52, v7
    s_lshl_b32 s52, s45, 12
    s_add_u32 s52, s52, 16384
    v_add_u32 v223, s52, v7
    s_lshl_b32 s68, s46, 17
    s_lshl_b32 s57, s45, 15
    s_add_u32 s68, s68, s57
    s_lshl_b32 s57, s50, 14
    s_add_u32 s68, s68, s57
    s_add_u32 s68, s68, 12591104
    s_mul_i32 s69, s46, 458752
    s_lshl_b32 s57, s55, 15
    s_add_u32 s69, s69, s57
    s_lshl_b32 s57, s45, 12
    s_add_u32 s69, s69, s57
    s_add_u32 s69, s69, 14682112
    s_waitcnt vmcnt(4)
    v_xor_b32 v244, v14, v124
    v_and_b32 v244, 0xfff, v244
    v_cmp_ne_u32 vcc, 0, v244
    s_nop 1
    s_cmp_eq_u64 vcc, 0
    s_cbranch_scc1 L_kok_36
    s_lshl_b32 s52, s47, 13
    s_lshl_b32 s57, s44, 10
    s_add_u32 s52, s52, s57
    s_add_u32 s52, s52, 4194304
    s_mov_b32 s70, 0
L_kl_35:
    buffer_load_dwordx4 v[124:127], v7, s[8:11], s52 offen sc1
    s_waitcnt vmcnt(0)
    v_xor_b32 v244, v14, v124
    v_and_b32 v244, 0xfff, v244
    v_cmp_ne_u32 vcc, 0, v244
    s_nop 4
    s_cmp_eq_u64 vcc, 0
    s_cbranch_scc1 L_kok_36
    s_add_u32 s70, s70, 1
    s_cmp_lt_u32 s70, 4000
    s_cbranch_scc1 L_kl_35
L_kok_36:
    s_lshr_b32 s52, s44, 2
    s_lshl_b32 s52, s52, 1
    s_and_b32 s53, s44, 1
    s_add_u32 s52, s52, s53
    s_lshl_b32 s52, s52, 10
    s_bfe_u32 s53, s44, 0x10001
    s_lshl_b32 s53, s53, 3
    s_add_u32 s52, s52, s53
    s_add_u32 s52, s52, 159744
    v_cvt_pk_bf16_f32 v124, v124, v125
    v_cvt_pk_bf16_f32 v125, v126, v127
    v_add_u32 v244, s52, v7
    ds_write_b64 v244, v[124:125]
    v_add_u32 v244, 159744, v7
    s_waitcnt lgkmcnt(0)
    s_barrier
    ds_read_b128 v[84:87], v244 offset:0
    ds_read_b128 v[88:91], v244 offset:1024
    ds_read_b128 v[92:95], v244 offset:2048
    ds_read_b128 v[96:99], v244 offset:3072
    s_waitcnt lgkmcnt(3)
    v_mfma_f32_16x16x32_bf16 v[108:111], v[84:87], v[208:211], 0
    s_waitcnt lgkmcnt(2)
    v_mfma_f32_16x16x32_bf16 v[112:115], v[88:91], v[208:211], 0
    v_mov_b32_dpp v100, v88 row_newbcast:12 row_mask:0xf bank_mask:0xf
    v_mov_b32_dpp v101, v89 row_newbcast:12 row_mask:0xf bank_mask:0xf
    v_mov_b32_dpp v102, v90 row_newbcast:12 row_mask:0xf bank_mask:0xf
    v_mov_b32_dpp v103, v91 row_newbcast:12 row_mask:0xf bank_mask:0xf
    s_waitcnt lgkmcnt(0)
    v_mov_b32_dpp v104, v96 row_newbcast:12 row_mask:0xf bank_mask:0xf
    v_mov_b32_dpp v105, v97 row_newbcast:12 row_mask:0xf bank_mask:0xf
    v_mov_b32_dpp v106, v98 row_newbcast:12 row_mask:0xf bank_mask:0xf
    v_mov_b32_dpp v107, v99 row_newbcast:12 row_mask:0xf bank_mask:0xf
    v_mfma_f32_16x16x32_bf16 v[108:111], v[92:95], v[212:215], v[108:111]
    v_mfma_f32_16x16x32_bf16 v[112:115], v[96:99], v[212:215], v[112:115]
    v_mfma_f32_16x16x32_bf16 v[116:119], v[100:103], v[208:211], 0
    v_mfma_f32_16x16x32_bf16 v[116:119], v[104:107], v[212:215], v[116:119]
    s_nop 7
    v_add_f32 v116, 0x358637bd, v116
    v_rcp_f32 v116, v116
    s_nop 0
    v_mul_f32 v108, v116, v108
    v_mul_f32 v109, v116, v109
    v_mul_f32 v110, v116, v110
    v_mul_f32 v111, v116, v111
    v_mul_f32 v112, v116, v112
    v_mul_f32 v113, v116, v113
    v_mul_f32 v114, v116, v114
    v_mul_f32 v115, v116, v115
    v_cvt_pk_bf16_f32 v120, v108, v109
    v_cvt_pk_bf16_f32 v121, v110, v111
    v_cvt_pk_bf16_f32 v122, v112, v113
    v_cvt_pk_bf16_f32 v123, v114, v115
    v_cndmask_b32 v122, v122, v15, s[62:63]
    v_cndmask_b32 v123, v123, v15, s[62:63]
    s_lshl_b32 s52, s46, 17
    s_lshl_b32 s57, s45, 15
    s_add_u32 s52, s52, s57
    s_lshl_b32 s57, s47, 10
    s_add_u32 s52, s52, s57
    s_add_u32 s52, s52, 12599296
    buffer_store_dwordx4 v[120:123], v7, s[8:11], s52 offen sc1
    s_waitcnt vmcnt(1)
    s_lshl_b32 s52, s46, 9
    s_lshl_b32 s57, s47, 5
    s_add_u32 s52, s52, s57
    s_lshl_b32 s57, s44, 2
    s_add_u32 s52, s52, s57
    s_add_u32 s52, s52, 172032
    s_mov_b64 exec, 1
    s_cmp_eq_u32 s49, 0
    s_cbranch_scc1 L_slow_37
    buffer_store_dword v14, v15, s[8:11], s52 offen
    s_branch L_mdone_38
L_slow_37:
    buffer_store_dword v14, v15, s[8:11], s52 offen sc1
L_mdone_38:
    s_mov_b64 exec, -1
    s_waitcnt vmcnt(1)
    s_lshl_b32 s52, s46, 9
    s_lshl_b32 s57, s47, 5
    s_add_u32 s52, s52, s57
    s_lshl_b32 s57, s44, 2
    s_add_u32 s52, s52, s57
    s_add_u32 s52, s52, 163840
    s_mov_b64 exec, 1
    s_cmp_eq_u32 s49, 0
    s_cbranch_scc1 L_slow_39
    buffer_store_dword v14, v15, s[8:11], s52 offen
    s_branch L_mdone_40
L_slow_39:
    buffer_store_dword v14, v15, s[8:11], s52 offen sc1
L_mdone_40:
    s_mov_b64 exec, -1
    s_barrier
    v_mov_b32 v52, 0
    v_mov_b32 v53, 0
    v_mov_b32 v54, 0
    v_mov_b32 v55, 0
    v_mov_b32 v56, 0
    v_mov_b32 v57, 0
    v_mov_b32 v58, 0
    v_mov_b32 v59, 0
    v_mov_b32 v60, 0
    v_mov_b32 v61, 0
    v_mov_b32 v62, 0
    v_mov_b32 v63, 0
    v_mov_b32 v64, 0
    v_mov_b32 v65, 0
    v_mov_b32 v66, 0
    v_mov_b32 v67, 0
    ds_write_b128 v222, v[132:135] offset:2048
    ds_write_b128 v222, v[140:143] offset:3072
    ds_read_b64_tr_b16 v[164:165], v8 offset:0
    ds_read_b64_tr_b16 v[166:167], v8 offset:2048
    ds_read_b64_tr_b16 v[168:169], v9 offset:0
    ds_read_b64_tr_b16 v[170:171], v9 offset:2048
    ds_read_b64_tr_b16 v[172:173], v10 offset:0
    ds_read_b64_tr_b16 v[174:175], v10 offset:2048
    ds_read_b64_tr_b16 v[176:177], v11 offset:0
    ds_read_b64_tr_b16 v[178:179], v11 offset:2048
    s_mov_b32 s52, 0
    s_mov_b32 exec_lo, 1023
    s_mov_b32 exec_hi, 0
    s_mov_b32 s70, 0
L_poll_41:
    buffer_load_dword v254, v230, s[8:11], s52 offen sc1
    s_waitcnt vmcnt(0)
    v_cmp_ne_u32 vcc, s48, v254
    s_nop 4
    s_cmp_eq_u64 vcc, 0
    s_cbranch_scc1 L_polld_42
    s_add_u32 s70, s70, 1
    s_cmp_lt_u32 s70, 4000
    s_cbranch_scc1 L_poll_41
L_polld_42:
    s_mov_b64 exec, -1
    buffer_load_dwordx4 v[20:23], v7, s[8:11], s68 offen offset:0 sc1
    buffer_load_dwordx4 v[24:27], v7, s[8:11], s68 offen offset:1024 sc1
    buffer_load_dwordx4 v[28:31], v7, s[8:11], s68 offen offset:2048 sc1
    buffer_load_dwordx4 v[32:35], v7, s[8:11], s68 offen offset:3072 sc1
    s_add_u32 s68, s68, 4096
    buffer_load_dwordx4 v[36:39], v7, s[8:11], s68 offen offset:0 sc1
    buffer_load_dwordx4 v[40:43], v7, s[8:11], s68 offen offset:1024 sc1
    buffer_load_dwordx4 v[44:47], v7, s[8:11], s68 offen offset:2048 sc1
    buffer_load_dwordx4 v[48:51], v7, s[8:11], s68 offen offset:3072 sc1
    buffer_load_dwordx4 v[68:71], v7, s[8:11], s69 offen offset:0 sc1
    buffer_load_dwordx4 v[72:75], v7, s[8:11], s69 offen offset:1024 sc1
    s_add_u32 s69, s69, 16384
    buffer_load_dwordx4 v[76:79], v7, s[8:11], s69 offen offset:0 sc1
    buffer_load_dwordx4 v[80:83], v7, s[8:11], s69 offen offset:1024 sc1
    s_waitcnt vmcnt(11) lgkmcnt(6)
    v_mfma_f32_16x16x32_bf16 v[52:55], v[164:167], v[20:23], v[52:55]
    ds_read_b64_tr_b16 v[180:181], v8 offset:4096
    s_waitcnt lgkmcnt(5)
    v_mfma_f32_16x16x32_bf16 v[56:59], v[168:171], v[20:23], v[56:59]
    ds_read_b64_tr_b16 v[182:183], v8 offset:6144
    s_waitcnt lgkmcnt(4)
    v_mfma_f32_16x16x32_bf16 v[60:63], v[172:175], v[20:23], v[60:63]
    ds_read_b64_tr_b16 v[184:185], v9 offset:4096
    s_waitcnt lgkmcnt(3)
    v_mfma_f32_16x16x32_bf16 v[64:67], v[176:179], v[20:23], v[64:67]
    ds_read_b64_tr_b16 v[186:187], v9 offset:6144
    ds_read_b64_tr_b16 v[188:189], v10 offset:4096
    ds_read_b64_tr_b16 v[190:191], v10 offset:6144
    ds_read_b64_tr_b16 v[192:193], v11 offset:4096
    ds_read_b64_tr_b16 v[194:195], v11 offset:6144
    s_waitcnt vmcnt(10) lgkmcnt(6)
    v_mfma_f32_16x16x32_bf16 v[52:55], v[180:183], v[24:27], v[52:55]
    ds_read_b64_tr_b16 v[164:165], v8 offset:8192
    s_waitcnt lgkmcnt(5)
    v_mfma_f32_16x16x32_bf16 v[56:59], v[184:187], v[24:27], v[56:59]
    ds_read_b64_tr_b16 v[166:167], v8 offset:10240
    s_waitcnt lgkmcnt(4)
    v_mfma_f32_16x16x32_bf16 v[60:63], v[188:191], v[24:27], v[60:63]
    ds_read_b64_tr_b16 v[168:169], v9 offset:8192
    s_waitcnt lgkmcnt(3)
    v_mfma_f32_16x16x32_bf16 v[64:67], v[192:195], v[24:27], v[64:67]
    ds_read_b64_tr_b16 v[170:171], v9 offset:10240
    ds_read_b64_tr_b16 v[172:173], v10 offset:8192
    ds_read_b64_tr_b16 v[174:175], v10 offset:10240
    ds_read_b64_tr_b16 v[176:177], v11 offset:8192
    ds_read_b64_tr_b16 v[178:179], v11 offset:10240
    s_waitcnt vmcnt(9) lgkmcnt(6)
    v_mfma_f32_16x16x32_bf16 v[52:55], v[164:167], v[28:31], v[52:55]
    ds_read_b64_tr_b16 v[180:181], v8 offset:12288
    s_waitcnt lgkmcnt(5)
    v_mfma_f32_16x16x32_bf16 v[56:59], v[168:171], v[28:31], v[56:59]
    ds_read_b64_tr_b16 v[182:183], v8 offset:14336
    s_waitcnt lgkmcnt(4)
    v_mfma_f32_16x16x32_bf16 v[60:63], v[172:175], v[28:31], v[60:63]
    ds_read_b64_tr_b16 v[184:185], v9 offset:12288
    s_waitcnt lgkmcnt(3)
    v_mfma_f32_16x16x32_bf16 v[64:67], v[176:179], v[28:31], v[64:67]
    ds_read_b64_tr_b16 v[186:187], v9 offset:14336
    ds_read_b64_tr_b16 v[188:189], v10 offset:12288
    ds_read_b64_tr_b16 v[190:191], v10 offset:14336
    ds_read_b64_tr_b16 v[192:193], v11 offset:12288
    ds_read_b64_tr_b16 v[194:195], v11 offset:14336
    s_waitcnt vmcnt(8) lgkmcnt(6)
    v_mfma_f32_16x16x32_bf16 v[52:55], v[180:183], v[32:35], v[52:55]
    ds_read_b64_tr_b16 v[164:165], v8 offset:32768
    s_waitcnt lgkmcnt(5)
    v_mfma_f32_16x16x32_bf16 v[56:59], v[184:187], v[32:35], v[56:59]
    ds_read_b64_tr_b16 v[166:167], v8 offset:34816
    s_waitcnt lgkmcnt(4)
    v_mfma_f32_16x16x32_bf16 v[60:63], v[188:191], v[32:35], v[60:63]
    ds_read_b64_tr_b16 v[168:169], v9 offset:32768
    s_waitcnt lgkmcnt(3)
    v_mfma_f32_16x16x32_bf16 v[64:67], v[192:195], v[32:35], v[64:67]
    ds_read_b64_tr_b16 v[170:171], v9 offset:34816
    ds_read_b64_tr_b16 v[172:173], v10 offset:32768
    ds_read_b64_tr_b16 v[174:175], v10 offset:34816
    ds_read_b64_tr_b16 v[176:177], v11 offset:32768
    ds_read_b64_tr_b16 v[178:179], v11 offset:34816
    s_waitcnt vmcnt(7) lgkmcnt(6)
    v_mfma_f32_16x16x32_bf16 v[52:55], v[164:167], v[36:39], v[52:55]
    ds_read_b64_tr_b16 v[180:181], v8 offset:36864
    s_waitcnt lgkmcnt(5)
    v_mfma_f32_16x16x32_bf16 v[56:59], v[168:171], v[36:39], v[56:59]
    ds_read_b64_tr_b16 v[182:183], v8 offset:38912
    s_waitcnt lgkmcnt(4)
    v_mfma_f32_16x16x32_bf16 v[60:63], v[172:175], v[36:39], v[60:63]
    ds_read_b64_tr_b16 v[184:185], v9 offset:36864
    s_waitcnt lgkmcnt(3)
    v_mfma_f32_16x16x32_bf16 v[64:67], v[176:179], v[36:39], v[64:67]
    ds_read_b64_tr_b16 v[186:187], v9 offset:38912
    ds_read_b64_tr_b16 v[188:189], v10 offset:36864
    ds_read_b64_tr_b16 v[190:191], v10 offset:38912
    ds_read_b64_tr_b16 v[192:193], v11 offset:36864
    ds_read_b64_tr_b16 v[194:195], v11 offset:38912
    s_waitcnt vmcnt(6) lgkmcnt(6)
    v_mfma_f32_16x16x32_bf16 v[52:55], v[180:183], v[40:43], v[52:55]
    ds_read_b64_tr_b16 v[164:165], v8 offset:40960
    s_waitcnt lgkmcnt(5)
    v_mfma_f32_16x16x32_bf16 v[56:59], v[184:187], v[40:43], v[56:59]
    ds_read_b64_tr_b16 v[166:167], v8 offset:43008
    s_waitcnt lgkmcnt(4)
    v_mfma_f32_16x16x32_bf16 v[60:63], v[188:191], v[40:43], v[60:63]
    ds_read_b64_tr_b16 v[168:169], v9 offset:40960
    s_waitcnt lgkmcnt(3)
    v_mfma_f32_16x16x32_bf16 v[64:67], v[192:195], v[40:43], v[64:67]
    ds_read_b64_tr_b16 v[170:171], v9 offset:43008
    ds_read_b64_tr_b16 v[172:173], v10 offset:40960
    ds_read_b64_tr_b16 v[174:175], v10 offset:43008
    ds_read_b64_tr_b16 v[176:177], v11 offset:40960
    ds_read_b64_tr_b16 v[178:179], v11 offset:43008
    s_waitcnt vmcnt(5) lgkmcnt(6)
    v_mfma_f32_16x16x32_bf16 v[52:55], v[164:167], v[44:47], v[52:55]
    ds_read_b64_tr_b16 v[180:181], v8 offset:45056
    s_waitcnt lgkmcnt(5)
    v_mfma_f32_16x16x32_bf16 v[56:59], v[168:171], v[44:47], v[56:59]
    ds_read_b64_tr_b16 v[182:183], v8 offset:47104
    s_waitcnt lgkmcnt(4)
    v_mfma_f32_16x16x32_bf16 v[60:63], v[172:175], v[44:47], v[60:63]
    ds_read_b64_tr_b16 v[184:185], v9 offset:45056
    s_waitcnt lgkmcnt(3)
    v_mfma_f32_16x16x32_bf16 v[64:67], v[176:179], v[44:47], v[64:67]
    ds_read_b64_tr_b16 v[186:187], v9 offset:47104
    ds_read_b64_tr_b16 v[188:189], v10 offset:45056
    ds_read_b64_tr_b16 v[190:191], v10 offset:47104
    ds_read_b64_tr_b16 v[192:193], v11 offset:45056
    ds_read_b64_tr_b16 v[194:195], v11 offset:47104
    s_waitcnt vmcnt(4) lgkmcnt(6)
    v_mfma_f32_16x16x32_bf16 v[52:55], v[180:183], v[48:51], v[52:55]
    s_waitcnt lgkmcnt(4)
    v_mfma_f32_16x16x32_bf16 v[56:59], v[184:187], v[48:51], v[56:59]
    s_waitcnt lgkmcnt(2)
    v_mfma_f32_16x16x32_bf16 v[60:63], v[188:191], v[48:51], v[60:63]
    s_waitcnt lgkmcnt(0)
    v_mfma_f32_16x16x32_bf16 v[64:67], v[192:195], v[48:51], v[64:67]
    s_waitcnt vmcnt(1)
    v_add_f32 v68, v68, v76
    v_add_f32 v69, v69, v77
    v_add_f32 v70, v70, v78
    v_add_f32 v71, v71, v79
    v_add_f32 v148, v148, v68
    v_add_f32 v149, v149, v69
    v_add_f32 v150, v150, v70
    v_add_f32 v151, v151, v71
    s_waitcnt vmcnt(0)
    v_add_f32 v72, v72, v80
    v_add_f32 v73, v73, v81
    v_add_f32 v74, v74, v82
    v_add_f32 v75, v75, v83
    v_add_f32 v156, v156, v72
    v_add_f32 v157, v157, v73
    v_add_f32 v158, v158, v74
    v_add_f32 v159, v159, v75
    ds_write_b128 v222, v[52:55] offset:0
    ds_write_b128 v222, v[56:59] offset:1024
    s_waitcnt lgkmcnt(0)
    s_barrier
    ds_read_b128 v[164:167], v223 offset:0
    ds_read_b128 v[168:171], v223 offset:1024
    ds_read_b128 v[172:175], v223 offset:2048
    ds_read_b128 v[176:179], v223 offset:3072
    ds_read_b64 v[232:233], v224
    ds_read_b64 v[234:235], v225
    v_lshlrev_b32 v236, 16, v196
    v_and_b32 v237, 0xffff0000, v196
    v_lshlrev_b32 v238, 16, v197
    v_and_b32 v239, 0xffff0000, v197
    v_add_f32 v148, v148, v236
    v_add_f32 v149, v149, v237
    v_add_f32 v150, v150, v238
    v_add_f32 v151, v151, v239
    s_waitcnt lgkmcnt(3)
    v_add_f32 v148, v148, v172
    v_add_f32 v149, v149, v173
    v_add_f32 v150, v150, v174
    v_add_f32 v151, v151, v175
    v_mul_f32 v68, 0xbfb8aa3b, v148
    v_mul_f32 v69, 0xbfb8aa3b, v149
    v_mul_f32 v70, 0xbfb8aa3b, v150
    v_mul_f32 v71, 0xbfb8aa3b, v151
    v_exp_f32 v68, v68
    v_exp_f32 v69, v69
    v_exp_f32 v70, v70
    v_exp_f32 v71, v71
    v_add_f32 v60, v60, v164
    v_add_f32 v61, v61, v165
    v_add_f32 v62, v62, v166
    v_add_f32 v63, v63, v167
    s_waitcnt lgkmcnt(1)
    v_lshlrev_b32 v240, 16, v232
    v_and_b32 v241, 0xffff0000, v232
    v_lshlrev_b32 v242, 16, v233
    v_and_b32 v243, 0xffff0000, v233
    v_add_f32 v68, 1.0, v68
    v_add_f32 v69, 1.0, v69
    v_add_f32 v70, 1.0, v70
    v_add_f32 v71, 1.0, v71
    v_rcp_f32 v68, v68
    v_rcp_f32 v69, v69
    v_rcp_f32 v70, v70
    v_rcp_f32 v71, v71
    v_mul_f32 v148, v148, v60
    v_mul_f32 v149, v149, v61
    v_mul_f32 v150, v150, v62
    v_mul_f32 v151, v151, v63
    v_fma_f32 v148, v68, v148, v240
    v_fma_f32 v149, v69, v149, v241
    v_fma_f32 v150, v70, v150, v242
    v_fma_f32 v151, v71, v151, v243
    v_cvt_pk_bf16_f32 v232, v148, v149
    v_cvt_pk_bf16_f32 v233, v150, v151
    ds_write_b64 v224, v[232:233]
    v_lshlrev_b32 v236, 16, v198
    v_and_b32 v237, 0xffff0000, v198
    v_lshlrev_b32 v238, 16, v199
    v_and_b32 v239, 0xffff0000, v199
    v_add_f32 v156, v156, v236
    v_add_f32 v157, v157, v237
    v_add_f32 v158, v158, v238
    v_add_f32 v159, v159, v239
    v_add_f32 v156, v156, v176
    v_add_f32 v157, v157, v177
    v_add_f32 v158, v158, v178
    v_add_f32 v159, v159, v179
    v_mul_f32 v72, 0xbfb8aa3b, v156
    v_mul_f32 v73, 0xbfb8aa3b, v157
    v_mul_f32 v74, 0xbfb8aa3b, v158
    v_mul_f32 v75, 0xbfb8aa3b, v159
    v_exp_f32 v72, v72
    v_exp_f32 v73, v73
    v_exp_f32 v74, v74
    v_exp_f32 v75, v75
    v_add_f32 v64, v64, v168
    v_add_f32 v65, v65, v169
    v_add_f32 v66, v66, v170
    v_add_f32 v67, v67, v171
    s_waitcnt lgkmcnt(1)
    v_lshlrev_b32 v240, 16, v234
    v_and_b32 v241, 0xffff0000, v234
    v_lshlrev_b32 v242, 16, v235
    v_and_b32 v243, 0xffff0000, v235
    v_add_f32 v72, 1.0, v72
    v_add_f32 v73, 1.0, v73
    v_add_f32 v74, 1.0, v74
    v_add_f32 v75, 1.0, v75
    v_rcp_f32 v72, v72
    v_rcp_f32 v73, v73
    v_rcp_f32 v74, v74
    v_rcp_f32 v75, v75
    v_mul_f32 v156, v156, v64
    v_mul_f32 v157, v157, v65
    v_mul_f32 v158, v158, v66
    v_mul_f32 v159, v159, v67
    v_fma_f32 v156, v72, v156, v240
    v_fma_f32 v157, v73, v157, v241
    v_fma_f32 v158, v74, v158, v242
    v_fma_f32 v159, v75, v159, v243
    v_cvt_pk_bf16_f32 v234, v156, v157
    v_cvt_pk_bf16_f32 v235, v158, v159
    ds_write_b64 v225, v[234:235]
    s_waitcnt lgkmcnt(0)
    s_barrier
    s_add_u32 s52, s59, 147456
    v_add_u32 v222, s52, v7
    ds_read_b128 v[236:239], v222
    s_waitcnt lgkmcnt(0)
    buffer_store_dwordx4 v[236:239], v4, s[28:31], 0 offen sc1
    s_endpgm
L_helper:
    s_cmp_ge_u32 s44, 4
    s_cbranch_scc1 L_helpB
L_helpA:
    v_lshlrev_b32 v238, 7, v1
    s_and_b32 s52, s46, 1
    s_lshl_b32 s52, s52, 1
    s_add_u32 s52, s52, s47
    s_sub_u32 s52, s52, 14
    s_lshl_b32 s52, s52, 3
    s_add_u32 s52, s52, s44
    s_lshl_b32 s52, s52, 13
    buffer_load_dword v249, v238, s[8:11], s52 offen
    s_mul_i32 s2, s75, 384
    s_add_u32 s2, s2, 128
    s_add_u32 m0, s58, 16384
    s_nop 0
    buffer_load_dwordx4 v4, s[4:7], s2 offen lds
    s_add_u32 m0, s58, 17408
    s_nop 0
    buffer_load_dwordx4 v5, s[4:7], s2 offen lds
    s_cmp_ge_u32 s47, 7
    s_cselect_b32 s50, 1, 0
    s_mul_i32 s52, s50, 7
    s_sub_u32 s51, s47, s52
    s_mul_i32 s3, s50, 802816
    s_mov_b32 s49, 0
    s_getreg_b32 s71, hwreg(HW_REG_XCC_ID)
    s_and_b32 s71, s71, 15
    v_mov_b32 v15, 0
    s_movk_i32 s74, 0xfff
    v_mov_b32 v16, 0x3f803f80
    v_mov_b32 v17, 0x3f803f80
    v_mov_b32 v18, 0x3f803f80
    v_mov_b32 v19, 0x3f803f80
    v_cmp_eq_u32 s[62:63], 3, v3
    v_cmp_le_u32 s[64:65], 12, v2
    s_mul_i32 s52, s47, 1568
    s_lshl_b32 s53, s44, 8
    s_add_u32 s52, s52, s53
    s_add_u32 m0, s53, 155648
    s_mov_b64 exec, 0xffff
    buffer_load_dwordx4 v7, s[32:35], s52 offen lds
    s_mov_b64 exec, -1
    v_lshrrev_b32 v222, 1, v2
    v_xor_b32 v222, v222, v3
    v_lshlrev_b32 v223, 7, v2
    s_lshl_b32 s52, s45, 12
    v_add_u32 v223, s52, v223
    v_lshl_add_u32 v12, v222, 4, v223
    v_xor_b32 v222, 4, v222
    v_lshl_add_u32 v13, v222, 4, v223
    v_add_u32 v220, 0x10000, v12
    v_add_u32 v221, 0x10000, v13
    v_mov_b32 v196, 0
    v_mov_b32 v197, 0
    v_mov_b32 v198, 0
    v_mov_b32 v199, 0
    v_mov_b32 v200, 0
    v_mov_b32 v201, 0
    v_mov_b32 v202, 0
    v_mov_b32 v203, 0
    v_mov_b32 v204, 0
    v_mov_b32 v205, 0
    v_mov_b32 v206, 0
    v_mov_b32 v207, 0
    s_cmp_ge_u32 s44, 6
    s_cselect_b32 s52, 2, 0
    s_sub_u32 s52, s44, s52
    s_lshr_b32 s53, s52, 1
    s_and_b32 s54, s52, 1
    v_lshrrev_b32 v222, 2, v2
    v_lshl_add_u32 v222, v3, 3, v222
    v_mul_u32_u24 v222, 176, v222
    v_and_b32 v223, 3, v1
    v_lshl_add_u32 v222, v223, 3, v222
    s_mul_i32 s55, s53, 56
    s_lshl_b32 s56, s54, 5
    s_add_u32 s55, s55, s56
    s_add_u32 s55, s55, 131072
    v_add_u32 v222, s55, v222
    s_and_b32 s55, s61, 15
    s_mul_i32 s55, s55, 3
    s_add_u32 s55, s55, s53
    s_and_b32 s56, s55, 15
    s_lshr_b32 s55, s55, 4
    s_add_u32 s55, s55, 2
    s_cmp_ge_u32 s55, 3
    s_cselect_b32 s57, 3, 0
    s_sub_u32 s55, s55, s57
    s_mul_i32 s56, s56, 3
    s_add_u32 s56, s56, s55
    s_lshl_b32 s56, s56, 1
    s_add_u32 s56, s56, s54
    s_mul_i32 s56, s56, 14336
    s_lshr_b32 s55, s61, 4
    s_lshl_b32 s57, s55, 10
    s_add_u32 s56, s56, s57
    s_add_u32 s56, s56, 262144
    s_cmp_ge_u32 s55, 14
    s_cselect_b32 s57, 1073741824, 0
    s_add_u32 s56, s56, s57
    s_waitcnt vmcnt(6)
    s_waitcnt lgkmcnt(0)
    s_add_u32 s48, s60, 0x9e3779b9
    v_mov_b32 v14, s48
    s_barrier
    ds_read_b64_tr_b16 v[226:227], v222
    ds_read_b64_tr_b16 v[228:229], v222 offset:704
    s_waitcnt lgkmcnt(0)
    buffer_store_dwordx4 v[226:229], v7, s[8:11], s56 offen sc1
    s_cmp_lg_u32 s45, 0
    s_cbranch_scc1 L_nw_43
    s_and_b32 s52, s61, 7
    s_lshl_b32 s52, s52, 7
    s_lshr_b32 s53, s61, 3
    s_lshl_b32 s53, s53, 2
    s_add_u32 s52, s52, s53
    s_add_u32 s52, s52, 4096
    s_add_u32 s53, s48, s71
    v_mov_b32 v230, s53
    s_mov_b64 exec, 1
    buffer_store_dword v230, v15, s[8:11], s52 offen sc1
    s_mov_b64 exec, -1
L_nw_43:
    s_waitcnt vmcnt(5)
    s_barrier
    ds_read_b128 v[20:23], v12 offset:0
    ds_read_b128 v[24:27], v12 offset:2048
    s_waitcnt lgkmcnt(1)
    v_mfma_f32_16x16x32_bf16 v[200:203], v[16:19], v[20:23], v[200:203]
    ds_read_b128 v[28:31], v13 offset:0
    s_mul_i32 s2, s75, 384
    s_add_u32 s2, s2, 256
    s_add_u32 m0, s58, 32768
    s_nop 0
    buffer_load_dwordx4 v4, s[4:7], s2 offen lds
    s_add_u32 m0, s58, 33792
    s_nop 0
    buffer_load_dwordx4 v5, s[4:7], s2 offen lds
    v_mfma_f32_16x16x32_bf16 v[204:207], v[20:23], v[20:23], v[204:207]
    ds_read_b128 v[32:35], v13 offset:2048
    s_mul_i32 s2, s75, 384
    s_add_u32 s2, s2, 384
    s_add_u32 m0, s58, 49152
    s_nop 0
    buffer_load_dwordx4 v4, s[4:7], s2 offen lds
    s_add_u32 m0, s58, 50176
    s_nop 0
    buffer_load_dwordx4 v5, s[4:7], s2 offen lds
    s_waitcnt vmcnt(6)
    s_barrier
    s_waitcnt lgkmcnt(1)
    v_mfma_f32_16x16x32_bf16 v[200:203], v[16:19], v[28:31], v[200:203]
    ds_read_b128 v[36:39], v12 offset:16384
    s_mul_i32 s2, s75, 4294966784
    s_add_u32 s2, s2, 512
    s_add_u32 m0, s58, 65536
    s_nop 0
    buffer_load_dwordx4 v4, s[4:7], s2 offen lds
    s_add_u32 m0, s58, 66560
    s_nop 0
    buffer_load_dwordx4 v5, s[4:7], s2 offen lds
    v_mfma_f32_16x16x32_bf16 v[204:207], v[28:31], v[28:31], v[204:207]
    ds_read_b128 v[40:43], v12 offset:18432
    s_mul_i32 s2, s75, 4294966784
    s_add_u32 s2, s2, 640
    s_add_u32 m0, s58, 81920
    s_nop 0
    buffer_load_dwordx4 v4, s[4:7], s2 offen lds
    s_add_u32 m0, s58, 82944
    s_nop 0
    buffer_load_dwordx4 v5, s[4:7], s2 offen lds
    s_waitcnt lgkmcnt(1)
    v_mfma_f32_16x16x32_bf16 v[200:203], v[16:19], v[36:39], v[200:203]
    ds_read_b128 v[44:47], v13 offset:16384
    s_mul_i32 s2, s75, 4294966784
    s_add_u32 s2, s2, 768
    s_add_u32 m0, s58, 98304
    s_nop 0
    buffer_load_dwordx4 v4, s[4:7], s2 offen lds
    v_mfma_f32_16x16x32_bf16 v[204:207], v[36:39], v[36:39], v[204:207]
    ds_read_b128 v[48:51], v13 offset:18432
    s_add_u32 m0, s58, 99328
    s_nop 0
    buffer_load_dwordx4 v5, s[4:7], s2 offen lds
    s_waitcnt vmcnt(8)
    s_barrier
    s_cmp_lg_u32 s45, 0
    s_cbranch_scc1 L_nw_44
    s_and_b32 s52, s61, 15
    s_lshl_b32 s52, s52, 7
    s_lshr_b32 s53, s61, 4
    s_lshl_b32 s54, s53, 2
    s_add_u32 s52, s52, s54
    s_add_u32 s52, s52, 8192
    s_cmp_ge_u32 s53, 14
    s_cselect_b32 s53, 1073741824, 0
    s_add_u32 s52, s52, s53
    s_mov_b64 exec, 1
    buffer_store_dword v14, v15, s[8:11], s52 offen sc1
    s_mov_b64 exec, -1
L_nw_44:
    s_waitcnt lgkmcnt(1)
    v_mfma_f32_16x16x32_bf16 v[200:203], v[16:19], v[44:47], v[200:203]
    ds_read_b128 v[52:55], v12 offset:32768
    v_mfma_f32_16x16x32_bf16 v[204:207], v[44:47], v[44:47], v[204:207]
    ds_read_b128 v[56:59], v12 offset:34816
    s_waitcnt lgkmcnt(1)
    v_mfma_f32_16x16x32_bf16 v[200:203], v[16:19], v[52:55], v[200:203]
    ds_read_b128 v[60:63], v13 offset:32768
    v_mfma_f32_16x16x32_bf16 v[204:207], v[52:55], v[52:55], v[204:207]
    ds_read_b128 v[64:67], v13 offset:34816
    s_and_b32 s52, s61, 7
    s_lshl_b32 s52, s52, 7
    s_add_u32 s52, s52, 4096
    v_lshlrev_b32 v248, 2, v1
    buffer_load_dword v248, v248, s[8:11], s52 offen sc1
    s_waitcnt vmcnt(7)
    s_barrier
    s_waitcnt lgkmcnt(1)
    v_mfma_f32_16x16x32_bf16 v[200:203], v[16:19], v[60:63], v[200:203]
    ds_read_b128 v[68:71], v12 offset:49152
    v_mfma_f32_16x16x32_bf16 v[204:207], v[60:63], v[60:63], v[204:207]
    ds_read_b128 v[72:75], v12 offset:51200
    s_waitcnt lgkmcnt(1)
    v_mfma_f32_16x16x32_bf16 v[200:203], v[16:19], v[68:71], v[200:203]
    ds_read_b128 v[76:79], v13 offset:49152
    v_mfma_f32_16x16x32_bf16 v[204:207], v[68:71], v[68:71], v[204:207]
    ds_read_b128 v[80:83], v13 offset:51200
    s_waitcnt vmcnt(5)
    s_barrier
    s_waitcnt lgkmcnt(1)
    v_mfma_f32_16x16x32_bf16 v[200:203], v[16:19], v[76:79], v[200:203]
    ds_read_b128 v[84:87], v220 offset:0
    v_mfma_f32_16x16x32_bf16 v[204:207], v[76:79], v[76:79], v[204:207]
    ds_read_b128 v[88:91], v220 offset:2048
    s_waitcnt lgkmcnt(1)
    v_mfma_f32_16x16x32_bf16 v[200:203], v[16:19], v[84:87], v[200:203]
    ds_read_b128 v[92:95], v221 offset:0
    v_mfma_f32_16x16x32_bf16 v[204:207], v[84:87], v[84:87], v[204:207]
    ds_read_b128 v[96:99], v221 offset:2048
    s_waitcnt vmcnt(0)
    v_subrev_u32 v239, s48, v248
    s_mov_b32 s70, 0
L_modep_45:
    s_mov_b32 exec_hi, 0
    v_cmp_le_u32 vcc, 16, v239
    s_nop 4
    s_cmp_eq_u64 vcc, 0
    s_cbranch_scc1 L_modeok_46
    s_add_u32 s70, s70, 1
    s_cmp_ge_u32 s70, 4000
    s_cbranch_scc1 L_modeok_46
    s_and_b32 s52, s61, 7
    s_lshl_b32 s52, s52, 7
    s_add_u32 s52, s52, 4096
    v_lshlrev_b32 v239, 2, v1
    buffer_load_dword v239, v239, s[8:11], s52 offen sc1
    s_waitcnt vmcnt(0)
    v_subrev_u32 v239, s48, v239
    s_branch L_modep_45
L_modeok_46:
    v_cmp_ne_u32 vcc, s71, v239
    s_nop 4
    s_cmp_eq_u64 vcc, 0
    s_cselect_b32 s49, 1, 0
    s_mov_b64 exec, -1
    s_barrier
    s_waitcnt lgkmcnt(1)
    v_mfma_f32_16x16x32_bf16 v[200:203], v[16:19], v[92:95], v[200:203]
    ds_read_b128 v[100:103], v220 offset:16384
    v_mfma_f32_16x16x32_bf16 v[204:207], v[92:95], v[92:95], v[204:207]
    ds_read_b128 v[104:107], v220 offset:18432
    s_waitcnt lgkmcnt(1)
    v_mfma_f32_16x16x32_bf16 v[200:203], v[16:19], v[100:103], v[200:203]
    ds_read_b128 v[108:111], v221 offset:16384
    v_mfma_f32_16x16x32_bf16 v[204:207], v[100:103], v[100:103], v[204:207]
    ds_read_b128 v[112:115], v221 offset:18432
    s_barrier
    s_waitcnt lgkmcnt(1)
    v_mfma_f32_16x16x32_bf16 v[200:203], v[16:19], v[108:111], v[200:203]
    ds_read_b128 v[116:119], v220 offset:32768
    v_mfma_f32_16x16x32_bf16 v[204:207], v[108:111], v[108:111], v[204:207]
    ds_read_b128 v[120:123], v220 offset:34816
    s_waitcnt lgkmcnt(1)
    v_mfma_f32_16x16x32_bf16 v[200:203], v[16:19], v[116:119], v[200:203]
    ds_read_b128 v[124:127], v221 offset:32768
    v_mfma_f32_16x16x32_bf16 v[204:207], v[116:119], v[116:119], v[204:207]
    ds_read_b128 v[128:131], v221 offset:34816
    s_waitcnt lgkmcnt(1)
    v_mfma_f32_16x16x32_bf16 v[200:203], v[16:19], v[124:127], v[200:203]
    v_mfma_f32_16x16x32_bf16 v[204:207], v[124:127], v[124:127], v[204:207]
    v_and_b32 v222, 3, v2
    v_cmp_eq_u32 s[78:79], 1, v222
    v_cmp_eq_u32 s[80:81], 2, v222
    v_cmp_eq_u32 s[82:83], 3, v222
    v_lshrrev_b32 v223, 2, v2
    v_cmp_eq_u32 s[72:73], v223, v3
    s_lshl_b32 s52, s45, 7
    s_add_u32 s52, s52, 147456
    v_lshl_add_u32 v226, v2, 2, s52
    v_mul_f32 v225, 0x3b124925, v200
    v_cndmask_b32 v224, v204, v205, s[78:79]
    v_cndmask_b32 v224, v224, v206, s[80:81]
    v_cndmask_b32 v224, v224, v207, s[82:83]
    v_mul_f32 v224, 0x3b124925, v224
    v_fma_f32 v224, -v225, v225, v224
    v_max_f32 v224, 0, v224
    v_add_f32 v224, 0x3727c5ac, v224
    v_rsq_f32 v224, v224
    s_nop 0
    v_mul_f32 v225, v225, v224
    v_sub_f32 v225, 0, v225
    s_mov_b64 exec, s[72:73]
    ds_write_b32 v226, v224
    ds_write_b32 v226, v225 offset:512
    s_mov_b64 exec, -1
    s_cmp_lg_u32 s45, 0
    s_cbranch_scc1 L_nw_47
    v_lshlrev_b32 v222, 4, v3
    v_add_u32 v222, s47, v222
    v_mul_u32_u24 v222, 21846, v222
    v_lshrrev_b32 v222, 16, v222
    v_lshlrev_b32 v222, 7, v222
    v_lshl_add_u32 v222, v2, 2, v222
    s_mov_b32 s52, 8192
    s_mov_b32 exec_lo, 1073692671
    s_mov_b32 exec_hi, 16383
    s_mov_b32 s70, 0
L_poll_48:
    buffer_load_dword v254, v222, s[8:11], s52 offen sc1
    s_waitcnt vmcnt(0)
    v_cmp_ne_u32 vcc, s48, v254
    s_nop 4
    s_cmp_eq_u64 vcc, 0
    s_cbranch_scc1 L_polld_49
    s_add_u32 s70, s70, 1
    s_cmp_lt_u32 s70, 4000
    s_cbranch_scc1 L_poll_48
L_polld_49:
    s_mov_b64 exec, -1
L_nw_47:
    s_waitcnt lgkmcnt(0)
    s_barrier
    s_lshr_b32 s53, s44, 1
    s_mul_i32 s52, s53, 14336
    s_mul_i32 s56, s47, 86016
    s_add_u32 s56, s56, s52
    s_add_u32 s56, s56, 262144
    s_add_u32 s52, s52, 81920
    s_cmp_eq_u32 s53, 3
    s_cselect_b32 s52, 16384, s52
    s_and_b32 s53, s44, 1
    s_mul_i32 s53, s53, 7
    s_lshl_b32 s55, s53, 10
    s_add_u32 s55, s55, s52
    s_mul_i32 s54, s75, 6
    s_add_u32 s54, s54, s53
    s_add_u32 s2, s54, 0
    s_cmp_ge_u32 s2, 14
    s_cselect_b32 s57, 14, 0
    s_sub_u32 s2, s2, s57
    s_lshl_b32 s2, s2, 10
    s_add_u32 s2, s2, s56
    s_add_u32 m0, s55, 0
    s_nop 0
    buffer_load_dwordx4 v7, s[8:11], s2 offen sc1 lds
    s_add_u32 s2, s54, 1
    s_cmp_ge_u32 s2, 14
    s_cselect_b32 s57, 14, 0
    s_sub_u32 s2, s2, s57
    s_lshl_b32 s2, s2, 10
    s_add_u32 s2, s2, s56
    s_add_u32 m0, s55, 1024
    s_nop 0
    buffer_load_dwordx4 v7, s[8:11], s2 offen sc1 lds
    s_add_u32 s2, s54, 2
    s_cmp_ge_u32 s2, 14
    s_cselect_b32 s57, 14, 0
    s_sub_u32 s2, s2, s57
    s_lshl_b32 s2, s2, 10
    s_add_u32 s2, s2, s56
    s_add_u32 m0, s55, 2048
    s_nop 0
    buffer_load_dwordx4 v7, s[8:11], s2 offen sc1 lds
    s_add_u32 s2, s54, 3
    s_cmp_ge_u32 s2, 14
    s_cselect_b32 s57, 14, 0
    s_sub_u32 s2, s2, s57
    s_lshl_b32 s2, s2, 10
    s_add_u32 s2, s2, s56
    s_add_u32 m0, s55, 3072
    s_nop 0
    buffer_load_dwordx4 v7, s[8:11], s2 offen sc1 lds
    s_add_u32 s2, s54, 4
    s_cmp_ge_u32 s2, 14
    s_cselect_b32 s57, 14, 0
    s_sub_u32 s2, s2, s57
    s_lshl_b32 s2, s2, 10
    s_add_u32 s2, s2, s56
    s_add_u32 m0, s55, 4096
    s_nop 0
    buffer_load_dwordx4 v7, s[8:11], s2 offen sc1 lds
    s_add_u32 s2, s54, 5
    s_cmp_ge_u32 s2, 14
    s_cselect_b32 s57, 14, 0
    s_sub_u32 s2, s2, s57
    s_lshl_b32 s2, s2, 10
    s_add_u32 s2, s2, s56
    s_add_u32 m0, s55, 5120
    s_nop 0
    buffer_load_dwordx4 v7, s[8:11], s2 offen sc1 lds
    s_add_u32 s2, s54, 6
    s_cmp_ge_u32 s2, 14
    s_cselect_b32 s57, 14, 0
    s_sub_u32 s2, s2, s57
    s_lshl_b32 s2, s2, 10
    s_add_u32 s2, s2, s56
    s_add_u32 m0, s55, 6144
    s_nop 0
    buffer_load_dwordx4 v7, s[8:11], s2 offen sc1 lds
    s_waitcnt vmcnt(0)
    s_barrier
    s_lshl_b32 s52, s45, 7
    s_add_u32 s52, s52, 147456
    v_lshl_add_u32 v220, v2, 2, s52
    ds_read_b32 v200, v220 offset:0
    ds_read_b32 v202, v220 offset:512
    ds_read_b32 v201, v220 offset:64
    ds_read_b32 v203, v220 offset:576
    s_mul_i32 s52, s45, 14336
    s_add_u32 s52, s52, 81920
    s_cmp_eq_u32 s45, 3
    s_cselect_b32 s52, 16384, s52
    v_add_u32 v221, s52, v7
    s_lshr_b32 s52, s44, 2
    s_mul_i32 s52, s52, 14336
    s_mul_i32 s56, s47, 86016
    s_add_u32 s56, s56, s52
    s_add_u32 s56, s56, 319488
    s_lshl_b32 s53, s45, 2
    s_lshl_b32 s55, s53, 10
    s_add_u32 s55, s55, s52
    s_mul_i32 s54, s75, 6
    s_add_u32 s54, s54, s53
    v_add_u32 v220, 81920, v7
    v_add_u32 v251, 96256, v7
    v_mov_b32 v204, 0
    v_mov_b32 v205, 0
    v_mov_b32 v206, 0
    v_mov_b32 v207, 0
    v_mov_b32 v208, 0
    v_mov_b32 v209, 0
    v_mov_b32 v210, 0
    v_mov_b32 v211, 0
    v_mov_b32 v212, 0
    v_mov_b32 v213, 0
    v_mov_b32 v214, 0
    v_mov_b32 v215, 0
    v_mov_b32 v216, 0
    v_mov_b32 v217, 0
    v_mov_b32 v218, 0
    v_mov_b32 v219, 0
    v_mov_b32 v196, 0
    v_mov_b32 v197, 0
    v_mov_b32 v198, 0
    v_mov_b32 v199, 0
    ds_read_b128 v[164:167], v220 offset:0
    ds_read_b128 v[168:171], v251 offset:0
    ds_read_b128 v[188:191], v221 offset:0
    ds_read_b128 v[172:175], v220 offset:1024
    ds_read_b128 v[176:179], v251 offset:1024
    s_waitcnt lgkmcnt(4)
    v_mfma_f32_16x16x32_bf16 v[204:207], v[164:167], v[20:23], v[204:207]
    ds_read_b128 v[180:183], v220 offset:2048
    v_mfma_f32_16x16x32_bf16 v[208:211], v[164:167], v[24:27], v[208:211]
    ds_read_b128 v[184:187], v251 offset:2048
    s_waitcnt lgkmcnt(5)
    v_mfma_f32_16x16x32_bf16 v[212:215], v[168:171], v[20:23], v[212:215]
    ds_read_b128 v[192:195], v221 offset:1024
    v_mfma_f32_16x16x32_bf16 v[216:219], v[168:171], v[24:27], v[216:219]
    s_waitcnt lgkmcnt(5)
    v_mfma_f32_16x16x32_bf16 v[196:199], v[188:191], v[16:19], v[196:199]
    s_waitcnt lgkmcnt(4)
    v_mfma_f32_16x16x32_bf16 v[204:207], v[172:175], v[28:31], v[204:207]
    ds_read_b128 v[164:167], v220 offset:3072
    v_mfma_f32_16x16x32_bf16 v[208:211], v[172:175], v[32:35], v[208:211]
    ds_read_b128 v[168:171], v251 offset:3072
    s_waitcnt lgkmcnt(5)
    v_mfma_f32_16x16x32_bf16 v[212:215], v[176:179], v[28:31], v[212:215]
    v_mfma_f32_16x16x32_bf16 v[216:219], v[176:179], v[32:35], v[216:219]
    s_waitcnt lgkmcnt(4)
    v_mfma_f32_16x16x32_bf16 v[204:207], v[180:183], v[36:39], v[204:207]
    ds_read_b128 v[172:175], v220 offset:4096
    v_mfma_f32_16x16x32_bf16 v[208:211], v[180:183], v[40:43], v[208:211]
    ds_read_b128 v[176:179], v251 offset:4096
    s_waitcnt lgkmcnt(5)
    v_mfma_f32_16x16x32_bf16 v[212:215], v[184:187], v[36:39], v[212:215]
    ds_read_b128 v[188:191], v221 offset:2048
    v_mfma_f32_16x16x32_bf16 v[216:219], v[184:187], v[40:43], v[216:219]
    s_waitcnt lgkmcnt(5)
    v_mfma_f32_16x16x32_bf16 v[196:199], v[192:195], v[16:19], v[196:199]
    s_waitcnt lgkmcnt(4)
    v_mfma_f32_16x16x32_bf16 v[204:207], v[164:167], v[44:47], v[204:207]
    ds_read_b128 v[180:183], v220 offset:5120
    v_mfma_f32_16x16x32_bf16 v[208:211], v[164:167], v[48:51], v[208:211]
    ds_read_b128 v[184:187], v251 offset:5120
    s_waitcnt lgkmcnt(5)
    v_mfma_f32_16x16x32_bf16 v[212:215], v[168:171], v[44:47], v[212:215]
    s_add_u32 s2, s54, 0
    s_cmp_ge_u32 s2, 14
    s_cselect_b32 s57, 14, 0
    s_sub_u32 s2, s2, s57
    s_lshl_b32 s2, s2, 10
    s_add_u32 s2, s2, s56
    s_add_u32 m0, s55, 49152
    s_nop 0
    buffer_load_dwordx4 v7, s[8:11], s2 offen sc1 lds
    v_mfma_f32_16x16x32_bf16 v[216:219], v[168:171], v[48:51], v[216:219]
    s_waitcnt lgkmcnt(4)
    v_mfma_f32_16x16x32_bf16 v[204:207], v[172:175], v[52:55], v[204:207]
    ds_read_b128 v[164:167], v220 offset:6144
    v_mfma_f32_16x16x32_bf16 v[208:211], v[172:175], v[56:59], v[208:211]
    ds_read_b128 v[168:171], v251 offset:6144
    s_waitcnt lgkmcnt(5)
    v_mfma_f32_16x16x32_bf16 v[212:215], v[176:179], v[52:55], v[212:215]
    ds_read_b128 v[192:195], v221 offset:3072
    v_mfma_f32_16x16x32_bf16 v[216:219], v[176:179], v[56:59], v[216:219]
    s_waitcnt lgkmcnt(5)
    v_mfma_f32_16x16x32_bf16 v[196:199], v[188:191], v[16:19], v[196:199]
    s_waitcnt lgkmcnt(4)
    v_mfma_f32_16x16x32_bf16 v[204:207], v[180:183], v[60:63], v[204:207]
    ds_read_b128 v[172:175], v220 offset:7168
    v_mfma_f32_16x16x32_bf16 v[208:211], v[180:183], v[64:67], v[208:211]
    ds_read_b128 v[176:179], v251 offset:7168
    s_waitcnt lgkmcnt(5)
    v_mfma_f32_16x16x32_bf16 v[212:215], v[184:187], v[60:63], v[212:215]
    v_mfma_f32_16x16x32_bf16 v[216:219], v[184:187], v[64:67], v[216:219]
    s_waitcnt lgkmcnt(4)
    v_mfma_f32_16x16x32_bf16 v[204:207], v[164:167], v[68:71], v[204:207]
    ds_read_b128 v[180:183], v220 offset:8192
    v_mfma_f32_16x16x32_bf16 v[208:211], v[164:167], v[72:75], v[208:211]
    ds_read_b128 v[184:187], v251 offset:8192
    s_waitcnt lgkmcnt(5)
    v_mfma_f32_16x16x32_bf16 v[212:215], v[168:171], v[68:71], v[212:215]
    ds_read_b128 v[188:191], v221 offset:4096
    s_add_u32 s2, s54, 1
    s_cmp_ge_u32 s2, 14
    s_cselect_b32 s57, 14, 0
    s_sub_u32 s2, s2, s57
    s_lshl_b32 s2, s2, 10
    s_add_u32 s2, s2, s56
    s_add_u32 m0, s55, 50176
    s_nop 0
    buffer_load_dwordx4 v7, s[8:11], s2 offen sc1 lds
    v_mfma_f32_16x16x32_bf16 v[216:219], v[168:171], v[72:75], v[216:219]
    s_waitcnt lgkmcnt(5)
    v_mfma_f32_16x16x32_bf16 v[196:199], v[192:195], v[16:19], v[196:199]
    s_waitcnt lgkmcnt(4)
    v_mfma_f32_16x16x32_bf16 v[204:207], v[172:175], v[76:79], v[204:207]
    ds_read_b128 v[164:167], v220 offset:9216
    v_mfma_f32_16x16x32_bf16 v[208:211], v[172:175], v[80:83], v[208:211]
    ds_read_b128 v[168:171], v251 offset:9216
    s_waitcnt lgkmcnt(5)
    v_mfma_f32_16x16x32_bf16 v[212:215], v[176:179], v[76:79], v[212:215]
    v_mfma_f32_16x16x32_bf16 v[216:219], v[176:179], v[80:83], v[216:219]
    s_waitcnt lgkmcnt(4)
    v_mfma_f32_16x16x32_bf16 v[204:207], v[180:183], v[84:87], v[204:207]
    ds_read_b128 v[172:175], v220 offset:10240
    v_mfma_f32_16x16x32_bf16 v[208:211], v[180:183], v[88:91], v[208:211]
    ds_read_b128 v[176:179], v251 offset:10240
    s_waitcnt lgkmcnt(5)
    v_mfma_f32_16x16x32_bf16 v[212:215], v[184:187], v[84:87], v[212:215]
    ds_read_b128 v[192:195], v221 offset:5120
    v_mfma_f32_16x16x32_bf16 v[216:219], v[184:187], v[88:91], v[216:219]
    s_waitcnt lgkmcnt(5)
    v_mfma_f32_16x16x32_bf16 v[196:199], v[188:191], v[16:19], v[196:199]
    s_waitcnt lgkmcnt(4)
    v_mfma_f32_16x16x32_bf16 v[204:207], v[164:167], v[92:95], v[204:207]
    ds_read_b128 v[180:183], v220 offset:11264
    v_mfma_f32_16x16x32_bf16 v[208:211], v[164:167], v[96:99], v[208:211]
    ds_read_b128 v[184:187], v251 offset:11264
    s_waitcnt lgkmcnt(5)
    v_mfma_f32_16x16x32_bf16 v[212:215], v[168:171], v[92:95], v[212:215]
    v_mfma_f32_16x16x32_bf16 v[216:219], v[168:171], v[96:99], v[216:219]
    s_waitcnt lgkmcnt(4)
    v_mfma_f32_16x16x32_bf16 v[204:207], v[172:175], v[100:103], v[204:207]
    ds_read_b128 v[164:167], v220 offset:12288
    v_mfma_f32_16x16x32_bf16 v[208:211], v[172:175], v[104:107], v[208:211]
    ds_read_b128 v[168:171], v251 offset:12288
    s_waitcnt lgkmcnt(5)
    v_mfma_f32_16x16x32_bf16 v[212:215], v[176:179], v[100:103], v[212:215]
    ds_read_b128 v[188:191], v221 offset:6144
    s_add_u32 s2, s54, 2
    s_cmp_ge_u32 s2, 14
    s_cselect_b32 s57, 14, 0
    s_sub_u32 s2, s2, s57
    s_lshl_b32 s2, s2, 10
    s_add_u32 s2, s2, s56
    s_add_u32 s57, s55, 51200
    s_cmp_eq_u32 s45, 3
    s_cselect_b32 m0, 80896, s57
    s_nop 0
    buffer_load_dwordx4 v7, s[8:11], s2 offen sc1 lds
    v_mfma_f32_16x16x32_bf16 v[216:219], v[176:179], v[104:107], v[216:219]
    s_waitcnt lgkmcnt(5)
    v_mfma_f32_16x16x32_bf16 v[196:199], v[192:195], v[16:19], v[196:199]
    s_waitcnt lgkmcnt(4)
    v_mfma_f32_16x16x32_bf16 v[204:207], v[180:183], v[108:111], v[204:207]
    ds_read_b128 v[172:175], v220 offset:13312
    v_mfma_f32_16x16x32_bf16 v[208:211], v[180:183], v[112:115], v[208:211]
    ds_read_b128 v[176:179], v251 offset:13312
    s_waitcnt lgkmcnt(5)
    v_mfma_f32_16x16x32_bf16 v[212:215], v[184:187], v[108:111], v[212:215]
    v_mfma_f32_16x16x32_bf16 v[216:219], v[184:187], v[112:115], v[216:219]
    s_waitcnt lgkmcnt(4)
    v_mfma_f32_16x16x32_bf16 v[204:207], v[164:167], v[116:119], v[204:207]
    v_mfma_f32_16x16x32_bf16 v[208:211], v[164:167], v[120:123], v[208:211]
    s_waitcnt lgkmcnt(3)
    v_mfma_f32_16x16x32_bf16 v[212:215], v[168:171], v[116:119], v[212:215]
    v_mfma_f32_16x16x32_bf16 v[216:219], v[168:171], v[120:123], v[216:219]
    s_waitcnt lgkmcnt(2)
    v_mfma_f32_16x16x32_bf16 v[196:199], v[188:191], v[16:19], v[196:199]
    s_waitcnt lgkmcnt(1)
    v_mfma_f32_16x16x32_bf16 v[204:207], v[172:175], v[124:127], v[204:207]
    v_mfma_f32_16x16x32_bf16 v[208:211], v[172:175], v[128:131], v[208:211]
    s_waitcnt lgkmcnt(0)
    v_mfma_f32_16x16x32_bf16 v[212:215], v[176:179], v[124:127], v[212:215]
    s_add_u32 s2, s54, 3
    s_cmp_ge_u32 s2, 14
    s_cselect_b32 s57, 14, 0
    s_sub_u32 s2, s2, s57
    s_lshl_b32 s2, s2, 10
    s_add_u32 s2, s2, s56
    s_add_u32 s57, s55, 52224
    s_cmp_eq_u32 s45, 3
    s_cselect_b32 m0, 80896, s57
    s_nop 0
    buffer_load_dwordx4 v7, s[8:11], s2 offen sc1 lds
    v_mfma_f32_16x16x32_bf16 v[216:219], v[176:179], v[128:131], v[216:219]
    s_lshl_b32 s52, s45, 6
    s_add_u32 s52, s52, 158208
    v_lshl_add_u32 v220, v3, 4, s52
    v_cmp_eq_u32 vcc, 0, v2
    s_nop 1
    s_mov_b64 exec, vcc
    ds_write_b128 v220, v[196:199]
    s_mov_b64 exec, -1
    s_waitcnt lgkmcnt(0)
    s_barrier
    v_lshrrev_b32 v243, 2, v2
    v_lshl_add_u32 v243, v3, 2, v243
    v_mul_u32_u24 v243, 56, v243
    v_and_b32 v244, 3, v1
    v_lshl_add_u32 v243, v244, 3, v243
    v_add_u32 v243, 155648, v243
    ds_read_b64_tr_b16 v[188:189], v243 offset:0
    ds_read_b64_tr_b16 v[190:191], v243 offset:896
    ds_read_b64_tr_b16 v[192:193], v243 offset:32
    ds_read_b64_tr_b16 v[194:195], v243 offset:928
    v_lshlrev_b32 v220, 4, v3
    v_add_u32 v220, 158208, v220
    ds_read_b128 v[172:175], v220 offset:0
    ds_read_b128 v[180:183], v220 offset:256
    ds_read_b128 v[176:179], v220 offset:64
    ds_read_b128 v[184:187], v220 offset:320
    s_waitcnt lgkmcnt(2)
    v_add_f32 v172, v172, v180
    v_add_f32 v173, v173, v181
    v_add_f32 v174, v174, v182
    v_add_f32 v175, v175, v183
    s_waitcnt lgkmcnt(0)
    v_add_f32 v176, v176, v184
    v_add_f32 v177, v177, v185
    v_add_f32 v178, v178, v186
    v_add_f32 v179, v179, v187
    s_lshl_b32 s52, s45, 10
    s_add_u32 s52, s52, 159744
    v_add_u32 v222, s52, v7
    v_mul_f32 v208, v201, v208
    v_fma_f32 v208, v203, v172, v208
    v_mul_f32 v209, v201, v209
    v_fma_f32 v209, v203, v173, v209
    v_mul_f32 v210, v201, v210
    v_fma_f32 v210, v203, v174, v210
    v_mul_f32 v211, v201, v211
    v_fma_f32 v211, v203, v175, v211
    v_cvt_pk_bf16_f32 v168, v208, v209
    v_cvt_pk_bf16_f32 v169, v210, v211
    v_mul_f32 v216, v201, v216
    v_fma_f32 v216, v203, v176, v216
    v_mul_f32 v217, v201, v217
    v_fma_f32 v217, v203, v177, v217
    v_mul_f32 v218, v201, v218
    v_fma_f32 v218, v203, v178, v218
    v_mul_f32 v219, v201, v219
    v_fma_f32 v219, v203, v179, v219
    v_cvt_pk_bf16_f32 v170, v216, v217
    v_cvt_pk_bf16_f32 v171, v218, v219
    ds_write_b128 v222, v[168:171]
    v_mul_f32 v204, v200, v204
    v_fma_f32 v204, v202, v172, v204
    v_mul_f32 v205, v200, v205
    v_fma_f32 v205, v202, v173, v205
    v_mul_f32 v206, v200, v206
    v_fma_f32 v206, v202, v174, v206
    v_mul_f32 v207, v200, v207
    v_fma_f32 v207, v202, v175, v207
    v_cvt_pk_bf16_f32 v164, v204, v205
    v_cvt_pk_bf16_f32 v165, v206, v207
    v_mul_f32 v212, v200, v212
    v_fma_f32 v212, v202, v176, v212
    v_mul_f32 v213, v200, v213
    v_fma_f32 v213, v202, v177, v213
    v_mul_f32 v214, v200, v214
    v_fma_f32 v214, v202, v178, v214
    v_mul_f32 v215, v200, v215
    v_fma_f32 v215, v202, v179, v215
    v_cvt_pk_bf16_f32 v166, v212, v213
    v_cvt_pk_bf16_f32 v167, v214, v215
    v_cndmask_b32 v190, v190, v15, s[62:63]
    v_cndmask_b32 v191, v191, v15, s[62:63]
    v_cndmask_b32 v194, v194, v15, s[62:63]
    v_cndmask_b32 v195, v195, v15, s[62:63]
    v_lshrrev_b32 v220, 1, v2
    v_and_b32 v220, 3, v220
    v_lshlrev_b32 v221, 7, v2
    v_lshl_add_u32 v221, v3, 3, v221
    s_lshl_b32 s52, s45, 12
    s_add_u32 s52, s52, 131072
    v_add_u32 v221, s52, v221
    v_xor_b32 v196, 0, v220
    v_lshl_add_u32 v204, v196, 5, v221
    v_xor_b32 v196, 1, v220
    v_lshl_add_u32 v205, v196, 5, v221
    v_xor_b32 v196, 2, v220
    v_lshl_add_u32 v206, v196, 5, v221
    v_xor_b32 v196, 3, v220
    v_lshl_add_u32 v207, v196, 5, v221
    s_waitcnt vmcnt(0)
    s_waitcnt lgkmcnt(0)
    s_barrier
    v_add_u32 v220, 49152, v7
    v_mov_b32 v148, 0
    v_mov_b32 v149, 0
    v_mov_b32 v150, 0
    v_mov_b32 v151, 0
    v_mov_b32 v152, 0
    v_mov_b32 v153, 0
    v_mov_b32 v154, 0
    v_mov_b32 v155, 0
    s_and_b32 s52, s45, 1
    s_mul_i32 s52, s52, 14336
    s_lshr_b32 s53, s45, 1
    s_mul_i32 s53, s53, 7168
    s_add_u32 s52, s52, s53
    s_add_u32 s52, s52, 49152
    v_add_u32 v221, s52, v7
    v_mov_b32 v196, 0
    v_mov_b32 v197, 0
    v_mov_b32 v198, 0
    v_mov_b32 v199, 0
    ds_read_b128 v[132:135], v220 offset:0
    ds_read_b128 v[136:139], v220 offset:14336
    ds_read_b128 v[156:159], v221 offset:0
    v_mfma_f32_16x16x32_bf16 v[172:175], v[188:191], v[164:167], 0
    v_mfma_f32_16x16x32_bf16 v[176:179], v[192:195], v[164:167], 0
    s_waitcnt lgkmcnt(2)
    v_mfma_f32_16x16x32_bf16 v[148:151], v[132:135], v[20:23], v[148:151]
    s_waitcnt lgkmcnt(1)
    v_mfma_f32_16x16x32_bf16 v[152:155], v[136:139], v[20:23], v[152:155]
    s_waitcnt lgkmcnt(0)
    v_mfma_f32_16x16x32_bf16 v[196:199], v[156:159], v[16:19], v[196:199]
    ds_read_b128 v[140:143], v220 offset:1024
    ds_read_b128 v[144:147], v220 offset:15360
    v_max3_f32 v222, v172, v173, v174
    v_max3_f32 v224, v176, v177, v178
    v_min3_f32 v223, v172, v173, v174
    v_min3_f32 v225, v176, v177, v178
    v_max_f32 v222, v222, v175
    v_max_f32 v224, v224, v179
    v_min_f32 v223, v223, v175
    s_waitcnt lgkmcnt(1)
    v_mfma_f32_16x16x32_bf16 v[148:151], v[140:143], v[28:31], v[148:151]
    s_waitcnt lgkmcnt(0)
    v_mfma_f32_16x16x32_bf16 v[152:155], v[144:147], v[28:31], v[152:155]
    ds_read_b128 v[132:135], v220 offset:2048
    ds_read_b128 v[136:139], v220 offset:16384
    ds_read_b128 v[160:163], v221 offset:1024
    v_min_f32 v225, v225, v179
    v_mov_b32 v226, 0x7149f2ca
    v_cndmask_b32 v224, v224, v222, s[62:63]
    v_cndmask_b32 v225, v225, v223, s[62:63]
    s_mov_b32 s56, 0x3fb8aa3b
    v_max_f32 v222, v222, v224
    v_min_f32 v223, v223, v225
    v_mul_f32 v222, 0x3fb8aa3b, v222
    s_waitcnt lgkmcnt(2)
    v_mfma_f32_16x16x32_bf16 v[148:151], v[132:135], v[36:39], v[148:151]
    s_waitcnt lgkmcnt(1)
    v_mfma_f32_16x16x32_bf16 v[152:155], v[136:139], v[36:39], v[152:155]
    s_waitcnt lgkmcnt(0)
    v_mfma_f32_16x16x32_bf16 v[196:199], v[160:163], v[16:19], v[196:199]
    ds_read_b128 v[140:143], v220 offset:3072
    ds_read_b128 v[144:147], v220 offset:17408
    v_mul_f32 v223, 0xbfb8aa3b, v223
    s_nop 1
    v_permlane32_swap_b32 v222, v223
    v_max_f32 v222, v222, v223
    v_mov_b32 v224, v222
    s_nop 1
    v_permlane16_swap_b32 v222, v224
    v_max_f32 v222, v222, v224
    v_mov_b32 v223, v222
    s_nop 1
    v_permlane32_swap_b32 v222, v223
    s_waitcnt lgkmcnt(1)
    v_mfma_f32_16x16x32_bf16 v[148:151], v[140:143], v[44:47], v[148:151]
    s_waitcnt lgkmcnt(0)
    v_mfma_f32_16x16x32_bf16 v[152:155], v[144:147], v[44:47], v[152:155]
    ds_read_b128 v[132:135], v220 offset:4096
    ds_read_b128 v[136:139], v220 offset:18432
    ds_read_b128 v[156:159], v221 offset:2048
    v_cndmask_b32 v224, v222, v226, s[62:63]
    v_cndmask_b32 v225, v223, v226, s[62:63]
    v_fma_f32 v227, v172, s56, -v222
    v_fma_f32 v235, -v172, s56, -v223
    v_fma_f32 v228, v173, s56, -v222
    v_fma_f32 v236, -v173, s56, -v223
    v_fma_f32 v229, v174, s56, -v222
    s_waitcnt lgkmcnt(2)
    v_mfma_f32_16x16x32_bf16 v[148:151], v[132:135], v[52:55], v[148:151]
    s_waitcnt lgkmcnt(1)
    v_mfma_f32_16x16x32_bf16 v[152:155], v[136:139], v[52:55], v[152:155]
    s_waitcnt lgkmcnt(0)
    v_mfma_f32_16x16x32_bf16 v[196:199], v[156:159], v[16:19], v[196:199]
    ds_read_b128 v[140:143], v220 offset:5120
    ds_read_b128 v[144:147], v220 offset:19456
    v_fma_f32 v237, -v174, s56, -v223
    v_fma_f32 v230, v175, s56, -v222
    v_fma_f32 v238, -v175, s56, -v223
    v_fma_f32 v231, v176, s56, -v224
    v_fma_f32 v239, -v176, s56, -v225
    v_fma_f32 v232, v177, s56, -v224
    v_fma_f32 v240, -v177, s56, -v225
    v_fma_f32 v233, v178, s56, -v224
    s_waitcnt lgkmcnt(1)
    v_mfma_f32_16x16x32_bf16 v[148:151], v[140:143], v[60:63], v[148:151]
    s_waitcnt lgkmcnt(0)
    v_mfma_f32_16x16x32_bf16 v[152:155], v[144:147], v[60:63], v[152:155]
    ds_read_b128 v[132:135], v220 offset:6144
    ds_read_b128 v[136:139], v220 offset:20480
    ds_read_b128 v[160:163], v221 offset:3072
    v_fma_f32 v241, -v178, s56, -v225
    v_fma_f32 v234, v179, s56, -v224
    v_fma_f32 v242, -v179, s56, -v225
    v_exp_f32 v227, v227
    v_exp_f32 v235, v235
    v_exp_f32 v228, v228
    v_exp_f32 v236, v236
    v_exp_f32 v229, v229
    s_waitcnt lgkmcnt(2)
    v_mfma_f32_16x16x32_bf16 v[148:151], v[132:135], v[68:71], v[148:151]
    s_waitcnt lgkmcnt(1)
    v_mfma_f32_16x16x32_bf16 v[152:155], v[136:139], v[68:71], v[152:155]
    s_waitcnt lgkmcnt(0)
    v_mfma_f32_16x16x32_bf16 v[196:199], v[160:163], v[16:19], v[196:199]
    ds_read_b128 v[140:143], v220 offset:7168
    ds_read_b128 v[144:147], v220 offset:21504
    v_exp_f32 v237, v237
    v_exp_f32 v230, v230
    v_exp_f32 v238, v238
    v_exp_f32 v231, v231
    v_exp_f32 v239, v239
    v_exp_f32 v232, v232
    v_exp_f32 v240, v240
    v_exp_f32 v233, v233
    s_waitcnt lgkmcnt(1)
    v_mfma_f32_16x16x32_bf16 v[148:151], v[140:143], v[76:79], v[148:151]
    s_waitcnt lgkmcnt(0)
    v_mfma_f32_16x16x32_bf16 v[152:155], v[144:147], v[76:79], v[152:155]
    ds_read_b128 v[132:135], v220 offset:8192
    ds_read_b128 v[136:139], v220 offset:22528
    ds_read_b128 v[156:159], v221 offset:4096
    v_exp_f32 v241, v241
    v_exp_f32 v234, v234
    v_exp_f32 v242, v242
    v_add_f32 v222, v227, v228
    v_add_f32 v223, v235, v236
    v_add_f32 v224, v229, v230
    v_add_f32 v225, v237, v238
    s_waitcnt lgkmcnt(2)
    v_mfma_f32_16x16x32_bf16 v[148:151], v[132:135], v[84:87], v[148:151]
    s_waitcnt lgkmcnt(1)
    v_mfma_f32_16x16x32_bf16 v[152:155], v[136:139], v[84:87], v[152:155]
    s_waitcnt lgkmcnt(0)
    v_mfma_f32_16x16x32_bf16 v[196:199], v[156:159], v[16:19], v[196:199]
    ds_read_b128 v[140:143], v220 offset:9216
    ds_read_b128 v[144:147], v220 offset:23552
    v_add_f32 v222, v222, v231
    v_add_f32 v223, v223, v239
    v_add_f32 v224, v224, v232
    v_add_f32 v225, v225, v240
    v_add_f32 v222, v222, v233
    v_add_f32 v223, v223, v241
    v_add_f32 v224, v224, v234
    v_add_f32 v225, v225, v242
    s_waitcnt lgkmcnt(1)
    v_mfma_f32_16x16x32_bf16 v[148:151], v[140:143], v[92:95], v[148:151]
    s_waitcnt lgkmcnt(0)
    v_mfma_f32_16x16x32_bf16 v[152:155], v[144:147], v[92:95], v[152:155]
    ds_read_b128 v[132:135], v220 offset:10240
    ds_read_b128 v[136:139], v220 offset:24576
    ds_read_b128 v[160:163], v221 offset:5120
    v_add_f32 v222, v222, v224
    v_add_f32 v223, v223, v225
    s_nop 1
    v_permlane32_swap_b32 v222, v223
    v_add_f32 v222, v222, v223
    v_mov_b32 v224, v222
    s_nop 1
    v_permlane16_swap_b32 v222, v224
    v_add_f32 v222, v222, v224
    v_mov_b32 v223, v222
    s_waitcnt lgkmcnt(2)
    v_mfma_f32_16x16x32_bf16 v[148:151], v[132:135], v[100:103], v[148:151]
    s_waitcnt lgkmcnt(1)
    v_mfma_f32_16x16x32_bf16 v[152:155], v[136:139], v[100:103], v[152:155]
    s_waitcnt lgkmcnt(0)
    v_mfma_f32_16x16x32_bf16 v[196:199], v[160:163], v[16:19], v[196:199]
    ds_read_b128 v[140:143], v220 offset:11264
    ds_read_b128 v[144:147], v220 offset:25600
    v_permlane32_swap_b32 v222, v223
    v_rcp_f32 v222, v222
    v_rcp_f32 v223, v223
    v_mul_f32 v227, v222, v227
    v_mul_f32 v235, v223, v235
    v_mul_f32 v228, v222, v228
    v_mul_f32 v236, v223, v236
    s_waitcnt lgkmcnt(1)
    v_mfma_f32_16x16x32_bf16 v[148:151], v[140:143], v[108:111], v[148:151]
    s_waitcnt lgkmcnt(0)
    v_mfma_f32_16x16x32_bf16 v[152:155], v[144:147], v[108:111], v[152:155]
    ds_read_b128 v[132:135], v220 offset:12288
    ds_read_b128 v[136:139], v220 offset:26624
    ds_read_b128 v[156:159], v221 offset:6144
    v_mul_f32 v229, v222, v229
    v_mul_f32 v237, v223, v237
    v_mul_f32 v230, v222, v230
    v_mul_f32 v238, v223, v238
    v_mul_f32 v231, v222, v231
    v_mul_f32 v239, v223, v239
    v_mul_f32 v232, v222, v232
    v_mul_f32 v240, v223, v240
    s_waitcnt lgkmcnt(2)
    v_mfma_f32_16x16x32_bf16 v[148:151], v[132:135], v[116:119], v[148:151]
    s_waitcnt lgkmcnt(1)
    v_mfma_f32_16x16x32_bf16 v[152:155], v[136:139], v[116:119], v[152:155]
    s_waitcnt lgkmcnt(0)
    v_mfma_f32_16x16x32_bf16 v[196:199], v[156:159], v[16:19], v[196:199]
    ds_read_b128 v[140:143], v220 offset:13312
    ds_read_b128 v[144:147], v220 offset:27648
    v_mul_f32 v233, v222, v233
    v_mul_f32 v241, v223, v241
    v_mul_f32 v234, v222, v234
    v_mul_f32 v242, v223, v242
    v_cvt_pk_bf16_f32 v180, v227, v228
    v_cvt_pk_bf16_f32 v184, v235, v236
    v_cvt_pk_bf16_f32 v181, v229, v230
    v_cvt_pk_bf16_f32 v185, v237, v238
    s_waitcnt lgkmcnt(1)
    v_mfma_f32_16x16x32_bf16 v[148:151], v[140:143], v[124:127], v[148:151]
    s_waitcnt lgkmcnt(0)
    v_mfma_f32_16x16x32_bf16 v[152:155], v[144:147], v[124:127], v[152:155]
    v_cvt_pk_bf16_f32 v182, v231, v232
    v_cvt_pk_bf16_f32 v186, v239, v240
    v_cvt_pk_bf16_f32 v183, v233, v234
    v_cvt_pk_bf16_f32 v187, v241, v242
    ds_write_b64 v204, v[180:181] offset:0
    ds_write_b64 v205, v[182:183] offset:0
    ds_write_b64 v206, v[184:185] offset:0
    ds_write_b64 v207, v[186:187] offset:0
    s_lshl_b32 s52, s45, 6
    s_add_u32 s52, s52, 158720
    v_lshl_add_u32 v220, v3, 4, s52
    v_cmp_eq_u32 vcc, 0, v2
    s_nop 1
    s_mov_b64 exec, vcc
    ds_write_b128 v220, v[196:199]
    s_mov_b64 exec, -1
    s_waitcnt lgkmcnt(0)
    s_barrier
    v_lshrrev_b32 v222, 2, v2
    v_lshl_add_u32 v223, v3, 2, v222
    v_lshrrev_b32 v224, 1, v223
    v_and_b32 v224, 3, v224
    s_lshr_b32 s52, s44, 1
    v_xor_b32 v224, s52, v224
    v_lshlrev_b32 v223, 7, v223
    v_lshl_add_u32 v223, v224, 5, v223
    v_and_b32 v224, 3, v1
    v_lshl_add_u32 v223, v224, 3, v223
    v_add_u32 v223, 131072, v223
    s_and_b32 s52, s44, 1
    s_lshl_b32 s52, s52, 10
    s_add_u32 s52, s52, 147456
    v_add_u32 v224, s52, v7
    ds_read_b64_tr_b16 v[164:165], v223 offset:0
    ds_read_b64_tr_b16 v[166:167], v223 offset:2048
    ds_read_b128 v[180:183], v224 offset:0
    ds_read_b64_tr_b16 v[168:169], v223 offset:4096
    ds_read_b64_tr_b16 v[170:171], v223 offset:6144
    ds_read_b128 v[184:187], v224 offset:2048
    ds_read_b64_tr_b16 v[172:173], v223 offset:8192
    ds_read_b64_tr_b16 v[174:175], v223 offset:10240
    ds_read_b128 v[188:191], v224 offset:4096
    ds_read_b64_tr_b16 v[176:177], v223 offset:12288
    ds_read_b64_tr_b16 v[178:179], v223 offset:14336
    ds_read_b128 v[192:195], v224 offset:6144
    s_waitcnt lgkmcnt(9)
    v_mfma_f32_16x16x32_bf16 v[226:229], v[164:167], v[180:183], 0
    s_waitcnt lgkmcnt(6)
    v_mfma_f32_16x16x32_bf16 v[226:229], v[168:171], v[184:187], v[226:229]
    s_waitcnt lgkmcnt(3)
    v_mfma_f32_16x16x32_bf16 v[226:229], v[172:175], v[188:191], v[226:229]
    s_waitcnt lgkmcnt(0)
    v_mfma_f32_16x16x32_bf16 v[226:229], v[176:179], v[192:195], v[226:229]
    s_lshl_b32 s52, s47, 17
    s_lshl_b32 s57, s46, 13
    s_add_u32 s52, s52, s57
    s_lshl_b32 s57, s44, 10
    s_add_u32 s52, s52, s57
    s_add_u32 s52, s52, 2097152
    s_nop 1
    v_bfi_b32 v226, s74, v14, v226
    buffer_store_dwordx4 v[226:229], v7, s[8:11], s52 offen sc1
    v_lshrrev_b32 v243, 2, v2
    v_lshl_add_u32 v243, v3, 2, v243
    v_mul_u32_u24 v243, 56, v243
    v_and_b32 v244, 3, v1
    v_lshl_add_u32 v243, v244, 3, v243
    v_add_u32 v243, 155648, v243
    ds_read_b64_tr_b16 v[104:105], v243 offset:0
    ds_read_b64_tr_b16 v[106:107], v243 offset:896
    ds_read_b64_tr_b16 v[108:109], v243 offset:32
    ds_read_b64_tr_b16 v[110:111], v243 offset:928
    v_lshlrev_b32 v220, 4, v3
    v_add_u32 v220, 158720, v220
    ds_read_b128 v[84:87], v220 offset:0
    ds_read_b128 v[92:95], v220 offset:128
    ds_read_b128 v[88:91], v220 offset:64
    ds_read_b128 v[96:99], v220 offset:192
    s_waitcnt lgkmcnt(2)
    v_add_f32 v84, v84, v92
    v_add_f32 v85, v85, v93
    v_add_f32 v86, v86, v94
    v_add_f32 v87, v87, v95
    s_waitcnt lgkmcnt(0)
    v_add_f32 v88, v88, v96
    v_add_f32 v89, v89, v97
    v_add_f32 v90, v90, v98
    v_add_f32 v91, v91, v99
    v_mul_f32 v148, v200, v148
    v_fma_f32 v148, v202, v84, v148
    v_mul_f32 v149, v200, v149
    v_fma_f32 v149, v202, v85, v149
    v_mul_f32 v150, v200, v150
    v_fma_f32 v150, v202, v86, v150
    v_mul_f32 v151, v200, v151
    v_fma_f32 v151, v202, v87, v151
    v_cvt_pk_bf16_f32 v120, v148, v149
    v_cvt_pk_bf16_f32 v121, v150, v151
    v_mul_f32 v152, v200, v152
    v_fma_f32 v152, v202, v88, v152
    v_mul_f32 v153, v200, v153
    v_fma_f32 v153, v202, v89, v153
    v_mul_f32 v154, v200, v154
    v_fma_f32 v154, v202, v90, v154
    v_mul_f32 v155, v200, v155
    v_fma_f32 v155, v202, v91, v155
    v_cvt_pk_bf16_f32 v122, v152, v153
    v_cvt_pk_bf16_f32 v123, v154, v155
    s_barrier
    s_sub_u32 s56, s47, 14
    s_lshl_b32 s52, s46, 17
    s_lshl_b32 s57, s56, 12
    s_add_u32 s52, s52, s57
    s_lshl_b32 s57, s45, 10
    s_add_u32 s52, s52, s57
    s_add_u32 s52, s52, 2097152
    s_waitcnt vmcnt(0) lgkmcnt(0)
    s_mov_b32 s70, 0
L_rl_50:
    s_mov_b32 s53, s52
    buffer_load_dwordx4 v[132:135], v7, s[8:11], s53 offen sc1
    s_add_u32 s53, s53, 8192
    buffer_load_dwordx4 v[136:139], v7, s[8:11], s53 offen sc1
    s_add_u32 s53, s53, 8192
    buffer_load_dwordx4 v[140:143], v7, s[8:11], s53 offen sc1
    s_add_u32 s53, s53, 8192
    buffer_load_dwordx4 v[144:147], v7, s[8:11], s53 offen sc1
    s_add_u32 s53, s53, 8192
    buffer_load_dwordx4 v[148:151], v7, s[8:11], s53 offen sc1
    s_add_u32 s53, s53, 8192
    buffer_load_dwordx4 v[152:155], v7, s[8:11], s53 offen sc1
    s_add_u32 s53, s53, 8192
    buffer_load_dwordx4 v[156:159], v7, s[8:11], s53 offen sc1
    s_add_u32 s53, s53, 8192
    buffer_load_dwordx4 v[160:163], v7, s[8:11], s53 offen sc1
    s_waitcnt vmcnt(0)
    v_xor_b32 v222, v14, v132
    v_xor_b32 v223, v14, v136
    v_or_b32 v222, v222, v223
    v_xor_b32 v223, v14, v140
    v_or_b32 v222, v222, v223
    v_xor_b32 v223, v14, v144
    v_or_b32 v222, v222, v223
    v_xor_b32 v223, v14, v148
    v_or_b32 v222, v222, v223
    v_xor_b32 v223, v14, v152
    v_or_b32 v222, v222, v223
    v_xor_b32 v223, v14, v156
    v_or_b32 v222, v222, v223
    v_xor_b32 v223, v14, v160
    v_or_b32 v222, v222, v223
    v_and_b32 v222, 0xfff, v222
    v_cmp_ne_u32 vcc, 0, v222
    s_nop 4
    s_cmp_eq_u64 vcc, 0
    s_cbranch_scc1 L_rok_51
    s_add_u32 s70, s70, 1
    s_cmp_lt_u32 s70, 4000
    s_cbranch_scc1 L_rl_50
L_rok_51:
    v_add_f32 v132, v132, v136
    v_add_f32 v133, v133, v137
    v_add_f32 v134, v134, v138
    v_add_f32 v135, v135, v139
    v_add_f32 v140, v140, v144
    v_add_f32 v141, v141, v145
    v_add_f32 v142, v142, v146
    v_add_f32 v143, v143, v147
    v_add_f32 v148, v148, v152
    v_add_f32 v149, v149, v153
    v_add_f32 v150, v150, v154
    v_add_f32 v151, v151, v155
    v_add_f32 v156, v156, v160
    v_add_f32 v157, v157, v161
    v_add_f32 v158, v158, v162
    v_add_f32 v159, v159, v163
    v_add_f32 v132, v132, v140
    v_add_f32 v148, v148, v156
    v_add_f32 v133, v133, v141
    v_add_f32 v149, v149, v157
    v_add_f32 v134, v134, v142
    v_add_f32 v150, v150, v158
    v_add_f32 v135, v135, v143
    v_add_f32 v151, v151, v159
    v_add_f32 v132, v132, v148
    v_add_f32 v133, v133, v149
    v_add_f32 v134, v134, v150
    v_add_f32 v135, v135, v151
    s_barrier
    s_lshl_b32 s52, s45, 10
    s_add_u32 s52, s52, 131072
    v_add_u32 v222, s52, v7
    ds_read_b128 v[136:139], v222
    s_sub_u32 s56, s47, 14
    s_lshl_b32 s54, s46, 13
    s_lshl_b32 s57, s56, 12
    s_add_u32 s54, s54, s57
    s_lshl_b32 s57, s45, 10
    s_add_u32 s54, s54, s57
    s_add_u32 s54, s54, 4194304
    s_waitcnt lgkmcnt(0)
    v_add_f32 v132, v132, v136
    v_add_f32 v133, v133, v137
    v_add_f32 v134, v134, v138
    v_add_f32 v135, v135, v139
    v_bfi_b32 v132, s74, v14, v132
    buffer_store_dwordx4 v[132:135], v7, s[8:11], s54 offen sc1
    v_cndmask_b32 v106, v106, v15, s[62:63]
    v_cndmask_b32 v107, v107, v15, s[62:63]
    v_cndmask_b32 v110, v110, v15, s[62:63]
    v_cndmask_b32 v111, v111, v15, s[62:63]
    v_mfma_f32_16x16x32_bf16 v[84:87], v[104:107], v[120:123], 0
    s_nop 0
    v_mfma_f32_16x16x32_bf16 v[88:91], v[108:111], v[120:123], 0
    s_nop 5
    v_max3_f32 v222, v84, v85, v86
    s_nop 0
    v_max3_f32 v224, v88, v89, v90
    v_min3_f32 v223, v84, v85, v86
    v_min3_f32 v225, v88, v89, v90
    v_max_f32 v222, v222, v87
    v_max_f32 v224, v224, v91
    v_min_f32 v223, v223, v87
    v_min_f32 v225, v225, v91
    v_mov_b32 v226, 0x7149f2ca
    v_cndmask_b32 v224, v224, v222, s[62:63]
    v_cndmask_b32 v225, v225, v223, s[62:63]
    s_mov_b32 s56, 0x3fb8aa3b
    v_max_f32 v222, v222, v224
    v_min_f32 v223, v223, v225
    v_mul_f32 v222, 0x3fb8aa3b, v222
    v_mul_f32 v223, 0xbfb8aa3b, v223
    s_nop 1
    v_permlane32_swap_b32 v222, v223
    v_max_f32 v222, v222, v223
    v_mov_b32 v224, v222
    s_nop 1
    v_permlane16_swap_b32 v222, v224
    v_max_f32 v222, v222, v224
    v_mov_b32 v223, v222
    s_nop 1
    v_permlane32_swap_b32 v222, v223
    v_cndmask_b32 v224, v222, v226, s[62:63]
    v_cndmask_b32 v225, v223, v226, s[62:63]
    v_fma_f32 v227, v84, s56, -v222
    v_fma_f32 v235, -v84, s56, -v223
    v_fma_f32 v228, v85, s56, -v222
    v_fma_f32 v236, -v85, s56, -v223
    v_fma_f32 v229, v86, s56, -v222
    v_fma_f32 v237, -v86, s56, -v223
    v_fma_f32 v230, v87, s56, -v222
    v_fma_f32 v238, -v87, s56, -v223
    v_fma_f32 v231, v88, s56, -v224
    v_fma_f32 v239, -v88, s56, -v225
    v_fma_f32 v232, v89, s56, -v224
    v_fma_f32 v240, -v89, s56, -v225
    v_fma_f32 v233, v90, s56, -v224
    v_fma_f32 v241, -v90, s56, -v225
    v_fma_f32 v234, v91, s56, -v224
    v_fma_f32 v242, -v91, s56, -v225
    v_exp_f32 v227, v227
    v_exp_f32 v235, v235
    v_exp_f32 v228, v228
    v_exp_f32 v236, v236
    v_exp_f32 v229, v229
    v_exp_f32 v237, v237
    v_exp_f32 v230, v230
    v_exp_f32 v238, v238
    v_exp_f32 v231, v231
    v_exp_f32 v239, v239
    v_exp_f32 v232, v232
    v_exp_f32 v240, v240
    v_exp_f32 v233, v233
    v_exp_f32 v241, v241
    v_exp_f32 v234, v234
    v_exp_f32 v242, v242
    v_add_f32 v222, v227, v228
    v_add_f32 v223, v235, v236
    v_add_f32 v224, v229, v230
    v_add_f32 v225, v237, v238
    v_add_f32 v222, v222, v231
    v_add_f32 v223, v223, v239
    v_add_f32 v224, v224, v232
    v_add_f32 v225, v225, v240
    v_add_f32 v222, v222, v233
    v_add_f32 v223, v223, v241
    v_add_f32 v224, v224, v234
    v_add_f32 v225, v225, v242
    v_add_f32 v222, v222, v224
    v_add_f32 v223, v223, v225
    s_nop 1
    v_permlane32_swap_b32 v222, v223
    v_add_f32 v222, v222, v223
    v_mov_b32 v224, v222
    s_nop 1
    v_permlane16_swap_b32 v222, v224
    v_add_f32 v222, v222, v224
    v_mov_b32 v223, v222
    s_nop 1
    v_permlane32_swap_b32 v222, v223
    v_rcp_f32 v222, v222
    v_rcp_f32 v223, v223
    v_mul_f32 v227, v222, v227
    v_mul_f32 v235, v223, v235
    v_mul_f32 v228, v222, v228
    v_mul_f32 v236, v223, v236
    v_mul_f32 v229, v222, v229
    v_mul_f32 v237, v223, v237
    v_mul_f32 v230, v222, v230
    v_mul_f32 v238, v223, v238
    v_mul_f32 v231, v222, v231
    v_mul_f32 v239, v223, v239
    v_mul_f32 v232, v222, v232
    v_mul_f32 v240, v223, v240
    v_mul_f32 v233, v222, v233
    v_mul_f32 v241, v223, v241
    v_mul_f32 v234, v222, v234
    v_mul_f32 v242, v223, v242
    v_cvt_pk_bf16_f32 v208, v227, v228
    v_cvt_pk_bf16_f32 v212, v235, v236
    v_cvt_pk_bf16_f32 v209, v229, v230
    v_cvt_pk_bf16_f32 v213, v237, v238
    v_cvt_pk_bf16_f32 v210, v231, v232
    v_cvt_pk_bf16_f32 v214, v239, v240
    v_cvt_pk_bf16_f32 v211, v233, v234
    v_cvt_pk_bf16_f32 v215, v241, v242
    s_lshl_b32 s52, s47, 13
    s_lshl_b32 s57, s44, 10
    s_add_u32 s52, s52, s57
    s_add_u32 s52, s52, 4194304
    buffer_load_dwordx4 v[124:127], v7, s[8:11], s52 offen sc1
    s_waitcnt vmcnt(0)
    v_xor_b32 v244, v14, v124
    v_and_b32 v244, 0xfff, v244
    v_cmp_ne_u32 vcc, 0, v244
    s_nop 1
    s_cmp_eq_u64 vcc, 0
    s_cbranch_scc1 L_kok_53
    s_lshl_b32 s52, s47, 13
    s_lshl_b32 s57, s44, 10
    s_add_u32 s52, s52, s57
    s_add_u32 s52, s52, 4194304
    s_mov_b32 s70, 0
L_kl_52:
    buffer_load_dwordx4 v[124:127], v7, s[8:11], s52 offen sc1
    s_waitcnt vmcnt(0)
    v_xor_b32 v244, v14, v124
    v_and_b32 v244, 0xfff, v244
    v_cmp_ne_u32 vcc, 0, v244
    s_nop 4
    s_cmp_eq_u64 vcc, 0
    s_cbranch_scc1 L_kok_53
    s_add_u32 s70, s70, 1
    s_cmp_lt_u32 s70, 4000
    s_cbranch_scc1 L_kl_52
L_kok_53:
    s_lshr_b32 s52, s44, 2
    s_lshl_b32 s52, s52, 1
    s_and_b32 s53, s44, 1
    s_add_u32 s52, s52, s53
    s_lshl_b32 s52, s52, 10
    s_bfe_u32 s53, s44, 0x10001
    s_lshl_b32 s53, s53, 3
    s_add_u32 s52, s52, s53
    s_add_u32 s52, s52, 159744
    v_cvt_pk_bf16_f32 v124, v124, v125
    v_cvt_pk_bf16_f32 v125, v126, v127
    v_add_u32 v244, s52, v7
    ds_write_b64 v244, v[124:125]
    v_add_u32 v244, 159744, v7
    s_waitcnt lgkmcnt(0)
    s_barrier
    ds_read_b128 v[84:87], v244 offset:0
    ds_read_b128 v[88:91], v244 offset:1024
    ds_read_b128 v[92:95], v244 offset:2048
    ds_read_b128 v[96:99], v244 offset:3072
    s_waitcnt lgkmcnt(3)
    v_mfma_f32_16x16x32_bf16 v[108:111], v[84:87], v[208:211], 0
    s_waitcnt lgkmcnt(2)
    v_mfma_f32_16x16x32_bf16 v[112:115], v[88:91], v[208:211], 0
    v_mov_b32_dpp v100, v88 row_newbcast:12 row_mask:0xf bank_mask:0xf
    v_mov_b32_dpp v101, v89 row_newbcast:12 row_mask:0xf bank_mask:0xf
    v_mov_b32_dpp v102, v90 row_newbcast:12 row_mask:0xf bank_mask:0xf
    v_mov_b32_dpp v103, v91 row_newbcast:12 row_mask:0xf bank_mask:0xf
    s_waitcnt lgkmcnt(0)
    v_mov_b32_dpp v104, v96 row_newbcast:12 row_mask:0xf bank_mask:0xf
    v_mov_b32_dpp v105, v97 row_newbcast:12 row_mask:0xf bank_mask:0xf
    v_mov_b32_dpp v106, v98 row_newbcast:12 row_mask:0xf bank_mask:0xf
    v_mov_b32_dpp v107, v99 row_newbcast:12 row_mask:0xf bank_mask:0xf
    v_mfma_f32_16x16x32_bf16 v[108:111], v[92:95], v[212:215], v[108:111]
    v_mfma_f32_16x16x32_bf16 v[112:115], v[96:99], v[212:215], v[112:115]
    v_mfma_f32_16x16x32_bf16 v[116:119], v[100:103], v[208:211], 0
    v_mfma_f32_16x16x32_bf16 v[116:119], v[104:107], v[212:215], v[116:119]
    s_nop 7
    v_add_f32 v116, 0x358637bd, v116
    v_rcp_f32 v116, v116
    s_nop 0
    v_mul_f32 v108, v116, v108
    v_mul_f32 v109, v116, v109
    v_mul_f32 v110, v116, v110
    v_mul_f32 v111, v116, v111
    v_mul_f32 v112, v116, v112
    v_mul_f32 v113, v116, v113
    v_mul_f32 v114, v116, v114
    v_mul_f32 v115, v116, v115
    v_cvt_pk_bf16_f32 v120, v108, v109
    v_cvt_pk_bf16_f32 v121, v110, v111
    v_cvt_pk_bf16_f32 v122, v112, v113
    v_cvt_pk_bf16_f32 v123, v114, v115
    v_cndmask_b32 v122, v122, v15, s[62:63]
    v_cndmask_b32 v123, v123, v15, s[62:63]
    s_lshl_b32 s52, s46, 17
    s_lshl_b32 s57, s45, 15
    s_add_u32 s52, s52, s57
    s_lshl_b32 s57, s47, 10
    s_add_u32 s52, s52, s57
    s_add_u32 s52, s52, 12582912
    buffer_store_dwordx4 v[120:123], v7, s[8:11], s52 offen sc1
    s_waitcnt vmcnt(0)
    s_lshl_b32 s52, s46, 9
    s_lshl_b32 s57, s47, 5
    s_add_u32 s52, s52, s57
    s_lshl_b32 s57, s44, 2
    s_add_u32 s52, s52, s57
    s_add_u32 s52, s52, 163840
    s_mov_b64 exec, 1
    s_cmp_eq_u32 s49, 0
    s_cbranch_scc1 L_slow_54
    buffer_store_dword v14, v15, s[8:11], s52 offen
    s_branch L_mdone_55
L_slow_54:
    buffer_store_dword v14, v15, s[8:11], s52 offen sc1
L_mdone_55:
    s_mov_b64 exec, -1
    s_endpgm
L_helpB:
    v_lshlrev_b32 v238, 7, v1
    s_and_b32 s52, s46, 1
    s_lshl_b32 s52, s52, 1
    s_add_u32 s52, s52, s47
    s_sub_u32 s52, s52, 14
    s_lshl_b32 s52, s52, 3
    s_add_u32 s52, s52, s44
    s_lshl_b32 s52, s52, 13
    buffer_load_dword v249, v238, s[8:11], s52 offen
    s_mul_i32 s2, s75, 384
    s_add_u32 s2, s2, 128
    s_add_u32 m0, s58, 16384
    s_nop 0
    buffer_load_dwordx4 v4, s[4:7], s2 offen lds
    s_add_u32 m0, s58, 17408
    s_nop 0
    buffer_load_dwordx4 v5, s[4:7], s2 offen lds
    s_cmp_ge_u32 s47, 7
    s_cselect_b32 s50, 1, 0
    s_mul_i32 s52, s50, 7
    s_sub_u32 s51, s47, s52
    s_mul_i32 s3, s50, 802816
    s_mov_b32 s49, 0
    s_getreg_b32 s71, hwreg(HW_REG_XCC_ID)
    s_and_b32 s71, s71, 15
    v_mov_b32 v15, 0
    s_movk_i32 s74, 0xfff
    v_mov_b32 v16, 0x3f803f80
    v_mov_b32 v17, 0x3f803f80
    v_mov_b32 v18, 0x3f803f80
    v_mov_b32 v19, 0x3f803f80
    v_cmp_eq_u32 s[62:63], 3, v3
    v_cmp_le_u32 s[64:65], 12, v2
    s_mul_i32 s52, s47, 1568
    s_lshl_b32 s53, s44, 8
    s_add_u32 s52, s52, s53
    s_add_u32 m0, s53, 155648
    s_mov_b64 exec, 0xffff
    buffer_load_dwordx4 v7, s[32:35], s52 offen lds
    s_mov_b64 exec, -1
    v_lshrrev_b32 v222, 1, v2
    v_xor_b32 v222, v222, v3
    v_lshlrev_b32 v223, 7, v2
    s_lshl_b32 s52, s45, 12
    v_add_u32 v223, s52, v223
    v_lshl_add_u32 v12, v222, 4, v223
    v_xor_b32 v222, 4, v222
    v_lshl_add_u32 v13, v222, 4, v223
    v_add_u32 v220, 0x10000, v12
    v_add_u32 v221, 0x10000, v13
    v_mov_b32 v196, 0
    v_mov_b32 v197, 0
    v_mov_b32 v198, 0
    v_mov_b32 v199, 0
    v_mov_b32 v200, 0
    v_mov_b32 v201, 0
    v_mov_b32 v202, 0
    v_mov_b32 v203, 0
    v_mov_b32 v204, 0
    v_mov_b32 v205, 0
    v_mov_b32 v206, 0
    v_mov_b32 v207, 0
    s_cmp_ge_u32 s44, 6
    s_cselect_b32 s52, 2, 0
    s_sub_u32 s52, s44, s52
    s_lshr_b32 s53, s52, 1
    s_and_b32 s54, s52, 1
    v_lshrrev_b32 v222, 2, v2
    v_lshl_add_u32 v222, v3, 3, v222
    v_mul_u32_u24 v222, 176, v222
    v_and_b32 v223, 3, v1
    v_lshl_add_u32 v222, v223, 3, v222
    s_mul_i32 s55, s53, 56
    s_lshl_b32 s56, s54, 5
    s_add_u32 s55, s55, s56
    s_add_u32 s55, s55, 131072
    v_add_u32 v222, s55, v222
    s_and_b32 s55, s61, 15
    s_mul_i32 s55, s55, 3
    s_add_u32 s55, s55, s53
    s_and_b32 s56, s55, 15
    s_lshr_b32 s55, s55, 4
    s_add_u32 s55, s55, 2
    s_cmp_ge_u32 s55, 3
    s_cselect_b32 s57, 3, 0
    s_sub_u32 s55, s55, s57
    s_mul_i32 s56, s56, 3
    s_add_u32 s56, s56, s55
    s_lshl_b32 s56, s56, 1
    s_add_u32 s56, s56, s54
    s_mul_i32 s56, s56, 14336
    s_lshr_b32 s55, s61, 4
    s_lshl_b32 s57, s55, 10
    s_add_u32 s56, s56, s57
    s_add_u32 s56, s56, 262144
    s_cmp_ge_u32 s55, 14
    s_cselect_b32 s57, 1073741824, 0
    s_add_u32 s56, s56, s57
    s_waitcnt vmcnt(6)
    s_waitcnt lgkmcnt(0)
    s_add_u32 s48, s60, 0x9e3779b9
    v_mov_b32 v14, s48
    s_barrier
    ds_read_b64_tr_b16 v[226:227], v222
    ds_read_b64_tr_b16 v[228:229], v222 offset:704
    s_waitcnt lgkmcnt(0)
    buffer_store_dwordx4 v[226:229], v7, s[8:11], s56 offen sc1
    s_cmp_lg_u32 s45, 3
    s_cbranch_scc1 L_nw_56
    v_lshlrev_b32 v238, 7, v1
    s_lshl_b32 s52, s61, 13
    buffer_load_dword v249, v238, s[16:19], s52 offen
    s_sub_u32 s52, s52, 1605632
    s_cselect_b32 s52, 1073741824, s52
    buffer_load_dword v249, v238, s[20:23], s52 offen
L_nw_56:
    s_cmp_lg_u32 s45, 2
    s_cbranch_scc1 L_nw_57
    v_lshlrev_b32 v238, 7, v1
    s_lshl_b32 s52, s61, 13
    s_waitcnt vmcnt(4)
    buffer_load_dword v249, v238, s[12:15], s52 offen
    s_sub_u32 s52, s52, 1605632
    s_cselect_b32 s52, 1073741824, s52
    buffer_load_dword v249, v238, s[36:39], s52 offen
    buffer_load_dword v249, v238, s[40:43], s52 offen
    buffer_load_dword v249, v238, s[32:35], s52 offen
L_nw_57:
    s_waitcnt vmcnt(5)
    s_barrier
    ds_read_b128 v[20:23], v12 offset:0
    ds_read_b128 v[24:27], v12 offset:2048
    s_waitcnt lgkmcnt(0)
    v_mfma_f32_16x16x32_bf16 v[200:203], v[16:19], v[24:27], v[200:203]
    ds_read_b128 v[28:31], v13 offset:0
    s_mul_i32 s2, s75, 384
    s_add_u32 s2, s2, 256
    s_add_u32 m0, s58, 32768
    s_nop 0
    buffer_load_dwordx4 v4, s[4:7], s2 offen lds
    s_add_u32 m0, s58, 33792
    s_nop 0
    buffer_load_dwordx4 v5, s[4:7], s2 offen lds
    v_mfma_f32_16x16x32_bf16 v[204:207], v[24:27], v[24:27], v[204:207]
    ds_read_b128 v[32:35], v13 offset:2048
    s_mul_i32 s2, s75, 384
    s_add_u32 s2, s2, 384
    s_add_u32 m0, s58, 49152
    s_nop 0
    buffer_load_dwordx4 v4, s[4:7], s2 offen lds
    s_add_u32 m0, s58, 50176
    s_nop 0
    buffer_load_dwordx4 v5, s[4:7], s2 offen lds
    s_waitcnt vmcnt(6)
    s_barrier
    s_waitcnt lgkmcnt(0)
    v_mfma_f32_16x16x32_bf16 v[200:203], v[16:19], v[32:35], v[200:203]
    ds_read_b128 v[36:39], v12 offset:16384
    s_mul_i32 s2, s75, 4294966784
    s_add_u32 s2, s2, 512
    s_add_u32 m0, s58, 65536
    s_nop 0
    buffer_load_dwordx4 v4, s[4:7], s2 offen lds
    s_add_u32 m0, s58, 66560
    s_nop 0
    buffer_load_dwordx4 v5, s[4:7], s2 offen lds
    v_mfma_f32_16x16x32_bf16 v[204:207], v[32:35], v[32:35], v[204:207]
    ds_read_b128 v[40:43], v12 offset:18432
    s_mul_i32 s2, s75, 4294966784
    s_add_u32 s2, s2, 640
    s_add_u32 m0, s58, 81920
    s_nop 0
    buffer_load_dwordx4 v4, s[4:7], s2 offen lds
    s_add_u32 m0, s58, 82944
    s_nop 0
    buffer_load_dwordx4 v5, s[4:7], s2 offen lds
    s_waitcnt lgkmcnt(0)
    v_mfma_f32_16x16x32_bf16 v[200:203], v[16:19], v[40:43], v[200:203]
    ds_read_b128 v[44:47], v13 offset:16384
    s_mul_i32 s2, s75, 4294966784
    s_add_u32 s2, s2, 768
    s_add_u32 m0, s58, 98304
    s_nop 0
    buffer_load_dwordx4 v4, s[4:7], s2 offen lds
    v_mfma_f32_16x16x32_bf16 v[204:207], v[40:43], v[40:43], v[204:207]
    ds_read_b128 v[48:51], v13 offset:18432
    s_add_u32 m0, s58, 99328
    s_nop 0
    buffer_load_dwordx4 v5, s[4:7], s2 offen lds
    s_waitcnt vmcnt(8)
    s_barrier
    s_waitcnt lgkmcnt(0)
    v_mfma_f32_16x16x32_bf16 v[200:203], v[16:19], v[48:51], v[200:203]
    ds_read_b128 v[52:55], v12 offset:32768
    v_mfma_f32_16x16x32_bf16 v[204:207], v[48:51], v[48:51], v[204:207]
    ds_read_b128 v[56:59], v12 offset:34816
    s_waitcnt lgkmcnt(0)
    v_mfma_f32_16x16x32_bf16 v[200:203], v[16:19], v[56:59], v[200:203]
    ds_read_b128 v[60:63], v13 offset:32768
    v_mfma_f32_16x16x32_bf16 v[204:207], v[56:59], v[56:59], v[204:207]
    ds_read_b128 v[64:67], v13 offset:34816
    s_and_b32 s52, s61, 7
    s_lshl_b32 s52, s52, 7
    s_add_u32 s52, s52, 4096
    v_lshlrev_b32 v248, 2, v1
    buffer_load_dword v248, v248, s[8:11], s52 offen sc1
    s_waitcnt vmcnt(7)
    s_barrier
    s_waitcnt lgkmcnt(0)
    v_mfma_f32_16x16x32_bf16 v[200:203], v[16:19], v[64:67], v[200:203]
    ds_read_b128 v[68:71], v12 offset:49152
    v_mfma_f32_16x16x32_bf16 v[204:207], v[64:67], v[64:67], v[204:207]
    ds_read_b128 v[72:75], v12 offset:51200
    s_waitcnt lgkmcnt(0)
    v_mfma_f32_16x16x32_bf16 v[200:203], v[16:19], v[72:75], v[200:203]
    ds_read_b128 v[76:79], v13 offset:49152
    v_mfma_f32_16x16x32_bf16 v[204:207], v[72:75], v[72:75], v[204:207]
    ds_read_b128 v[80:83], v13 offset:51200
    s_waitcnt vmcnt(5)
    s_barrier
    s_waitcnt lgkmcnt(0)
    v_mfma_f32_16x16x32_bf16 v[200:203], v[16:19], v[80:83], v[200:203]
    ds_read_b128 v[84:87], v220 offset:0
    v_mfma_f32_16x16x32_bf16 v[204:207], v[80:83], v[80:83], v[204:207]
    ds_read_b128 v[88:91], v220 offset:2048
    s_waitcnt lgkmcnt(0)
    v_mfma_f32_16x16x32_bf16 v[200:203], v[16:19], v[88:91], v[200:203]
    ds_read_b128 v[92:95], v221 offset:0
    v_mfma_f32_16x16x32_bf16 v[204:207], v[88:91], v[88:91], v[204:207]
    ds_read_b128 v[96:99], v221 offset:2048
    s_waitcnt vmcnt(0)
    v_subrev_u32 v239, s48, v248
    s_mov_b32 s70, 0
L_modep_58:
    s_mov_b32 exec_hi, 0
    v_cmp_le_u32 vcc, 16, v239
    s_nop 4
    s_cmp_eq_u64 vcc, 0
    s_cbranch_scc1 L_modeok_59
    s_add_u32 s70, s70, 1
    s_cmp_ge_u32 s70, 4000
    s_cbranch_scc1 L_modeok_59
    s_and_b32 s52, s61, 7
    s_lshl_b32 s52, s52, 7
    s_add_u32 s52, s52, 4096
    v_lshlrev_b32 v239, 2, v1
    buffer_load_dword v239, v239, s[8:11], s52 offen sc1
    s_waitcnt vmcnt(0)
    v_subrev_u32 v239, s48, v239
    s_branch L_modep_58
L_modeok_59:
    v_cmp_ne_u32 vcc, s71, v239
    s_nop 4
    s_cmp_eq_u64 vcc, 0
    s_cselect_b32 s49, 1, 0
    s_mov_b64 exec, -1
    s_barrier
    s_waitcnt lgkmcnt(0)
    v_mfma_f32_16x16x32_bf16 v[200:203], v[16:19], v[96:99], v[200:203]
    ds_read_b128 v[100:103], v220 offset:16384
    v_mfma_f32_16x16x32_bf16 v[204:207], v[96:99], v[96:99], v[204:207]
    ds_read_b128 v[104:107], v220 offset:18432
    s_waitcnt lgkmcnt(0)
    v_mfma_f32_16x16x32_bf16 v[200:203], v[16:19], v[104:107], v[200:203]
    ds_read_b128 v[108:111], v221 offset:16384
    v_mfma_f32_16x16x32_bf16 v[204:207], v[104:107], v[104:107], v[204:207]
    ds_read_b128 v[112:115], v221 offset:18432
    s_barrier
    s_waitcnt lgkmcnt(0)
    v_mfma_f32_16x16x32_bf16 v[200:203], v[16:19], v[112:115], v[200:203]
    ds_read_b128 v[116:119], v220 offset:32768
    v_mfma_f32_16x16x32_bf16 v[204:207], v[112:115], v[112:115], v[204:207]
    ds_read_b128 v[120:123], v220 offset:34816
    s_waitcnt lgkmcnt(0)
    v_mfma_f32_16x16x32_bf16 v[200:203], v[16:19], v[120:123], v[200:203]
    ds_read_b128 v[124:127], v221 offset:32768
    v_mfma_f32_16x16x32_bf16 v[204:207], v[120:123], v[120:123], v[204:207]
    ds_read_b128 v[128:131], v221 offset:34816
    s_waitcnt lgkmcnt(0)
    v_mfma_f32_16x16x32_bf16 v[200:203], v[16:19], v[128:131], v[200:203]
    v_mfma_f32_16x16x32_bf16 v[204:207], v[128:131], v[128:131], v[204:207]
    v_and_b32 v222, 3, v2
    v_cmp_eq_u32 s[78:79], 1, v222
    v_cmp_eq_u32 s[80:81], 2, v222
    v_cmp_eq_u32 s[82:83], 3, v222
    v_lshrrev_b32 v223, 2, v2
    v_cmp_eq_u32 s[72:73], v223, v3
    s_lshl_b32 s52, s45, 7
    s_add_u32 s52, s52, 147520
    v_lshl_add_u32 v226, v2, 2, s52
    v_mul_f32 v225, 0x3b124925, v200
    v_cndmask_b32 v224, v204, v205, s[78:79]
    v_cndmask_b32 v224, v224, v206, s[80:81]
    v_cndmask_b32 v224, v224, v207, s[82:83]
    v_mul_f32 v224, 0x3b124925, v224
    v_fma_f32 v224, -v225, v225, v224
    v_max_f32 v224, 0, v224
    v_add_f32 v224, 0x3727c5ac, v224
    v_rsq_f32 v224, v224
    s_nop 0
    v_mul_f32 v225, v225, v224
    v_sub_f32 v225, 0, v225
    s_mov_b64 exec, s[72:73]
    ds_write_b32 v226, v224
    ds_write_b32 v226, v225 offset:512
    s_mov_b64 exec, -1
    s_waitcnt lgkmcnt(0)
    s_barrier
    s_lshr_b32 s53, s44, 1
    s_mul_i32 s52, s53, 14336
    s_mul_i32 s56, s47, 86016
    s_add_u32 s56, s56, s52
    s_add_u32 s56, s56, 262144
    s_add_u32 s52, s52, 81920
    s_cmp_eq_u32 s53, 3
    s_cselect_b32 s52, 16384, s52
    s_and_b32 s53, s44, 1
    s_mul_i32 s53, s53, 7
    s_lshl_b32 s55, s53, 10
    s_add_u32 s55, s55, s52
    s_mul_i32 s54, s75, 6
    s_add_u32 s54, s54, s53
    s_add_u32 s2, s54, 0
    s_cmp_ge_u32 s2, 14
    s_cselect_b32 s57, 14, 0
    s_sub_u32 s2, s2, s57
    s_lshl_b32 s2, s2, 10
    s_add_u32 s2, s2, s56
    s_add_u32 m0, s55, 0
    s_nop 0
    buffer_load_dwordx4 v7, s[8:11], s2 offen sc1 lds
    s_add_u32 s2, s54, 1
    s_cmp_ge_u32 s2, 14
    s_cselect_b32 s57, 14, 0
    s_sub_u32 s2, s2, s57
    s_lshl_b32 s2, s2, 10
    s_add_u32 s2, s2, s56
    s_add_u32 m0, s55, 1024
    s_nop 0
    buffer_load_dwordx4 v7, s[8:11], s2 offen sc1 lds
    s_add_u32 s2, s54, 2
    s_cmp_ge_u32 s2, 14
    s_cselect_b32 s57, 14, 0
    s_sub_u32 s2, s2, s57
    s_lshl_b32 s2, s2, 10
    s_add_u32 s2, s2, s56
    s_add_u32 m0, s55, 2048
    s_nop 0
    buffer_load_dwordx4 v7, s[8:11], s2 offen sc1 lds
    s_add_u32 s2, s54, 3
    s_cmp_ge_u32 s2, 14
    s_cselect_b32 s57, 14, 0
    s_sub_u32 s2, s2, s57
    s_lshl_b32 s2, s2, 10
    s_add_u32 s2, s2, s56
    s_add_u32 m0, s55, 3072
    s_nop 0
    buffer_load_dwordx4 v7, s[8:11], s2 offen sc1 lds
    s_add_u32 s2, s54, 4
    s_cmp_ge_u32 s2, 14
    s_cselect_b32 s57, 14, 0
    s_sub_u32 s2, s2, s57
    s_lshl_b32 s2, s2, 10
    s_add_u32 s2, s2, s56
    s_add_u32 m0, s55, 4096
    s_nop 0
    buffer_load_dwordx4 v7, s[8:11], s2 offen sc1 lds
    s_add_u32 s2, s54, 5
    s_cmp_ge_u32 s2, 14
    s_cselect_b32 s57, 14, 0
    s_sub_u32 s2, s2, s57
    s_lshl_b32 s2, s2, 10
    s_add_u32 s2, s2, s56
    s_add_u32 m0, s55, 5120
    s_nop 0
    buffer_load_dwordx4 v7, s[8:11], s2 offen sc1 lds
    s_add_u32 s2, s54, 6
    s_cmp_ge_u32 s2, 14
    s_cselect_b32 s57, 14, 0
    s_sub_u32 s2, s2, s57
    s_lshl_b32 s2, s2, 10
    s_add_u32 s2, s2, s56
    s_add_u32 m0, s55, 6144
    s_nop 0
    buffer_load_dwordx4 v7, s[8:11], s2 offen sc1 lds
    s_waitcnt vmcnt(0)
    s_barrier
    s_lshl_b32 s52, s45, 7
    s_add_u32 s52, s52, 147456
    v_lshl_add_u32 v220, v2, 2, s52
    ds_read_b32 v200, v220 offset:0
    ds_read_b32 v202, v220 offset:512
    ds_read_b32 v201, v220 offset:64
    ds_read_b32 v203, v220 offset:576
    s_mul_i32 s52, s45, 14336
    s_add_u32 s52, s52, 89088
    s_cmp_eq_u32 s45, 3
    s_cselect_b32 s52, 23552, s52
    v_add_u32 v221, s52, v7
    s_lshr_b32 s52, s44, 2
    s_mul_i32 s52, s52, 14336
    s_mul_i32 s56, s47, 86016
    s_add_u32 s56, s56, s52
    s_add_u32 s56, s56, 319488
    s_lshl_b32 s53, s45, 2
    s_lshl_b32 s55, s53, 10
    s_add_u32 s55, s55, s52
    s_mul_i32 s54, s75, 6
    s_add_u32 s54, s54, s53
    v_add_u32 v220, 110592, v7
    v_add_u32 v251, 16384, v7
    v_mov_b32 v204, 0
    v_mov_b32 v205, 0
    v_mov_b32 v206, 0
    v_mov_b32 v207, 0
    v_mov_b32 v208, 0
    v_mov_b32 v209, 0
    v_mov_b32 v210, 0
    v_mov_b32 v211, 0
    v_mov_b32 v212, 0
    v_mov_b32 v213, 0
    v_mov_b32 v214, 0
    v_mov_b32 v215, 0
    v_mov_b32 v216, 0
    v_mov_b32 v217, 0
    v_mov_b32 v218, 0
    v_mov_b32 v219, 0
    v_mov_b32 v196, 0
    v_mov_b32 v197, 0
    v_mov_b32 v198, 0
    v_mov_b32 v199, 0
    ds_read_b128 v[164:167], v220 offset:0
    ds_read_b128 v[168:171], v251 offset:0
    ds_read_b128 v[188:191], v221 offset:0
    ds_read_b128 v[172:175], v220 offset:1024
    ds_read_b128 v[176:179], v251 offset:1024
    s_waitcnt lgkmcnt(4)
    v_mfma_f32_16x16x32_bf16 v[204:207], v[20:23], v[164:167], v[204:207]
    ds_read_b128 v[180:183], v220 offset:2048
    v_mfma_f32_16x16x32_bf16 v[208:211], v[24:27], v[164:167], v[208:211]
    ds_read_b128 v[184:187], v251 offset:2048
    s_waitcnt lgkmcnt(5)
    v_mfma_f32_16x16x32_bf16 v[212:215], v[20:23], v[168:171], v[212:215]
    ds_read_b128 v[192:195], v221 offset:1024
    v_mfma_f32_16x16x32_bf16 v[216:219], v[24:27], v[168:171], v[216:219]
    s_waitcnt lgkmcnt(5)
    v_mfma_f32_16x16x32_bf16 v[196:199], v[188:191], v[16:19], v[196:199]
    s_waitcnt lgkmcnt(4)
    v_mfma_f32_16x16x32_bf16 v[204:207], v[28:31], v[172:175], v[204:207]
    ds_read_b128 v[164:167], v220 offset:3072
    v_mfma_f32_16x16x32_bf16 v[208:211], v[32:35], v[172:175], v[208:211]
    ds_read_b128 v[168:171], v251 offset:3072
    s_waitcnt lgkmcnt(5)
    v_mfma_f32_16x16x32_bf16 v[212:215], v[28:31], v[176:179], v[212:215]
    v_mfma_f32_16x16x32_bf16 v[216:219], v[32:35], v[176:179], v[216:219]
    s_waitcnt lgkmcnt(4)
    v_mfma_f32_16x16x32_bf16 v[204:207], v[36:39], v[180:183], v[204:207]
    ds_read_b128 v[172:175], v220 offset:4096
    v_mfma_f32_16x16x32_bf16 v[208:211], v[40:43], v[180:183], v[208:211]
    ds_read_b128 v[176:179], v251 offset:4096
    s_waitcnt lgkmcnt(5)
    v_mfma_f32_16x16x32_bf16 v[212:215], v[36:39], v[184:187], v[212:215]
    ds_read_b128 v[188:191], v221 offset:2048
    s_lshl_b32 s52, s45, 7
    s_add_u32 s52, s52, 147456
    v_lshl_add_u32 v238, v3, 4, s52
    ds_read_b128 v[132:135], v238 offset:0
    ds_read_b128 v[140:143], v238 offset:512
    ds_read_b128 v[136:139], v238 offset:64
    ds_read_b128 v[144:147], v238 offset:576
    v_mfma_f32_16x16x32_bf16 v[216:219], v[40:43], v[184:187], v[216:219]
    s_waitcnt lgkmcnt(9)
    v_mfma_f32_16x16x32_bf16 v[196:199], v[192:195], v[16:19], v[196:199]
    s_waitcnt lgkmcnt(8)
    v_mfma_f32_16x16x32_bf16 v[204:207], v[44:47], v[164:167], v[204:207]
    ds_read_b128 v[180:183], v220 offset:5120
    v_mfma_f32_16x16x32_bf16 v[208:211], v[48:51], v[164:167], v[208:211]
    ds_read_b128 v[184:187], v251 offset:5120
    s_waitcnt lgkmcnt(9)
    v_mfma_f32_16x16x32_bf16 v[212:215], v[44:47], v[168:171], v[212:215]
    v_mfma_f32_16x16x32_bf16 v[216:219], v[48:51], v[168:171], v[216:219]
    s_waitcnt lgkmcnt(8)
    v_mfma_f32_16x16x32_bf16 v[204:207], v[52:55], v[172:175], v[204:207]
    ds_read_b128 v[164:167], v220 offset:6144
    v_mfma_f32_16x16x32_bf16 v[208:211], v[56:59], v[172:175], v[208:211]
    ds_read_b128 v[168:171], v251 offset:6144
    s_waitcnt lgkmcnt(9)
    v_mfma_f32_16x16x32_bf16 v[212:215], v[52:55], v[176:179], v[212:215]
    ds_read_b128 v[192:195], v221 offset:3072
    v_mfma_f32_16x16x32_bf16 v[216:219], v[56:59], v[176:179], v[216:219]
    s_waitcnt lgkmcnt(9)
    v_mfma_f32_16x16x32_bf16 v[196:199], v[188:191], v[16:19], v[196:199]
    s_waitcnt lgkmcnt(4)
    v_mfma_f32_16x16x32_bf16 v[204:207], v[60:63], v[180:183], v[204:207]
    ds_read_b128 v[172:175], v220 offset:7168
    v_mfma_f32_16x16x32_bf16 v[208:211], v[64:67], v[180:183], v[208:211]
    ds_read_b128 v[176:179], v251 offset:7168
    s_waitcnt lgkmcnt(5)
    v_mfma_f32_16x16x32_bf16 v[212:215], v[60:63], v[184:187], v[212:215]
    s_add_u32 s2, s54, 0
    s_cmp_ge_u32 s2, 14
    s_cselect_b32 s57, 14, 0
    s_sub_u32 s2, s2, s57
    s_lshl_b32 s2, s2, 10
    s_add_u32 s2, s2, s56
    s_add_u32 m0, s55, 49152
    s_nop 0
    buffer_load_dwordx4 v7, s[8:11], s2 offen sc1 lds
    v_mfma_f32_16x16x32_bf16 v[216:219], v[64:67], v[184:187], v[216:219]
    s_waitcnt lgkmcnt(4)
    v_mfma_f32_16x16x32_bf16 v[204:207], v[68:71], v[164:167], v[204:207]
    ds_read_b128 v[180:183], v220 offset:8192
    v_mfma_f32_16x16x32_bf16 v[208:211], v[72:75], v[164:167], v[208:211]
    ds_read_b128 v[184:187], v251 offset:8192
    s_waitcnt lgkmcnt(5)
    v_mfma_f32_16x16x32_bf16 v[212:215], v[68:71], v[168:171], v[212:215]
    ds_read_b128 v[188:191], v221 offset:4096
    v_mfma_f32_16x16x32_bf16 v[216:219], v[72:75], v[168:171], v[216:219]
    s_waitcnt lgkmcnt(5)
    v_mfma_f32_16x16x32_bf16 v[196:199], v[192:195], v[16:19], v[196:199]
    s_waitcnt lgkmcnt(4)
    v_mfma_f32_16x16x32_bf16 v[204:207], v[76:79], v[172:175], v[204:207]
    ds_read_b128 v[164:167], v220 offset:9216
    v_mfma_f32_16x16x32_bf16 v[208:211], v[80:83], v[172:175], v[208:211]
    ds_read_b128 v[168:171], v251 offset:9216
    s_waitcnt lgkmcnt(5)
    v_mfma_f32_16x16x32_bf16 v[212:215], v[76:79], v[176:179], v[212:215]
    v_mfma_f32_16x16x32_bf16 v[216:219], v[80:83], v[176:179], v[216:219]
    s_waitcnt lgkmcnt(4)
    v_mfma_f32_16x16x32_bf16 v[204:207], v[84:87], v[180:183], v[204:207]
    ds_read_b128 v[172:175], v220 offset:10240
    v_mfma_f32_16x16x32_bf16 v[208:211], v[88:91], v[180:183], v[208:211]
    ds_read_b128 v[176:179], v251 offset:10240
    s_waitcnt lgkmcnt(5)
    v_mfma_f32_16x16x32_bf16 v[212:215], v[84:87], v[184:187], v[212:215]
    ds_read_b128 v[192:195], v221 offset:5120
    s_add_u32 s2, s54, 1
    s_cmp_ge_u32 s2, 14
    s_cselect_b32 s57, 14, 0
    s_sub_u32 s2, s2, s57
    s_lshl_b32 s2, s2, 10
    s_add_u32 s2, s2, s56
    s_add_u32 m0, s55, 50176
    s_nop 0
    buffer_load_dwordx4 v7, s[8:11], s2 offen sc1 lds
    v_mfma_f32_16x16x32_bf16 v[216:219], v[88:91], v[184:187], v[216:219]
    s_waitcnt lgkmcnt(5)
    v_mfma_f32_16x16x32_bf16 v[196:199], v[188:191], v[16:19], v[196:199]
    s_waitcnt lgkmcnt(4)
    v_mfma_f32_16x16x32_bf16 v[204:207], v[92:95], v[164:167], v[204:207]
    ds_read_b128 v[180:183], v220 offset:11264
    v_mfma_f32_16x16x32_bf16 v[208:211], v[96:99], v[164:167], v[208:211]
    ds_read_b128 v[184:187], v251 offset:11264
    s_waitcnt lgkmcnt(5)
    v_mfma_f32_16x16x32_bf16 v[212:215], v[92:95], v[168:171], v[212:215]
    v_mfma_f32_16x16x32_bf16 v[216:219], v[96:99], v[168:171], v[216:219]
    s_waitcnt lgkmcnt(4)
    v_mfma_f32_16x16x32_bf16 v[204:207], v[100:103], v[172:175], v[204:207]
    ds_read_b128 v[164:167], v220 offset:12288
    v_mfma_f32_16x16x32_bf16 v[208:211], v[104:107], v[172:175], v[208:211]
    ds_read_b128 v[168:171], v251 offset:12288
    s_waitcnt lgkmcnt(5)
    v_mfma_f32_16x16x32_bf16 v[212:215], v[100:103], v[176:179], v[212:215]
    ds_read_b128 v[188:191], v221 offset:6144
    v_mfma_f32_16x16x32_bf16 v[216:219], v[104:107], v[176:179], v[216:219]
    s_waitcnt lgkmcnt(5)
    v_mfma_f32_16x16x32_bf16 v[196:199], v[192:195], v[16:19], v[196:199]
    s_waitcnt lgkmcnt(4)
    v_mfma_f32_16x16x32_bf16 v[204:207], v[108:111], v[180:183], v[204:207]
    ds_read_b128 v[172:175], v220 offset:13312
    v_mfma_f32_16x16x32_bf16 v[208:211], v[112:115], v[180:183], v[208:211]
    ds_read_b128 v[176:179], v251 offset:13312
    s_waitcnt lgkmcnt(5)
    v_mfma_f32_16x16x32_bf16 v[212:215], v[108:111], v[184:187], v[212:215]
    s_add_u32 s2, s54, 2
    s_cmp_ge_u32 s2, 14
    s_cselect_b32 s57, 14, 0
    s_sub_u32 s2, s2, s57
    s_lshl_b32 s2, s2, 10
    s_add_u32 s2, s2, s56
    s_add_u32 s57, s55, 51200
    s_cmp_eq_u32 s45, 3
    s_cselect_b32 m0, 80896, s57
    s_nop 0
    buffer_load_dwordx4 v7, s[8:11], s2 offen sc1 lds
    v_mfma_f32_16x16x32_bf16 v[216:219], v[112:115], v[184:187], v[216:219]
    s_waitcnt lgkmcnt(4)
    v_mfma_f32_16x16x32_bf16 v[204:207], v[116:119], v[164:167], v[204:207]
    v_mfma_f32_16x16x32_bf16 v[208:211], v[120:123], v[164:167], v[208:211]
    s_waitcnt lgkmcnt(3)
    v_mfma_f32_16x16x32_bf16 v[212:215], v[116:119], v[168:171], v[212:215]
    v_mfma_f32_16x16x32_bf16 v[216:219], v[120:123], v[168:171], v[216:219]
    s_waitcnt lgkmcnt(2)
    v_mfma_f32_16x16x32_bf16 v[196:199], v[188:191], v[16:19], v[196:199]
    s_waitcnt lgkmcnt(1)
    v_mfma_f32_16x16x32_bf16 v[204:207], v[124:127], v[172:175], v[204:207]
    v_mfma_f32_16x16x32_bf16 v[208:211], v[128:131], v[172:175], v[208:211]
    s_waitcnt lgkmcnt(0)
    v_mfma_f32_16x16x32_bf16 v[212:215], v[124:127], v[176:179], v[212:215]
    s_add_u32 s2, s54, 3
    s_cmp_ge_u32 s2, 14
    s_cselect_b32 s57, 14, 0
    s_sub_u32 s2, s2, s57
    s_lshl_b32 s2, s2, 10
    s_add_u32 s2, s2, s56
    s_add_u32 s57, s55, 52224
    s_cmp_eq_u32 s45, 3
    s_cselect_b32 m0, 80896, s57
    s_nop 0
    buffer_load_dwordx4 v7, s[8:11], s2 offen sc1 lds
    v_mfma_f32_16x16x32_bf16 v[216:219], v[128:131], v[176:179], v[216:219]
    s_lshl_b32 s52, s45, 6
    s_add_u32 s52, s52, 158464
    v_lshl_add_u32 v220, v3, 4, s52
    v_cmp_eq_u32 vcc, 0, v2
    s_nop 1
    s_mov_b64 exec, vcc
    ds_write_b128 v220, v[196:199]
    s_mov_b64 exec, -1
    s_waitcnt lgkmcnt(0)
    s_barrier
    v_lshrrev_b32 v243, 2, v2
    v_lshl_add_u32 v243, v3, 2, v243
    v_mul_u32_u24 v243, 56, v243
    v_and_b32 v244, 3, v1
    v_lshl_add_u32 v243, v244, 3, v243
    v_add_u32 v243, 155648, v243
    ds_read_b64_tr_b16 v[188:189], v243 offset:0
    ds_read_b64_tr_b16 v[190:191], v243 offset:896
    ds_read_b64_tr_b16 v[192:193], v243 offset:32
    ds_read_b64_tr_b16 v[194:195], v243 offset:928
    v_lshlrev_b32 v239, 2, v2
    v_add_u32 v239, 158336, v239
    ds_read_b32 v240, v239 offset:0
    ds_read_b32 v242, v239 offset:256
    ds_read_b32 v241, v239 offset:64
    ds_read_b32 v243, v239 offset:320
    s_waitcnt lgkmcnt(2)
    v_add_f32 v240, v240, v242
    s_waitcnt lgkmcnt(0)
    v_add_f32 v241, v241, v243
    v_cmp_eq_u32 vcc, 12, v2
    v_mov_b32 v238, 0x3f803f80
    s_nop 0
    v_cndmask_b32 v238, v15, v238, vcc
    s_lshl_b32 s52, s45, 11
    s_add_u32 s52, s52, 147456
    v_add_u32 v239, s52, v7
    v_mul_f32 v204, v132, v204
    v_fma_f32 v204, v140, v240, v204
    v_mul_f32 v205, v133, v205
    v_fma_f32 v205, v141, v240, v205
    v_mul_f32 v206, v134, v206
    v_fma_f32 v206, v142, v240, v206
    v_mul_f32 v207, v135, v207
    v_fma_f32 v207, v143, v240, v207
    v_cvt_pk_bf16_f32 v164, v204, v205
    v_cvt_pk_bf16_f32 v165, v206, v207
    v_mul_f32 v208, v136, v208
    v_fma_f32 v208, v144, v240, v208
    v_mul_f32 v209, v137, v209
    v_fma_f32 v209, v145, v240, v209
    v_mul_f32 v210, v138, v210
    v_fma_f32 v210, v146, v240, v210
    v_mul_f32 v211, v139, v211
    v_fma_f32 v211, v147, v240, v211
    v_cvt_pk_bf16_f32 v166, v208, v209
    v_cvt_pk_bf16_f32 v167, v210, v211
    ds_write_b128 v239, v[164:167] offset:0
    v_mul_f32 v212, v132, v212
    v_fma_f32 v212, v140, v241, v212
    v_mul_f32 v213, v133, v213
    v_fma_f32 v213, v141, v241, v213
    v_mul_f32 v214, v134, v214
    v_fma_f32 v214, v142, v241, v214
    v_mul_f32 v215, v135, v215
    v_fma_f32 v215, v143, v241, v215
    v_cvt_pk_bf16_f32 v168, v212, v213
    v_cvt_pk_bf16_f32 v169, v214, v215
    v_mul_f32 v216, v136, v216
    v_fma_f32 v216, v144, v241, v216
    v_mul_f32 v217, v137, v217
    v_fma_f32 v217, v145, v241, v217
    v_mul_f32 v218, v138, v218
    v_fma_f32 v218, v146, v241, v218
    v_mul_f32 v219, v139, v219
    v_fma_f32 v219, v147, v241, v219
    v_cvt_pk_bf16_f32 v170, v216, v217
    v_cvt_pk_bf16_f32 v171, v218, v219
    v_cndmask_b32 v168, v168, v238, s[64:65]
    v_cndmask_b32 v169, v169, v238, s[64:65]
    v_cndmask_b32 v170, v170, v238, s[64:65]
    v_cndmask_b32 v171, v171, v238, s[64:65]
    ds_write_b128 v239, v[168:171] offset:1024
    v_cndmask_b32 v190, v190, v15, s[62:63]
    v_cndmask_b32 v191, v191, v15, s[62:63]
    v_cndmask_b32 v194, v194, v15, s[62:63]
    v_cndmask_b32 v195, v195, v15, s[62:63]
    v_lshrrev_b32 v220, 1, v2
    v_and_b32 v220, 3, v220
    v_lshlrev_b32 v221, 7, v2
    v_lshl_add_u32 v221, v3, 3, v221
    s_lshl_b32 s52, s45, 12
    s_add_u32 s52, s52, 131072
    v_add_u32 v221, s52, v221
    v_xor_b32 v196, 0, v220
    v_lshl_add_u32 v204, v196, 5, v221
    v_xor_b32 v196, 1, v220
    v_lshl_add_u32 v205, v196, 5, v221
    v_xor_b32 v196, 2, v220
    v_lshl_add_u32 v206, v196, 5, v221
    v_xor_b32 v196, 3, v220
    v_lshl_add_u32 v207, v196, 5, v221
    s_waitcnt vmcnt(0)
    s_waitcnt lgkmcnt(0)
    s_barrier
    s_lshl_b32 s52, s45, 10
    s_add_u32 s52, s52, 159744
    v_add_u32 v222, s52, v7
    ds_read_b128 v[172:175], v222
    v_add_u32 v220, 49152, v7
    v_mov_b32 v148, 0
    v_mov_b32 v149, 0
    v_mov_b32 v150, 0
    v_mov_b32 v151, 0
    v_mov_b32 v152, 0
    v_mov_b32 v153, 0
    v_mov_b32 v154, 0
    v_mov_b32 v155, 0
    ds_read_b128 v[132:135], v220 offset:0
    ds_read_b128 v[136:139], v220 offset:14336
    s_waitcnt lgkmcnt(2)
    v_mfma_f32_16x16x32_bf16 v[176:179], v[188:191], v[172:175], 0
    v_mfma_f32_16x16x32_bf16 v[180:183], v[192:195], v[172:175], 0
    s_waitcnt lgkmcnt(1)
    v_mfma_f32_16x16x32_bf16 v[148:151], v[132:135], v[24:27], v[148:151]
    s_waitcnt lgkmcnt(0)
    v_mfma_f32_16x16x32_bf16 v[152:155], v[136:139], v[24:27], v[152:155]
    ds_read_b128 v[140:143], v220 offset:1024
    ds_read_b128 v[144:147], v220 offset:15360
    s_nop 0
    v_max3_f32 v222, v176, v177, v178
    v_max3_f32 v224, v180, v181, v182
    v_min3_f32 v223, v176, v177, v178
    v_min3_f32 v225, v180, v181, v182
    v_max_f32 v222, v222, v179
    v_max_f32 v224, v224, v183
    v_min_f32 v223, v223, v179
    s_waitcnt lgkmcnt(1)
    v_mfma_f32_16x16x32_bf16 v[148:151], v[140:143], v[32:35], v[148:151]
    s_waitcnt lgkmcnt(0)
    v_mfma_f32_16x16x32_bf16 v[152:155], v[144:147], v[32:35], v[152:155]
    ds_read_b128 v[132:135], v220 offset:2048
    ds_read_b128 v[136:139], v220 offset:16384
    v_min_f32 v225, v225, v183
    v_mov_b32 v226, 0x7149f2ca
    v_cndmask_b32 v224, v224, v222, s[62:63]
    v_cndmask_b32 v225, v225, v223, s[62:63]
    s_mov_b32 s56, 0x3fb8aa3b
    v_max_f32 v222, v222, v224
    v_min_f32 v223, v223, v225
    v_mul_f32 v222, 0x3fb8aa3b, v222
    s_waitcnt lgkmcnt(1)
    v_mfma_f32_16x16x32_bf16 v[148:151], v[132:135], v[40:43], v[148:151]
    s_waitcnt lgkmcnt(0)
    v_mfma_f32_16x16x32_bf16 v[152:155], v[136:139], v[40:43], v[152:155]
    ds_read_b128 v[140:143], v220 offset:3072
    ds_read_b128 v[144:147], v220 offset:17408
    v_mul_f32 v223, 0xbfb8aa3b, v223
    s_nop 1
    v_permlane32_swap_b32 v222, v223
    v_max_f32 v222, v222, v223
    v_mov_b32 v224, v222
    s_nop 1
    v_permlane16_swap_b32 v222, v224
    v_max_f32 v222, v222, v224
    v_mov_b32 v223, v222
    s_nop 1
    v_permlane32_swap_b32 v222, v223
    s_waitcnt lgkmcnt(1)
    v_mfma_f32_16x16x32_bf16 v[148:151], v[140:143], v[48:51], v[148:151]
    s_waitcnt lgkmcnt(0)
    v_mfma_f32_16x16x32_bf16 v[152:155], v[144:147], v[48:51], v[152:155]
    ds_read_b128 v[132:135], v220 offset:4096
    ds_read_b128 v[136:139], v220 offset:18432
    v_cndmask_b32 v224, v222, v226, s[62:63]
    v_cndmask_b32 v225, v223, v226, s[62:63]
    v_fma_f32 v227, v176, s56, -v222
    v_fma_f32 v235, -v176, s56, -v223
    v_fma_f32 v228, v177, s56, -v222
    v_fma_f32 v236, -v177, s56, -v223
    v_fma_f32 v229, v178, s56, -v222
    s_waitcnt lgkmcnt(1)
    v_mfma_f32_16x16x32_bf16 v[148:151], v[132:135], v[56:59], v[148:151]
    s_waitcnt lgkmcnt(0)
    v_mfma_f32_16x16x32_bf16 v[152:155], v[136:139], v[56:59], v[152:155]
    ds_read_b128 v[140:143], v220 offset:5120
    ds_read_b128 v[144:147], v220 offset:19456
    v_fma_f32 v237, -v178, s56, -v223
    v_fma_f32 v230, v179, s56, -v222
    v_fma_f32 v238, -v179, s56, -v223
    v_fma_f32 v231, v180, s56, -v224
    v_fma_f32 v239, -v180, s56, -v225
    v_fma_f32 v232, v181, s56, -v224
    v_fma_f32 v240, -v181, s56, -v225
    v_fma_f32 v233, v182, s56, -v224
    s_waitcnt lgkmcnt(1)
    v_mfma_f32_16x16x32_bf16 v[148:151], v[140:143], v[64:67], v[148:151]
    s_waitcnt lgkmcnt(0)
    v_mfma_f32_16x16x32_bf16 v[152:155], v[144:147], v[64:67], v[152:155]
    ds_read_b128 v[132:135], v220 offset:6144
    ds_read_b128 v[136:139], v220 offset:20480
    v_fma_f32 v241, -v182, s56, -v225
    v_fma_f32 v234, v183, s56, -v224
    v_fma_f32 v242, -v183, s56, -v225
    v_exp_f32 v227, v227
    v_exp_f32 v235, v235
    v_exp_f32 v228, v228
    v_exp_f32 v236, v236
    v_exp_f32 v229, v229
    s_waitcnt lgkmcnt(1)
    v_mfma_f32_16x16x32_bf16 v[148:151], v[132:135], v[72:75], v[148:151]
    s_waitcnt lgkmcnt(0)
    v_mfma_f32_16x16x32_bf16 v[152:155], v[136:139], v[72:75], v[152:155]
    ds_read_b128 v[140:143], v220 offset:7168
    ds_read_b128 v[144:147], v220 offset:21504
    v_exp_f32 v237, v237
    v_exp_f32 v230, v230
    v_exp_f32 v238, v238
    v_exp_f32 v231, v231
    v_exp_f32 v239, v239
    v_exp_f32 v232, v232
    v_exp_f32 v240, v240
    v_exp_f32 v233, v233
    s_waitcnt lgkmcnt(1)
    v_mfma_f32_16x16x32_bf16 v[148:151], v[140:143], v[80:83], v[148:151]
    s_waitcnt lgkmcnt(0)
    v_mfma_f32_16x16x32_bf16 v[152:155], v[144:147], v[80:83], v[152:155]
    ds_read_b128 v[132:135], v220 offset:8192
    ds_read_b128 v[136:139], v220 offset:22528
    v_exp_f32 v241, v241
    v_exp_f32 v234, v234
    v_exp_f32 v242, v242
    v_add_f32 v222, v227, v228
    v_add_f32 v223, v235, v236
    v_add_f32 v224, v229, v230
    v_add_f32 v225, v237, v238
    s_waitcnt lgkmcnt(1)
    v_mfma_f32_16x16x32_bf16 v[148:151], v[132:135], v[88:91], v[148:151]
    s_waitcnt lgkmcnt(0)
    v_mfma_f32_16x16x32_bf16 v[152:155], v[136:139], v[88:91], v[152:155]
    ds_read_b128 v[140:143], v220 offset:9216
    ds_read_b128 v[144:147], v220 offset:23552
    v_add_f32 v222, v222, v231
    v_add_f32 v223, v223, v239
    v_add_f32 v224, v224, v232
    v_add_f32 v225, v225, v240
    v_add_f32 v222, v222, v233
    v_add_f32 v223, v223, v241
    v_add_f32 v224, v224, v234
    v_add_f32 v225, v225, v242
    s_waitcnt lgkmcnt(1)
    v_mfma_f32_16x16x32_bf16 v[148:151], v[140:143], v[96:99], v[148:151]
    s_waitcnt lgkmcnt(0)
    v_mfma_f32_16x16x32_bf16 v[152:155], v[144:147], v[96:99], v[152:155]
    ds_read_b128 v[132:135], v220 offset:10240
    ds_read_b128 v[136:139], v220 offset:24576
    v_add_f32 v222, v222, v224
    v_add_f32 v223, v223, v225
    s_nop 1
    v_permlane32_swap_b32 v222, v223
    v_add_f32 v222, v222, v223
    v_mov_b32 v224, v222
    s_nop 1
    v_permlane16_swap_b32 v222, v224
    v_add_f32 v222, v222, v224
    v_mov_b32 v223, v222
    s_waitcnt lgkmcnt(1)
    v_mfma_f32_16x16x32_bf16 v[148:151], v[132:135], v[104:107], v[148:151]
    s_waitcnt lgkmcnt(0)
    v_mfma_f32_16x16x32_bf16 v[152:155], v[136:139], v[104:107], v[152:155]
    ds_read_b128 v[140:143], v220 offset:11264
    ds_read_b128 v[144:147], v220 offset:25600
    v_permlane32_swap_b32 v222, v223
    v_rcp_f32 v222, v222
    v_rcp_f32 v223, v223
    v_mul_f32 v227, v222, v227
    v_mul_f32 v235, v223, v235
    v_mul_f32 v228, v222, v228
    v_mul_f32 v236, v223, v236
    s_waitcnt lgkmcnt(1)
    v_mfma_f32_16x16x32_bf16 v[148:151], v[140:143], v[112:115], v[148:151]
    s_waitcnt lgkmcnt(0)
    v_mfma_f32_16x16x32_bf16 v[152:155], v[144:147], v[112:115], v[152:155]
    ds_read_b128 v[132:135], v220 offset:12288
    ds_read_b128 v[136:139], v220 offset:26624
    v_mul_f32 v229, v222, v229
    v_mul_f32 v237, v223, v237
    v_mul_f32 v230, v222, v230
    v_mul_f32 v238, v223, v238
    v_mul_f32 v231, v222, v231
    v_mul_f32 v239, v223, v239
    v_mul_f32 v232, v222, v232
    v_mul_f32 v240, v223, v240
    s_waitcnt lgkmcnt(1)
    v_mfma_f32_16x16x32_bf16 v[148:151], v[132:135], v[120:123], v[148:151]
    s_waitcnt lgkmcnt(0)
    v_mfma_f32_16x16x32_bf16 v[152:155], v[136:139], v[120:123], v[152:155]
    ds_read_b128 v[140:143], v220 offset:13312
    ds_read_b128 v[144:147], v220 offset:27648
    v_mul_f32 v233, v222, v233
    v_mul_f32 v241, v223, v241
    v_mul_f32 v234, v222, v234
    v_mul_f32 v242, v223, v242
    v_cvt_pk_bf16_f32 v164, v227, v228
    v_cvt_pk_bf16_f32 v168, v235, v236
    v_cvt_pk_bf16_f32 v165, v229, v230
    v_cvt_pk_bf16_f32 v169, v237, v238
    s_waitcnt lgkmcnt(1)
    v_mfma_f32_16x16x32_bf16 v[148:151], v[140:143], v[128:131], v[148:151]
    s_waitcnt lgkmcnt(0)
    v_mfma_f32_16x16x32_bf16 v[152:155], v[144:147], v[128:131], v[152:155]
    v_cvt_pk_bf16_f32 v166, v231, v232
    v_cvt_pk_bf16_f32 v170, v239, v240
    v_cvt_pk_bf16_f32 v167, v233, v234
    v_cvt_pk_bf16_f32 v171, v241, v242
    ds_write_b64 v204, v[164:165] offset:2048
    ds_write_b64 v205, v[166:167] offset:2048
    ds_write_b64 v206, v[168:169] offset:2048
    ds_write_b64 v207, v[170:171] offset:2048
    s_waitcnt lgkmcnt(0)
    s_barrier
    v_lshrrev_b32 v222, 2, v2
    v_lshl_add_u32 v223, v3, 2, v222
    v_lshrrev_b32 v224, 1, v223
    v_and_b32 v224, 3, v224
    s_lshr_b32 s52, s44, 1
    v_xor_b32 v224, s52, v224
    v_lshlrev_b32 v223, 7, v223
    v_lshl_add_u32 v223, v224, 5, v223
    v_and_b32 v224, 3, v1
    v_lshl_add_u32 v223, v224, 3, v223
    v_add_u32 v223, 131072, v223
    s_and_b32 s52, s44, 1
    s_lshl_b32 s52, s52, 10
    s_add_u32 s52, s52, 147456
    v_add_u32 v224, s52, v7
    ds_read_b64_tr_b16 v[164:165], v223 offset:0
    ds_read_b64_tr_b16 v[166:167], v223 offset:2048
    ds_read_b128 v[180:183], v224 offset:0
    ds_read_b64_tr_b16 v[168:169], v223 offset:4096
    ds_read_b64_tr_b16 v[170:171], v223 offset:6144
    ds_read_b128 v[184:187], v224 offset:2048
    ds_read_b64_tr_b16 v[172:173], v223 offset:8192
    ds_read_b64_tr_b16 v[174:175], v223 offset:10240
    ds_read_b128 v[188:191], v224 offset:4096
    ds_read_b64_tr_b16 v[176:177], v223 offset:12288
    ds_read_b64_tr_b16 v[178:179], v223 offset:14336
    ds_read_b128 v[192:195], v224 offset:6144
    s_waitcnt lgkmcnt(9)
    v_mfma_f32_16x16x32_bf16 v[226:229], v[164:167], v[180:183], 0
    s_waitcnt lgkmcnt(6)
    v_mfma_f32_16x16x32_bf16 v[226:229], v[168:171], v[184:187], v[226:229]
    s_waitcnt lgkmcnt(3)
    v_mfma_f32_16x16x32_bf16 v[226:229], v[172:175], v[188:191], v[226:229]
    s_waitcnt lgkmcnt(0)
    v_mfma_f32_16x16x32_bf16 v[226:229], v[176:179], v[192:195], v[226:229]
    s_lshl_b32 s52, s47, 17
    s_lshl_b32 s57, s46, 13
    s_add_u32 s52, s52, s57
    s_lshl_b32 s57, s44, 10
    s_add_u32 s52, s52, s57
    s_add_u32 s52, s52, 2097152
    s_nop 1
    v_bfi_b32 v226, s74, v14, v226
    buffer_store_dwordx4 v[226:229], v7, s[8:11], s52 offen sc1
    v_lshrrev_b32 v243, 2, v2
    v_lshl_add_u32 v243, v3, 2, v243
    v_mul_u32_u24 v243, 56, v243
    v_and_b32 v244, 3, v1
    v_lshl_add_u32 v243, v244, 3, v243
    v_add_u32 v243, 155648, v243
    ds_read_b64_tr_b16 v[104:105], v243 offset:0
    ds_read_b64_tr_b16 v[106:107], v243 offset:896
    ds_read_b64_tr_b16 v[108:109], v243 offset:32
    ds_read_b64_tr_b16 v[110:111], v243 offset:928
    v_lshlrev_b32 v220, 4, v3
    v_add_u32 v220, 158720, v220
    ds_read_b128 v[84:87], v220 offset:0
    ds_read_b128 v[92:95], v220 offset:128
    ds_read_b128 v[88:91], v220 offset:64
    ds_read_b128 v[96:99], v220 offset:192
    s_waitcnt lgkmcnt(2)
    v_add_f32 v84, v84, v92
    v_add_f32 v85, v85, v93
    v_add_f32 v86, v86, v94
    v_add_f32 v87, v87, v95
    s_waitcnt lgkmcnt(0)
    v_add_f32 v88, v88, v96
    v_add_f32 v89, v89, v97
    v_add_f32 v90, v90, v98
    v_add_f32 v91, v91, v99
    v_mul_f32 v148, v201, v148
    v_fma_f32 v148, v203, v84, v148
    v_mul_f32 v149, v201, v149
    v_fma_f32 v149, v203, v85, v149
    v_mul_f32 v150, v201, v150
    v_fma_f32 v150, v203, v86, v150
    v_mul_f32 v151, v201, v151
    v_fma_f32 v151, v203, v87, v151
    v_cvt_pk_bf16_f32 v120, v148, v149
    v_cvt_pk_bf16_f32 v121, v150, v151
    v_mul_f32 v152, v201, v152
    v_fma_f32 v152, v203, v88, v152
    v_mul_f32 v153, v201, v153
    v_fma_f32 v153, v203, v89, v153
    v_mul_f32 v154, v201, v154
    v_fma_f32 v154, v203, v90, v154
    v_mul_f32 v155, v201, v155
    v_fma_f32 v155, v203, v91, v155
    v_cvt_pk_bf16_f32 v122, v152, v153
    v_cvt_pk_bf16_f32 v123, v154, v155
    s_barrier
    s_sub_u32 s56, s47, 14
    s_lshl_b32 s52, s46, 17
    s_lshl_b32 s57, s56, 12
    s_add_u32 s52, s52, s57
    s_lshl_b32 s57, s45, 10
    s_add_u32 s52, s52, s57
    s_add_u32 s52, s52, 2162688
    s_waitcnt vmcnt(0) lgkmcnt(0)
    s_mov_b32 s70, 0
L_rl_60:
    s_mov_b32 s53, s52
    buffer_load_dwordx4 v[132:135], v7, s[8:11], s53 offen sc1
    s_add_u32 s53, s53, 8192
    buffer_load_dwordx4 v[136:139], v7, s[8:11], s53 offen sc1
    s_add_u32 s53, s53, 8192
    buffer_load_dwordx4 v[140:143], v7, s[8:11], s53 offen sc1
    s_add_u32 s53, s53, 8192
    buffer_load_dwordx4 v[144:147], v7, s[8:11], s53 offen sc1
    s_add_u32 s53, s53, 8192
    buffer_load_dwordx4 v[148:151], v7, s[8:11], s53 offen sc1
    s_add_u32 s53, s53, 8192
    buffer_load_dwordx4 v[152:155], v7, s[8:11], s53 offen sc1
    s_add_u32 s53, s53, 8192
    buffer_load_dwordx4 v[156:159], v7, s[8:11], s53 offen sc1
    s_add_u32 s53, s53, 8192
    buffer_load_dwordx4 v[160:163], v7, s[8:11], s53 offen sc1
    s_waitcnt vmcnt(0)
    v_xor_b32 v222, v14, v132
    v_xor_b32 v223, v14, v136
    v_or_b32 v222, v222, v223
    v_xor_b32 v223, v14, v140
    v_or_b32 v222, v222, v223
    v_xor_b32 v223, v14, v144
    v_or_b32 v222, v222, v223
    v_xor_b32 v223, v14, v148
    v_or_b32 v222, v222, v223
    v_xor_b32 v223, v14, v152
    v_or_b32 v222, v222, v223
    v_xor_b32 v223, v14, v156
    v_or_b32 v222, v222, v223
    v_xor_b32 v223, v14, v160
    v_or_b32 v222, v222, v223
    v_and_b32 v222, 0xfff, v222
    v_cmp_ne_u32 vcc, 0, v222
    s_nop 4
    s_cmp_eq_u64 vcc, 0
    s_cbranch_scc1 L_rok_61
    s_add_u32 s70, s70, 1
    s_cmp_lt_u32 s70, 4000
    s_cbranch_scc1 L_rl_60
L_rok_61:
    v_add_f32 v132, v132, v136
    v_add_f32 v133, v133, v137
    v_add_f32 v134, v134, v138
    v_add_f32 v135, v135, v139
    v_add_f32 v140, v140, v144
    v_add_f32 v141, v141, v145
    v_add_f32 v142, v142, v146
    v_add_f32 v143, v143, v147
    v_add_f32 v148, v148, v152
    v_add_f32 v149, v149, v153
    v_add_f32 v150, v150, v154
    v_add_f32 v151, v151, v155
    v_add_f32 v156, v156, v160
    v_add_f32 v157, v157, v161
    v_add_f32 v158, v158, v162
    v_add_f32 v159, v159, v163
    v_add_f32 v132, v132, v140
    v_add_f32 v148, v148, v156
    v_add_f32 v133, v133, v141
    v_add_f32 v149, v149, v157
    v_add_f32 v134, v134, v142
    v_add_f32 v150, v150, v158
    v_add_f32 v135, v135, v143
    v_add_f32 v151, v151, v159
    v_add_f32 v132, v132, v148
    v_add_f32 v133, v133, v149
    v_add_f32 v134, v134, v150
    v_add_f32 v135, v135, v151
    s_lshl_b32 s52, s45, 10
    s_add_u32 s52, s52, 131072
    v_add_u32 v222, s52, v7
    ds_write_b128 v222, v[132:135]
    s_waitcnt vmcnt(0) lgkmcnt(0)
    s_barrier
    v_cndmask_b32 v106, v106, v15, s[62:63]
    v_cndmask_b32 v107, v107, v15, s[62:63]
    v_cndmask_b32 v110, v110, v15, s[62:63]
    v_cndmask_b32 v111, v111, v15, s[62:63]
    v_mfma_f32_16x16x32_bf16 v[84:87], v[104:107], v[120:123], 0
    s_nop 0
    v_mfma_f32_16x16x32_bf16 v[88:91], v[108:111], v[120:123], 0
    s_nop 5
    v_max3_f32 v222, v84, v85, v86
    s_nop 0
    v_max3_f32 v224, v88, v89, v90
    v_min3_f32 v223, v84, v85, v86
    v_min3_f32 v225, v88, v89, v90
    v_max_f32 v222, v222, v87
    v_max_f32 v224, v224, v91
    v_min_f32 v223, v223, v87
    v_min_f32 v225, v225, v91
    v_mov_b32 v226, 0x7149f2ca
    v_cndmask_b32 v224, v224, v222, s[62:63]
    v_cndmask_b32 v225, v225, v223, s[62:63]
    s_mov_b32 s56, 0x3fb8aa3b
    v_max_f32 v222, v222, v224
    v_min_f32 v223, v223, v225
    v_mul_f32 v222, 0x3fb8aa3b, v222
    v_mul_f32 v223, 0xbfb8aa3b, v223
    s_nop 1
    v_permlane32_swap_b32 v222, v223
    v_max_f32 v222, v222, v223
    v_mov_b32 v224, v222
    s_nop 1
    v_permlane16_swap_b32 v222, v224
    v_max_f32 v222, v222, v224
    v_mov_b32 v223, v222
    s_nop 1
    v_permlane32_swap_b32 v222, v223
    v_cndmask_b32 v224, v222, v226, s[62:63]
    v_cndmask_b32 v225, v223, v226, s[62:63]
    v_fma_f32 v227, v84, s56, -v222
    v_fma_f32 v235, -v84, s56, -v223
    v_fma_f32 v228, v85, s56, -v222
    v_fma_f32 v236, -v85, s56, -v223
    v_fma_f32 v229, v86, s56, -v222
    v_fma_f32 v237, -v86, s56, -v223
    v_fma_f32 v230, v87, s56, -v222
    v_fma_f32 v238, -v87, s56, -v223
    v_fma_f32 v231, v88, s56, -v224
    v_fma_f32 v239, -v88, s56, -v225
    v_fma_f32 v232, v89, s56, -v224
    v_fma_f32 v240, -v89, s56, -v225
    v_fma_f32 v233, v90, s56, -v224
    v_fma_f32 v241, -v90, s56, -v225
    v_fma_f32 v234, v91, s56, -v224
    v_fma_f32 v242, -v91, s56, -v225
    v_exp_f32 v227, v227
    v_exp_f32 v235, v235
    v_exp_f32 v228, v228
    v_exp_f32 v236, v236
    v_exp_f32 v229, v229
    v_exp_f32 v237, v237
    v_exp_f32 v230, v230
    v_exp_f32 v238, v238
    v_exp_f32 v231, v231
    v_exp_f32 v239, v239
    v_exp_f32 v232, v232
    v_exp_f32 v240, v240
    v_exp_f32 v233, v233
    v_exp_f32 v241, v241
    v_exp_f32 v234, v234
    v_exp_f32 v242, v242
    v_add_f32 v222, v227, v228
    v_add_f32 v223, v235, v236
    v_add_f32 v224, v229, v230
    v_add_f32 v225, v237, v238
    v_add_f32 v222, v222, v231
    v_add_f32 v223, v223, v239
    v_add_f32 v224, v224, v232
    v_add_f32 v225, v225, v240
    v_add_f32 v222, v222, v233
    v_add_f32 v223, v223, v241
    v_add_f32 v224, v224, v234
    v_add_f32 v225, v225, v242
    v_add_f32 v222, v222, v224
    v_add_f32 v223, v223, v225
    s_nop 1
    v_permlane32_swap_b32 v222, v223
    v_add_f32 v222, v222, v223
    v_mov_b32 v224, v222
    s_nop 1
    v_permlane16_swap_b32 v222, v224
    v_add_f32 v222, v222, v224
    v_mov_b32 v223, v222
    s_nop 1
    v_permlane32_swap_b32 v222, v223
    v_rcp_f32 v222, v222
    v_rcp_f32 v223, v223
    v_mul_f32 v227, v222, v227
    v_mul_f32 v235, v223, v235
    v_mul_f32 v228, v222, v228
    v_mul_f32 v236, v223, v236
    v_mul_f32 v229, v222, v229
    v_mul_f32 v237, v223, v237
    v_mul_f32 v230, v222, v230
    v_mul_f32 v238, v223, v238
    v_mul_f32 v231, v222, v231
    v_mul_f32 v239, v223, v239
    v_mul_f32 v232, v222, v232
    v_mul_f32 v240, v223, v240
    v_mul_f32 v233, v222, v233
    v_mul_f32 v241, v223, v241
    v_mul_f32 v234, v222, v234
    v_mul_f32 v242, v223, v242
    v_cvt_pk_bf16_f32 v208, v227, v228
    v_cvt_pk_bf16_f32 v212, v235, v236
    v_cvt_pk_bf16_f32 v209, v229, v230
    v_cvt_pk_bf16_f32 v213, v237, v238
    v_cvt_pk_bf16_f32 v210, v231, v232
    v_cvt_pk_bf16_f32 v214, v239, v240
    v_cvt_pk_bf16_f32 v211, v233, v234
    v_cvt_pk_bf16_f32 v215, v241, v242
    s_lshl_b32 s52, s47, 13
    s_lshl_b32 s57, s44, 10
    s_add_u32 s52, s52, s57
    s_add_u32 s52, s52, 4194304
    buffer_load_dwordx4 v[124:127], v7, s[8:11], s52 offen sc1
    s_waitcnt vmcnt(0)
    v_xor_b32 v244, v14, v124
    v_and_b32 v244, 0xfff, v244
    v_cmp_ne_u32 vcc, 0, v244
    s_nop 1
    s_cmp_eq_u64 vcc, 0
    s_cbranch_scc1 L_kok_63
    s_lshl_b32 s52, s47, 13
    s_lshl_b32 s57, s44, 10
    s_add_u32 s52, s52, s57
    s_add_u32 s52, s52, 4194304
    s_mov_b32 s70, 0
L_kl_62:
    buffer_load_dwordx4 v[124:127], v7, s[8:11], s52 offen sc1
    s_waitcnt vmcnt(0)
    v_xor_b32 v244, v14, v124
    v_and_b32 v244, 0xfff, v244
    v_cmp_ne_u32 vcc, 0, v244
    s_nop 4
    s_cmp_eq_u64 vcc, 0
    s_cbranch_scc1 L_kok_63
    s_add_u32 s70, s70, 1
    s_cmp_lt_u32 s70, 4000
    s_cbranch_scc1 L_kl_62
L_kok_63:
    s_lshr_b32 s52, s44, 2
    s_lshl_b32 s52, s52, 1
    s_and_b32 s53, s44, 1
    s_add_u32 s52, s52, s53
    s_lshl_b32 s52, s52, 10
    s_bfe_u32 s53, s44, 0x10001
    s_lshl_b32 s53, s53, 3
    s_add_u32 s52, s52, s53
    s_add_u32 s52, s52, 159744
    v_cvt_pk_bf16_f32 v124, v124, v125
    v_cvt_pk_bf16_f32 v125, v126, v127
    v_add_u32 v244, s52, v7
    ds_write_b64 v244, v[124:125]
    v_add_u32 v244, 159744, v7
    s_waitcnt lgkmcnt(0)
    s_barrier
    ds_read_b128 v[84:87], v244 offset:0
    ds_read_b128 v[88:91], v244 offset:1024
    ds_read_b128 v[92:95], v244 offset:2048
    ds_read_b128 v[96:99], v244 offset:3072
    s_waitcnt lgkmcnt(3)
    v_mfma_f32_16x16x32_bf16 v[108:111], v[84:87], v[208:211], 0
    s_waitcnt lgkmcnt(2)
    v_mfma_f32_16x16x32_bf16 v[112:115], v[88:91], v[208:211], 0
    v_mov_b32_dpp v100, v88 row_newbcast:12 row_mask:0xf bank_mask:0xf
    v_mov_b32_dpp v101, v89 row_newbcast:12 row_mask:0xf bank_mask:0xf
    v_mov_b32_dpp v102, v90 row_newbcast:12 row_mask:0xf bank_mask:0xf
    v_mov_b32_dpp v103, v91 row_newbcast:12 row_mask:0xf bank_mask:0xf
    s_waitcnt lgkmcnt(0)
    v_mov_b32_dpp v104, v96 row_newbcast:12 row_mask:0xf bank_mask:0xf
    v_mov_b32_dpp v105, v97 row_newbcast:12 row_mask:0xf bank_mask:0xf
    v_mov_b32_dpp v106, v98 row_newbcast:12 row_mask:0xf bank_mask:0xf
    v_mov_b32_dpp v107, v99 row_newbcast:12 row_mask:0xf bank_mask:0xf
    v_mfma_f32_16x16x32_bf16 v[108:111], v[92:95], v[212:215], v[108:111]
    v_mfma_f32_16x16x32_bf16 v[112:115], v[96:99], v[212:215], v[112:115]
    v_mfma_f32_16x16x32_bf16 v[116:119], v[100:103], v[208:211], 0
    v_mfma_f32_16x16x32_bf16 v[116:119], v[104:107], v[212:215], v[116:119]
    s_nop 7
    v_add_f32 v116, 0x358637bd, v116
    v_rcp_f32 v116, v116
    s_nop 0
    v_mul_f32 v108, v116, v108
    v_mul_f32 v109, v116, v109
    v_mul_f32 v110, v116, v110
    v_mul_f32 v111, v116, v111
    v_mul_f32 v112, v116, v112
    v_mul_f32 v113, v116, v113
    v_mul_f32 v114, v116, v114
    v_mul_f32 v115, v116, v115
    v_cvt_pk_bf16_f32 v120, v108, v109
    v_cvt_pk_bf16_f32 v121, v110, v111
    v_cvt_pk_bf16_f32 v122, v112, v113
    v_cvt_pk_bf16_f32 v123, v114, v115
    v_cndmask_b32 v122, v122, v15, s[62:63]
    v_cndmask_b32 v123, v123, v15, s[62:63]
    s_lshl_b32 s52, s46, 17
    s_lshl_b32 s57, s45, 15
    s_add_u32 s52, s52, s57
    s_lshl_b32 s57, s47, 10
    s_add_u32 s52, s52, s57
    s_add_u32 s52, s52, 12599296
    buffer_store_dwordx4 v[120:123], v7, s[8:11], s52 offen sc1
    s_waitcnt vmcnt(0)
    s_lshl_b32 s52, s46, 9
    s_lshl_b32 s57, s47, 5
    s_add_u32 s52, s52, s57
    s_lshl_b32 s57, s44, 2
    s_add_u32 s52, s52, s57
    s_add_u32 s52, s52, 163840
    s_mov_b64 exec, 1
    s_cmp_eq_u32 s49, 0
    s_cbranch_scc1 L_slow_64
    buffer_store_dword v14, v15, s[8:11], s52 offen
    s_branch L_mdone_65
L_slow_64:
    buffer_store_dword v14, v15, s[8:11], s52 offen sc1
L_mdone_65:
    s_mov_b64 exec, -1
    s_endpgm
L_end:
    s_endpgm
L_code_end:
.section .rodata,"a"
.p2align 6
.amdhsa_kernel recurrent_scan__linear_kernel_hedgehog__dense_activation_squared_relu__prompt_kernel
  .amdhsa_next_free_vgpr 256
  .amdhsa_next_free_sgpr 102
  .amdhsa_accum_offset 256
  .amdhsa_group_segment_fixed_size 0
  .amdhsa_kernarg_size 96
  .amdhsa_user_sgpr_count 2
  .amdhsa_user_sgpr_kernarg_segment_ptr 1
  .amdhsa_system_sgpr_workgroup_id_x 1
.end_amdhsa_kernel
```
